```python
import torch

def _softmax(x, axis=-1):
    return torch.softmax(x, dim=axis)

def _gelu(x):
    return torch.nn.functional.gelu(x, approximate='tanh')

def _silu(x):
    return torch.nn.functional.silu(x)

def _sigmoid(x):
    return torch.sigmoid(x)

def _layernorm(x, axis=-1, eps=1e-05):
    m = x.mean(dim=axis, keepdim=True)
    v = x.var(dim=axis, keepdim=True, unbiased=False)
    return (x - m) / torch.sqrt(v + eps)

def _scatter_add(tgt, idx, src, axis=0):
    return tgt.clone().index_add_(axis, idx, src)

def _segment_sum(src, seg, n):
    out = torch.zeros((n,) + src.shape[1:], dtype=src.dtype)
    return out.index_add_(0, seg, src)

def _pad(x, pw):
    flat = tuple((v for pair in reversed(pw) for v in pair))
    return torch.nn.functional.pad(x, flat)
kernel_name = 'concat_heads__memory_aug_recurrent_mem_tr__memory_aug_recurrent_mem_tr__prompt'

def setup_inputs():

    _w = lambda a: (lambda t: t.to(torch.bfloat16) if t.is_floating_point() else t)(torch.as_tensor(a))

    def _A_setup():
        B, S, Dm = (1, 2048, 512)
        H, Dh = (32, 128)
        M, seg = (8, 32)
        seg = min(seg, S)
        S = S // seg * seg
        return {'x': _w((lambda *s: torch.randn(*s, dtype=torch.bfloat16) * 0.05)(B, S, Dm)), 'mem0': _w((lambda *s: torch.randn(*s, dtype=torch.bfloat16) * 0.4)(B, M, Dm)), 'Wq': _w((lambda *s: torch.randn(*s, dtype=torch.bfloat16) * 6.4)(Dm, H, Dh) * Dm ** (-0.5)), 'Wk': _w((lambda *s: torch.randn(*s, dtype=torch.bfloat16) * 6.4)(Dm, H, Dh) * Dm ** (-0.5)), 'Wv': _w((lambda *s: torch.randn(*s, dtype=torch.bfloat16) * 0.4)(Dm, H, Dh) * Dm ** (-0.5)), 'Wo': _w((lambda *s: torch.randn(*s, dtype=torch.bfloat16) * 0.4)(H, Dh, Dm) * (H * Dh) ** (-0.5)), 'seg_len': seg}
    _A_in = _A_setup()

    def _B_setup():
        B, S, Dm = (1, 2048, 512)
        H, Dh = (32, 128)
        M, seg = (8, 32)
        seg = min(seg, S)
        S = S // seg * seg
        return {'x': _w((lambda *s: torch.randn(*s, dtype=torch.bfloat16) * 0.05)(B, S, Dm)), 'mem0': _w((lambda *s: torch.randn(*s, dtype=torch.bfloat16) * 0.4)(B, M, Dm)), 'Wq': _w((lambda *s: torch.randn(*s, dtype=torch.bfloat16) * 6.4)(Dm, H, Dh) * Dm ** (-0.5)), 'Wk': _w((lambda *s: torch.randn(*s, dtype=torch.bfloat16) * 6.4)(Dm, H, Dh) * Dm ** (-0.5)), 'Wv': _w((lambda *s: torch.randn(*s, dtype=torch.bfloat16) * 0.4)(Dm, H, Dh) * Dm ** (-0.5)), 'Wo': _w((lambda *s: torch.randn(*s, dtype=torch.bfloat16) * 0.4)(H, Dh, Dm) * (H * Dh) ** (-0.5)), 'seg_len': seg}
    _B_in = _B_setup()
    return {'A_x': _A_in['x'], 'A_mem0': _A_in['mem0'], 'A_Wq': _A_in['Wq'], 'A_Wk': _A_in['Wk'], 'A_Wv': _A_in['Wv'], 'A_Wo': _A_in['Wo'], 'A_seg_len': _A_in['seg_len'], 'B_x': _B_in['x'], 'B_mem0': _B_in['mem0'], 'B_Wq': _B_in['Wq'], 'B_Wk': _B_in['Wk'], 'B_Wv': _B_in['Wv'], 'B_Wo': _B_in['Wo'], 'B_seg_len': _B_in['seg_len']}

def reference(A_x, A_mem0, A_Wq, A_Wk, A_Wv, A_Wo, A_seg_len, B_x, B_mem0, B_Wq, B_Wk, B_Wv, B_Wo, B_seg_len):

    def _A_ref(x, mem0, Wq, Wk, Wv, Wo, seg_len):
        B, S, Dm = x.shape
        H, Dh = (Wq.shape[1], Wq.shape[2])
        M = mem0.shape[1]
        scale = Dh ** (-0.5)
        n_seg = S // seg_len
        L = M + seg_len
        idx = torch.arange(L)
        mask = (idx[:, None] < M) | (idx[:, None] >= idx[None, :])
        mem = mem0
        outs = []
        for s in range(n_seg):
            xs = x[:, s * seg_len:(s + 1) * seg_len, :].clone()
            h = torch.concatenate([mem, xs], axis=1)
            q = torch.einsum('btd,dhe->bhte', h, Wq)
            k = torch.einsum('btd,dhe->bhte', h, Wk)
            v = torch.einsum('btd,dhe->bhte', h, Wv)
            scores = torch.einsum('bhqe,bhke->bhqk', q, k) * scale
            scores = torch.where(mask[None, None], scores, -1000000000.0)
            p = _softmax(scores, axis=-1)
            o = torch.einsum('bhqk,bhke->bhqe', p, v)
            o = torch.einsum('bhte,hed->btd', o, Wo)
            mem = o[:, :M, :].clone()
            outs.append(o[:, M:, :])
        return torch.concatenate(outs, axis=1)

    def _B_ref(x, mem0, Wq, Wk, Wv, Wo, seg_len):
        B, S, Dm = x.shape
        H, Dh = (Wq.shape[1], Wq.shape[2])
        M = mem0.shape[1]
        scale = Dh ** (-0.5)
        n_seg = S // seg_len
        L = M + seg_len
        idx = torch.arange(L)
        mask = (idx[:, None] < M) | (idx[:, None] >= idx[None, :])
        mem = mem0
        outs = []
        for s in range(n_seg):
            xs = x[:, s * seg_len:(s + 1) * seg_len, :].clone()
            h = torch.concatenate([mem, xs], axis=1)
            q = torch.einsum('btd,dhe->bhte', h, Wq)
            k = torch.einsum('btd,dhe->bhte', h, Wk)
            v = torch.einsum('btd,dhe->bhte', h, Wv)
            scores = torch.einsum('bhqe,bhke->bhqk', q, k) * scale
            scores = torch.where(mask[None, None], scores, -1000000000.0)
            p = _softmax(scores, axis=-1)
            o = torch.einsum('bhqk,bhke->bhqe', p, v)
            o = torch.einsum('bhte,hed->btd', o, Wo)
            mem = o[:, :M, :].clone()
            outs.append(o[:, M:, :])
        return torch.concatenate(outs, axis=1)
    a = _A_ref(A_x, A_mem0, A_Wq, A_Wk, A_Wv, A_Wo, A_seg_len)
    b = _B_ref(B_x, B_mem0, B_Wq, B_Wk, B_Wv, B_Wo, B_seg_len)
    return torch.concatenate([a, b], axis=-1)
```

```asm
; @launch grid=(256,1,1) block=(256,1,1) lds=163840
.amdgcn_target "amdgcn-amd-amdhsa--gfx950"
.text
.globl concat_heads__memory_aug_recurrent_mem_tr__memory_aug_recurrent_mem_tr__prompt_kernel
.p2align 8
.type concat_heads__memory_aug_recurrent_mem_tr__memory_aug_recurrent_mem_tr__prompt_kernel,@function
concat_heads__memory_aug_recurrent_mem_tr__memory_aug_recurrent_mem_tr__prompt_kernel:
    s_cmp_ge_u32 s2, 256
    s_cbranch_scc1 L_end
    s_load_dwordx16 s[16:31], s[0:1], 0
    s_load_dwordx16 s[32:47], s[0:1], 64
    s_load_dwordx2 s[48:49], s[0:1], 128
    s_getreg_b32 s12, hwreg(HW_REG_XCC_ID)
    s_and_b32 s12, s12, 7
    v_lshrrev_b32 v1, 6, v0
    s_nop 0
    v_readfirstlane_b32 s3, v1
    v_and_b32 v0, 63, v0
    s_lshl_b32 s14, s12, 2
    s_lshr_b32 s4, 0x54761032, s14
    s_and_b32 s4, s4, 7
    s_lshr_b32 s5, s2, 3
    s_mov_b32 s6, 0
    s_mov_b32 s7, 0
    s_waitcnt lgkmcnt(0)
    s_mov_b32 s52, s48
    s_mov_b32 s53, s49
    s_mov_b32 s54, 0x10000000
    s_mov_b32 s55, 0x20000
    s_mov_b32 s56, s46
    s_mov_b32 s57, s47
    s_mov_b32 s58, 0x100
    s_mov_b32 s59, 0x20000
    s_mov_b32 s80, s44
    s_mov_b32 s81, s45
    s_mov_b32 s82, 0x400000
    s_mov_b32 s83, 0x20000
    s_branch L_role
L_reload:
    s_load_dwordx16 s[16:31], s[0:1], 0
    s_load_dwordx16 s[32:47], s[0:1], 64
    s_waitcnt vmcnt(0) lgkmcnt(0)
L_role:
    s_lshr_b32 s8, s4, 2
    s_cmp_eq_u32 s8, 1
    s_cselect_b64 s[60:61], s[34:35], s[20:21]
    s_mov_b32 s62, 0x400000
    s_mov_b32 s63, 0x20000
    s_cselect_b64 s[64:65], s[36:37], s[22:23]
    s_mov_b32 s66, 0x400000
    s_mov_b32 s67, 0x20000
    s_cselect_b64 s[68:69], s[38:39], s[24:25]
    s_mov_b32 s70, 0x400000
    s_mov_b32 s71, 0x20000
    s_cselect_b64 s[72:73], s[40:41], s[26:27]
    s_mov_b32 s74, 0x400000
    s_mov_b32 s75, 0x20000
    v_lshlrev_b32 v1, 4, v0
    s_and_b32 s14, s4, 3
    s_cmp_eq_u32 s14, 0
    s_cbranch_scc1 L_chain
    s_cmp_eq_u32 s14, 1
    s_cbranch_scc1 L_outp
    s_branch L_work
L_chain:
    s_mov_b32 s9, s5
    s_lshl_b32 s84, s3, 10
    v_lshrrev_b32 v64, 4, v0
    v_and_b32 v65, 1, v64
    s_lshl_b32 s14, s3, 1
    v_or_b32 v65, s14, v65
    v_lshlrev_b32 v65, 1, v65
    v_and_b32 v66, 15, v0
    v_xor_b32 v65, v65, v66
    v_lshlrev_b32 v65, 4, v65
    s_lshl_b32 s14, s3, 2
    v_add_u32 v64, s14, v64
    v_lshlrev_b32 v64, 13, v64
    s_lshl_b32 s14, s9, 8
    v_add3_u32 v108, v64, v65, s14
    s_add_u32 m0, s84, 0
    s_mov_b32 s50, 0
    buffer_load_dwordx4 v108, s[60:63], s50 offen  lds
    s_add_u32 m0, m0, 4096
    s_add_u32 s50, s50, 131072
    buffer_load_dwordx4 v108, s[60:63], s50 offen  lds
    s_add_u32 m0, m0, 4096
    s_add_u32 s50, s50, 131072
    buffer_load_dwordx4 v108, s[60:63], s50 offen  lds
    s_add_u32 m0, m0, 4096
    s_add_u32 s50, s50, 131072
    buffer_load_dwordx4 v108, s[60:63], s50 offen  lds
    s_add_u32 m0, m0, 4096
    s_add_u32 s50, s50, 131072
    buffer_load_dwordx4 v108, s[60:63], s50 offen  lds
    s_add_u32 m0, m0, 4096
    s_add_u32 s50, s50, 131072
    buffer_load_dwordx4 v108, s[60:63], s50 offen  lds
    s_add_u32 m0, m0, 4096
    s_add_u32 s50, s50, 131072
    buffer_load_dwordx4 v108, s[60:63], s50 offen  lds
    s_add_u32 m0, m0, 4096
    s_add_u32 s50, s50, 131072
    buffer_load_dwordx4 v108, s[60:63], s50 offen  lds
    s_add_u32 m0, m0, 4096
    s_add_u32 s50, s50, 131072
    buffer_load_dwordx4 v108, s[60:63], s50 offen  lds
    s_add_u32 m0, m0, 4096
    s_add_u32 s50, s50, 131072
    buffer_load_dwordx4 v108, s[60:63], s50 offen  lds
    s_add_u32 m0, m0, 4096
    s_add_u32 s50, s50, 131072
    buffer_load_dwordx4 v108, s[60:63], s50 offen  lds
    s_add_u32 m0, m0, 4096
    s_add_u32 s50, s50, 131072
    buffer_load_dwordx4 v108, s[60:63], s50 offen  lds
    s_add_u32 m0, m0, 4096
    s_add_u32 s50, s50, 131072
    buffer_load_dwordx4 v108, s[60:63], s50 offen  lds
    s_add_u32 m0, m0, 4096
    s_add_u32 s50, s50, 131072
    buffer_load_dwordx4 v108, s[60:63], s50 offen  lds
    s_add_u32 m0, m0, 4096
    s_add_u32 s50, s50, 131072
    buffer_load_dwordx4 v108, s[60:63], s50 offen  lds
    s_add_u32 m0, m0, 4096
    s_add_u32 s50, s50, 131072
    buffer_load_dwordx4 v108, s[60:63], s50 offen  lds
    v_mov_b32 v116, -1
    v_mov_b32 v117, -1
    v_mov_b32 v118, -1
    v_mov_b32 v119, -1
    s_lshl_b32 s14, s3, 10
    s_cmp_eq_u32 s7, 0
    s_cselect_b32 s14, s14, 0x40000000
    v_add_u32 v120, s14, v1
    s_lshl_b32 s14, s2, 12
    buffer_store_dwordx4 v[116:119], v120, s[52:55], s14 offen sc1
    s_add_u32 m0, s84, 65536
    s_mov_b32 s50, 2097152
    buffer_load_dwordx4 v108, s[60:63], s50 offen  lds
    s_add_u32 m0, m0, 4096
    s_add_u32 s50, s50, 131072
    buffer_load_dwordx4 v108, s[60:63], s50 offen  lds
    s_add_u32 m0, m0, 4096
    s_add_u32 s50, s50, 131072
    buffer_load_dwordx4 v108, s[60:63], s50 offen  lds
    s_add_u32 m0, m0, 4096
    s_add_u32 s50, s50, 131072
    buffer_load_dwordx4 v108, s[60:63], s50 offen  lds
    s_add_u32 m0, m0, 4096
    s_add_u32 s50, s50, 131072
    buffer_load_dwordx4 v108, s[60:63], s50 offen  lds
    s_add_u32 m0, m0, 4096
    s_add_u32 s50, s50, 131072
    buffer_load_dwordx4 v108, s[60:63], s50 offen  lds
    s_add_u32 m0, m0, 4096
    s_add_u32 s50, s50, 131072
    buffer_load_dwordx4 v108, s[60:63], s50 offen  lds
    s_add_u32 m0, m0, 4096
    s_add_u32 s50, s50, 131072
    buffer_load_dwordx4 v108, s[60:63], s50 offen  lds
    s_add_u32 m0, m0, 4096
    s_add_u32 s50, s50, 131072
    buffer_load_dwordx4 v108, s[60:63], s50 offen  lds
    s_add_u32 m0, m0, 4096
    s_add_u32 s50, s50, 131072
    buffer_load_dwordx4 v108, s[60:63], s50 offen  lds
    s_add_u32 m0, m0, 4096
    s_add_u32 s50, s50, 131072
    buffer_load_dwordx4 v108, s[60:63], s50 offen  lds
    s_add_u32 m0, m0, 4096
    s_add_u32 s50, s50, 131072
    buffer_load_dwordx4 v108, s[60:63], s50 offen  lds
    s_add_u32 m0, m0, 4096
    s_add_u32 s50, s50, 131072
    buffer_load_dwordx4 v108, s[60:63], s50 offen  lds
    s_add_u32 m0, m0, 4096
    s_add_u32 s50, s50, 131072
    buffer_load_dwordx4 v108, s[60:63], s50 offen  lds
    s_add_u32 m0, m0, 4096
    s_add_u32 s50, s50, 131072
    buffer_load_dwordx4 v108, s[60:63], s50 offen  lds
    s_add_u32 m0, m0, 4096
    s_add_u32 s50, s50, 131072
    buffer_load_dwordx4 v108, s[60:63], s50 offen  lds
    v_bfe_u32 v65, v0, 4, 1
    v_bfe_u32 v66, v0, 3, 1
    v_bfe_u32 v67, v0, 2, 1
    v_lshl_add_u32 v68, v65, 1, v67
    v_lshl_add_u32 v68, v66, 2, v68
    v_lshlrev_b32 v68, 1, v68
    v_lshrrev_b32 v64, 5, v0
    v_lshl_add_u32 v64, v64, 4, v67
    v_lshl_add_u32 v64, v65, 2, v64
    v_lshl_add_u32 v64, v66, 3, v64
    v_lshlrev_b32 v64, 8, v64
    v_bfe_u32 v69, v0, 1, 1
    s_lshl_b32 s14, s3, 2
    v_add_u32 v69, s14, v69
    v_xor_b32 v69, v69, v68
    v_lshl_add_u32 v64, v69, 4, v64
    v_and_b32 v69, 1, v0
    v_lshl_add_u32 v109, v69, 3, v64
    s_lshl_b32 s14, s3, 14
    v_add_u32 v109, s14, v109
    v_xor_b32 v110, 32, v109
    s_and_b32 s14, s3, 1
    s_lshr_b32 s15, s3, 1
    s_lshl_b32 s50, s3, 2
    v_xor_b32 v113, s50, v0
    v_lshlrev_b32 v113, 4, v113
    s_lshl_b32 s15, s15, 4
    s_add_u32 s14, s14, s15
    s_lshl_b32 s85, s14, 10
    s_lshl_b32 s15, s9, 17
    s_add_u32 s14, s85, s15
    v_add_u32 v113, s14, v113
    v_lshrrev_b32 v64, 5, v0
    v_lshl_add_u32 v64, v64, 2, v67
    v_lshl_add_u32 v64, v65, 4, v64
    v_lshlrev_b32 v64, 10, v64
    v_lshl_add_u32 v64, v66, 4, v64
    v_lshl_add_u32 v68, v65, 1, v67
    v_xor_b32 v68, s3, v68
    v_lshl_add_u32 v64, v68, 6, v64
    v_bfe_u32 v69, v0, 1, 1
    v_lshl_add_u32 v64, v69, 5, v64
    v_and_b32 v69, 1, v0
    v_lshl_add_u32 v114, v69, 3, v64
    s_cmp_eq_u32 s8, 1
    s_cselect_b64 s[76:77], s[32:33], s[18:19]
    s_mov_b32 s78, 0x2000
    s_mov_b32 s79, 0x20000
    v_and_b32 v66, 15, v0
    v_lshrrev_b32 v67, 4, v0
    v_bfe_u32 v64, v0, 2, 2
    v_and_b32 v65, 1, v0
    v_lshl_add_u32 v64, v64, 1, v65
    v_lshlrev_b32 v54, 10, v64
    v_lshl_add_u32 v54, v67, 5, v54
    v_bfe_u32 v68, v0, 1, 1
    v_lshl_add_u32 v54, v68, 4, v54
    v_mov_b32 v2, 0x4444
    v_mov_b32 v69, 0xeeee
    v_cmp_eq_u32 vcc, 1, v68
    s_nop 1
    v_cndmask_b32 v2, v2, v69, vcc
    v_mul_u32_u24 v68, 544, v64
    v_lshl_add_u32 v68, v67, 4, v68
    v_add_u32 v8, 155648, v68
    v_lshl_add_u32 v69, v67, 3, v64
    v_lshlrev_b32 v69, 4, v69
    v_add_u32 v9, 160256, v69
    v_and_b32 v69, 2, v0
    v_lshl_add_u32 v7, v69, 2, v9
    s_mov_b32 s48, 0xcccccccc
    s_mov_b32 s49, 0xcccccccc
    v_lshlrev_b32 v68, 8, v64
    v_lshl_add_u32 v68, v67, 4, v68
    s_lshl_b32 s14, s3, 6
    v_add_u32 v68, s14, v68
    v_mov_b32 v69, 0x40000000
    v_cndmask_b32 v10, v68, v69, vcc
    v_bfe_u32 v69, v0, 2, 1
    v_lshlrev_b32 v69, 4, v69
    v_mov_b32 v70, 0x3f80
    v_lshlrev_b32 v69, v69, v70
    v_lshrrev_b32 v70, 3, v66
    v_lshl_add_u32 v70, v65, 1, v70
    v_cmp_eq_u32 vcc, 0, v70
    s_nop 1
    v_cndmask_b32 v48, 0, v69, vcc
    v_cmp_eq_u32 vcc, 1, v70
    s_nop 1
    v_cndmask_b32 v49, 0, v69, vcc
    v_cmp_eq_u32 vcc, 2, v70
    s_nop 1
    v_cndmask_b32 v50, 0, v69, vcc
    v_cmp_eq_u32 vcc, 3, v70
    s_nop 1
    v_cndmask_b32 v51, 0, v69, vcc
    v_add_u32 v14, 131072, v1
    ds_write_b128 v14, v[48:51] offset:31232
    s_lshl_b32 s14, s3, 3
    v_lshrrev_b32 v68, 3, v66
    v_lshl_add_u32 v68, v68, 2, v67
    v_add_u32 v68, s14, v68
    v_mul_u32_u24 v68, 8448, v68
    v_and_b32 v69, 7, v0
    v_lshlrev_b32 v69, 3, v69
    s_lshl_b32 s15, s9, 6
    v_add3_u32 v3, v68, v69, s15
    v_and_b32 v69, 3, v0
    v_lshlrev_b32 v69, 2, v69
    v_lshl_add_u32 v68, v67, 4, v69
    s_lshl_b32 s14, s3, 11
    v_add_u32 v68, s14, v68
    v_add_u32 v4, s15, v68
    v_and_b32 v69, 12, v0
    v_cmp_eq_u32 vcc, 0, v69
    v_mov_b32 v69, 0x40000000
    s_nop 0
    v_cndmask_b32 v4, v69, v4, vcc
    v_mov_b32 v5, -1
    s_lshl_b32 s14, s3, 6
    v_lshl_add_u32 v68, v66, 2, s14
    v_mul_u32_u24 v69, 1088, v67
    v_add_u32 v69, 155648, v69
    v_add_u32 v6, v68, v69
    s_lshl_b32 s14, s3, 9
    s_add_u32 s14, s14, 2048
    v_lshl_add_u32 v68, v66, 4, s14
    v_lshl_add_u32 v11, v67, 2, v68
    s_lshl_b32 s14, s3, 14
    v_add_u32 v12, s14, v1
    s_lshl_b32 s14, s3, 13
    s_add_u32 s14, s14, 0x10000
    v_add_u32 v13, s14, v1
    v_add_u32 v15, 139264, v1
    v_mov_b32 v121, 0
    v_mov_b32 v123, 0
    v_mov_b32 v125, 0
    s_mov_b32 s16, 0
    s_mov_b32 s17, 0
    s_mul_i32 s18, s8, 270336
    s_add_u32 s19, s18, 4096
    s_mul_i32 s14, s9, 8448
    s_lshl_b32 s34, s3, 11
    s_add_u32 s22, s18, s14
    s_add_u32 s22, s22, s34
    s_lshl_b32 s14, s8, 15
    s_add_u32 s23, s14, 851968
    s_mul_i32 s14, s8, 2048
    s_mul_i32 s15, s9, 1
    s_add_u32 s14, s14, s15
    s_lshl_b32 s27, s14, 14
    s_add_u32 s27, s27, 2097152
    s_add_u32 s27, s27, s34
    s_lshl_b32 s28, s14, 12
    s_add_u32 s28, s28, 106954752
    s_mov_b32 s24, 0x40000000
    s_lshl_b32 s14, s8, 5
    s_add_u32 s14, s14, s9
    s_lshl_b32 s14, s14, 7
    s_add_u32 s29, s14, 917504
    s_add_u32 s30, s14, 925696
    s_add_u32 s31, s34, 139264
    s_mov_b32 s32, 0x3e0293ee
    s_mov_b32 s33, 0x3e0293ee
    s_add_u32 s20, s27, 8192
    s_add_u32 s21, s27, 524288
    s_mov_b32 s91, 0
L_cdry_ret:
    s_waitcnt vmcnt(17)
    s_barrier
    ds_read_b64_tr_b16 v[24:25], v109 offset:0
    ds_read_b64_tr_b16 v[26:27], v109 offset:512
    ds_read_b64_tr_b16 v[28:29], v109 offset:8192
    ds_read_b64_tr_b16 v[30:31], v109 offset:8704
    ds_read_b64_tr_b16 v[32:33], v110 offset:0
    ds_read_b64_tr_b16 v[34:35], v110 offset:512
    ds_read_b64_tr_b16 v[36:37], v110 offset:8192
    ds_read_b64_tr_b16 v[38:39], v110 offset:8704
    v_xor_b32 v109, 0x4000, v109
    v_xor_b32 v110, 0x4000, v110
    ds_read_b64_tr_b16 a[16:17], v109 offset:0
    ds_read_b64_tr_b16 a[18:19], v109 offset:512
    ds_read_b64_tr_b16 a[20:21], v109 offset:8192
    ds_read_b64_tr_b16 a[22:23], v109 offset:8704
    ds_read_b64_tr_b16 a[80:81], v110 offset:0
    ds_read_b64_tr_b16 a[82:83], v110 offset:512
    ds_read_b64_tr_b16 a[84:85], v110 offset:8192
    ds_read_b64_tr_b16 a[86:87], v110 offset:8704
    v_xor_b32 v109, 0xc000, v109
    v_xor_b32 v110, 0xc000, v110
    ds_read_b64_tr_b16 a[24:25], v109 offset:0
    ds_read_b64_tr_b16 a[26:27], v109 offset:512
    ds_read_b64_tr_b16 a[28:29], v109 offset:8192
    ds_read_b64_tr_b16 a[30:31], v109 offset:8704
    ds_read_b64_tr_b16 a[88:89], v110 offset:0
    ds_read_b64_tr_b16 a[90:91], v110 offset:512
    ds_read_b64_tr_b16 a[92:93], v110 offset:8192
    ds_read_b64_tr_b16 a[94:95], v110 offset:8704
    v_xor_b32 v109, 0x4000, v109
    v_xor_b32 v110, 0x4000, v110
    ds_read_b64_tr_b16 a[32:33], v109 offset:0
    ds_read_b64_tr_b16 a[34:35], v109 offset:512
    ds_read_b64_tr_b16 a[36:37], v109 offset:8192
    ds_read_b64_tr_b16 a[38:39], v109 offset:8704
    ds_read_b64_tr_b16 a[96:97], v110 offset:0
    ds_read_b64_tr_b16 a[98:99], v110 offset:512
    ds_read_b64_tr_b16 a[100:101], v110 offset:8192
    ds_read_b64_tr_b16 a[102:103], v110 offset:8704
    v_xor_b32 v109, 0x1c000, v109
    v_xor_b32 v110, 0x1c000, v110
    s_waitcnt lgkmcnt(0)
    s_barrier
    s_add_u32 m0, s84, 0
    s_mov_b32 s50, 0
    buffer_load_dwordx4 v108, s[64:67], s50 offen  lds
    s_add_u32 m0, m0, 4096
    s_add_u32 s50, s50, 131072
    buffer_load_dwordx4 v108, s[64:67], s50 offen  lds
    s_add_u32 m0, m0, 4096
    s_add_u32 s50, s50, 131072
    buffer_load_dwordx4 v108, s[64:67], s50 offen  lds
    s_add_u32 m0, m0, 4096
    s_add_u32 s50, s50, 131072
    buffer_load_dwordx4 v108, s[64:67], s50 offen  lds
    s_add_u32 m0, m0, 4096
    s_add_u32 s50, s50, 131072
    buffer_load_dwordx4 v108, s[64:67], s50 offen  lds
    s_add_u32 m0, m0, 4096
    s_add_u32 s50, s50, 131072
    buffer_load_dwordx4 v108, s[64:67], s50 offen  lds
    s_add_u32 m0, m0, 4096
    s_add_u32 s50, s50, 131072
    buffer_load_dwordx4 v108, s[64:67], s50 offen  lds
    s_add_u32 m0, m0, 4096
    s_add_u32 s50, s50, 131072
    buffer_load_dwordx4 v108, s[64:67], s50 offen  lds
    s_add_u32 m0, m0, 4096
    s_add_u32 s50, s50, 131072
    buffer_load_dwordx4 v108, s[64:67], s50 offen  lds
    s_add_u32 m0, m0, 4096
    s_add_u32 s50, s50, 131072
    buffer_load_dwordx4 v108, s[64:67], s50 offen  lds
    s_add_u32 m0, m0, 4096
    s_add_u32 s50, s50, 131072
    buffer_load_dwordx4 v108, s[64:67], s50 offen  lds
    s_add_u32 m0, m0, 4096
    s_add_u32 s50, s50, 131072
    buffer_load_dwordx4 v108, s[64:67], s50 offen  lds
    s_add_u32 m0, m0, 4096
    s_add_u32 s50, s50, 131072
    buffer_load_dwordx4 v108, s[64:67], s50 offen  lds
    s_add_u32 m0, m0, 4096
    s_add_u32 s50, s50, 131072
    buffer_load_dwordx4 v108, s[64:67], s50 offen  lds
    s_add_u32 m0, m0, 4096
    s_add_u32 s50, s50, 131072
    buffer_load_dwordx4 v108, s[64:67], s50 offen  lds
    s_add_u32 m0, m0, 4096
    s_add_u32 s50, s50, 131072
    buffer_load_dwordx4 v108, s[64:67], s50 offen  lds
    s_waitcnt vmcnt(16)
    s_barrier
    s_lshl_b32 s14, s12, 3
    s_or_b32 s15, s3, s7
    s_cmp_eq_u32 s15, 0
    s_cselect_b32 s14, s14, 0x40000000
    s_lshr_b32 s15, s2, 3
    s_lshl_b32 s15, 1, s15
    v_mov_b32 v126, s15
    v_mov_b32 v127, 0x100
    v_mov_b32 v52, s14
    v_cmp_eq_u32 vcc, 0, v0
    v_mov_b32 v53, 0x40000000
    s_nop 0
    v_cndmask_b32 v52, v53, v52, vcc
    buffer_atomic_add_x2 v[126:127], v52, s[56:59], 0 offen offset:128 sc0 sc1
    ds_read_b64_tr_b16 a[8:9], v109 offset:0
    ds_read_b64_tr_b16 a[10:11], v109 offset:512
    ds_read_b64_tr_b16 a[12:13], v109 offset:8192
    ds_read_b64_tr_b16 a[14:15], v109 offset:8704
    ds_read_b64_tr_b16 a[72:73], v110 offset:0
    ds_read_b64_tr_b16 a[74:75], v110 offset:512
    ds_read_b64_tr_b16 a[76:77], v110 offset:8192
    ds_read_b64_tr_b16 a[78:79], v110 offset:8704
    v_xor_b32 v109, 0x4000, v109
    v_xor_b32 v110, 0x4000, v110
    ds_read_b64_tr_b16 a[40:41], v109 offset:0
    ds_read_b64_tr_b16 a[42:43], v109 offset:512
    ds_read_b64_tr_b16 a[44:45], v109 offset:8192
    ds_read_b64_tr_b16 a[46:47], v109 offset:8704
    ds_read_b64_tr_b16 a[104:105], v110 offset:0
    ds_read_b64_tr_b16 a[106:107], v110 offset:512
    ds_read_b64_tr_b16 a[108:109], v110 offset:8192
    ds_read_b64_tr_b16 a[110:111], v110 offset:8704
    v_xor_b32 v109, 0xc000, v109
    v_xor_b32 v110, 0xc000, v110
    ds_read_b64_tr_b16 a[48:49], v109 offset:0
    ds_read_b64_tr_b16 a[50:51], v109 offset:512
    ds_read_b64_tr_b16 a[52:53], v109 offset:8192
    ds_read_b64_tr_b16 a[54:55], v109 offset:8704
    ds_read_b64_tr_b16 a[112:113], v110 offset:0
    ds_read_b64_tr_b16 a[114:115], v110 offset:512
    ds_read_b64_tr_b16 a[116:117], v110 offset:8192
    ds_read_b64_tr_b16 a[118:119], v110 offset:8704
    v_xor_b32 v109, 0x4000, v109
    v_xor_b32 v110, 0x4000, v110
    ds_read_b64_tr_b16 a[56:57], v109 offset:0
    ds_read_b64_tr_b16 a[58:59], v109 offset:512
    ds_read_b64_tr_b16 a[60:61], v109 offset:8192
    ds_read_b64_tr_b16 a[62:63], v109 offset:8704
    ds_read_b64_tr_b16 a[120:121], v110 offset:0
    ds_read_b64_tr_b16 a[122:123], v110 offset:512
    ds_read_b64_tr_b16 a[124:125], v110 offset:8192
    ds_read_b64_tr_b16 a[126:127], v110 offset:8704
    v_xor_b32 v109, 0x1c000, v109
    v_xor_b32 v110, 0x1c000, v110
    s_waitcnt lgkmcnt(0)
    s_barrier
    s_add_u32 m0, s84, 65536
    s_mov_b32 s50, 2097152
    buffer_load_dwordx4 v108, s[64:67], s50 offen  lds
    s_add_u32 m0, m0, 4096
    s_add_u32 s50, s50, 131072
    buffer_load_dwordx4 v108, s[64:67], s50 offen  lds
    s_add_u32 m0, m0, 4096
    s_add_u32 s50, s50, 131072
    buffer_load_dwordx4 v108, s[64:67], s50 offen  lds
    s_add_u32 m0, m0, 4096
    s_add_u32 s50, s50, 131072
    buffer_load_dwordx4 v108, s[64:67], s50 offen  lds
    s_add_u32 m0, m0, 4096
    s_add_u32 s50, s50, 131072
    buffer_load_dwordx4 v108, s[64:67], s50 offen  lds
    s_add_u32 m0, m0, 4096
    s_add_u32 s50, s50, 131072
    buffer_load_dwordx4 v108, s[64:67], s50 offen  lds
    s_add_u32 m0, m0, 4096
    s_add_u32 s50, s50, 131072
    buffer_load_dwordx4 v108, s[64:67], s50 offen  lds
    s_add_u32 m0, m0, 4096
    s_add_u32 s50, s50, 131072
    buffer_load_dwordx4 v108, s[64:67], s50 offen  lds
    s_add_u32 m0, m0, 4096
    s_add_u32 s50, s50, 131072
    buffer_load_dwordx4 v108, s[64:67], s50 offen  lds
    s_add_u32 m0, m0, 4096
    s_add_u32 s50, s50, 131072
    buffer_load_dwordx4 v108, s[64:67], s50 offen  lds
    s_add_u32 m0, m0, 4096
    s_add_u32 s50, s50, 131072
    buffer_load_dwordx4 v108, s[64:67], s50 offen  lds
    s_add_u32 m0, m0, 4096
    s_add_u32 s50, s50, 131072
    buffer_load_dwordx4 v108, s[64:67], s50 offen  lds
    s_add_u32 m0, m0, 4096
    s_add_u32 s50, s50, 131072
    buffer_load_dwordx4 v108, s[64:67], s50 offen  lds
    s_add_u32 m0, m0, 4096
    s_add_u32 s50, s50, 131072
    buffer_load_dwordx4 v108, s[64:67], s50 offen  lds
    s_add_u32 m0, m0, 4096
    s_add_u32 s50, s50, 131072
    buffer_load_dwordx4 v108, s[64:67], s50 offen  lds
    s_add_u32 m0, m0, 4096
    s_add_u32 s50, s50, 131072
    buffer_load_dwordx4 v108, s[64:67], s50 offen  lds
    s_waitcnt vmcnt(17)
    s_barrier
    ds_read_b64_tr_b16 v[40:41], v109 offset:0
    ds_read_b64_tr_b16 v[42:43], v109 offset:512
    ds_read_b64_tr_b16 v[44:45], v109 offset:8192
    ds_read_b64_tr_b16 v[46:47], v109 offset:8704
    ds_read_b64_tr_b16 v[76:77], v110 offset:0
    ds_read_b64_tr_b16 v[78:79], v110 offset:512
    ds_read_b64_tr_b16 v[80:81], v110 offset:8192
    ds_read_b64_tr_b16 v[82:83], v110 offset:8704
    v_xor_b32 v109, 0x4000, v109
    v_xor_b32 v110, 0x4000, v110
    ds_read_b64_tr_b16 a[144:145], v109 offset:0
    ds_read_b64_tr_b16 a[146:147], v109 offset:512
    ds_read_b64_tr_b16 a[148:149], v109 offset:8192
    ds_read_b64_tr_b16 a[150:151], v109 offset:8704
    ds_read_b64_tr_b16 a[208:209], v110 offset:0
    ds_read_b64_tr_b16 a[210:211], v110 offset:512
    ds_read_b64_tr_b16 a[212:213], v110 offset:8192
    ds_read_b64_tr_b16 a[214:215], v110 offset:8704
    v_xor_b32 v109, 0xc000, v109
    v_xor_b32 v110, 0xc000, v110
    ds_read_b64_tr_b16 a[152:153], v109 offset:0
    ds_read_b64_tr_b16 a[154:155], v109 offset:512
    ds_read_b64_tr_b16 a[156:157], v109 offset:8192
    ds_read_b64_tr_b16 a[158:159], v109 offset:8704
    ds_read_b64_tr_b16 a[216:217], v110 offset:0
    ds_read_b64_tr_b16 a[218:219], v110 offset:512
    ds_read_b64_tr_b16 a[220:221], v110 offset:8192
    ds_read_b64_tr_b16 a[222:223], v110 offset:8704
    v_xor_b32 v109, 0x4000, v109
    v_xor_b32 v110, 0x4000, v110
    ds_read_b64_tr_b16 a[160:161], v109 offset:0
    ds_read_b64_tr_b16 a[162:163], v109 offset:512
    ds_read_b64_tr_b16 a[164:165], v109 offset:8192
    ds_read_b64_tr_b16 a[166:167], v109 offset:8704
    ds_read_b64_tr_b16 a[224:225], v110 offset:0
    ds_read_b64_tr_b16 a[226:227], v110 offset:512
    ds_read_b64_tr_b16 a[228:229], v110 offset:8192
    ds_read_b64_tr_b16 a[230:231], v110 offset:8704
    v_xor_b32 v109, 0x1c000, v109
    v_xor_b32 v110, 0x1c000, v110
    s_waitcnt lgkmcnt(0)
    s_barrier
    s_add_u32 m0, s84, 0
    s_mov_b32 s50, 0
    buffer_load_dwordx4 v108, s[68:71], s50 offen  lds
    s_add_u32 m0, m0, 4096
    s_add_u32 s50, s50, 131072
    buffer_load_dwordx4 v108, s[68:71], s50 offen  lds
    s_add_u32 m0, m0, 4096
    s_add_u32 s50, s50, 131072
    buffer_load_dwordx4 v108, s[68:71], s50 offen  lds
    s_add_u32 m0, m0, 4096
    s_add_u32 s50, s50, 131072
    buffer_load_dwordx4 v108, s[68:71], s50 offen  lds
    s_add_u32 m0, m0, 4096
    s_add_u32 s50, s50, 131072
    buffer_load_dwordx4 v108, s[68:71], s50 offen  lds
    s_add_u32 m0, m0, 4096
    s_add_u32 s50, s50, 131072
    buffer_load_dwordx4 v108, s[68:71], s50 offen  lds
    s_add_u32 m0, m0, 4096
    s_add_u32 s50, s50, 131072
    buffer_load_dwordx4 v108, s[68:71], s50 offen  lds
    s_add_u32 m0, m0, 4096
    s_add_u32 s50, s50, 131072
    buffer_load_dwordx4 v108, s[68:71], s50 offen  lds
    s_add_u32 m0, m0, 4096
    s_add_u32 s50, s50, 131072
    buffer_load_dwordx4 v108, s[68:71], s50 offen  lds
    s_add_u32 m0, m0, 4096
    s_add_u32 s50, s50, 131072
    buffer_load_dwordx4 v108, s[68:71], s50 offen  lds
    s_add_u32 m0, m0, 4096
    s_add_u32 s50, s50, 131072
    buffer_load_dwordx4 v108, s[68:71], s50 offen  lds
    s_add_u32 m0, m0, 4096
    s_add_u32 s50, s50, 131072
    buffer_load_dwordx4 v108, s[68:71], s50 offen  lds
    s_add_u32 m0, m0, 4096
    s_add_u32 s50, s50, 131072
    buffer_load_dwordx4 v108, s[68:71], s50 offen  lds
    s_add_u32 m0, m0, 4096
    s_add_u32 s50, s50, 131072
    buffer_load_dwordx4 v108, s[68:71], s50 offen  lds
    s_add_u32 m0, m0, 4096
    s_add_u32 s50, s50, 131072
    buffer_load_dwordx4 v108, s[68:71], s50 offen  lds
    s_add_u32 m0, m0, 4096
    s_add_u32 s50, s50, 131072
    buffer_load_dwordx4 v108, s[68:71], s50 offen  lds
    s_waitcnt vmcnt(16)
    s_barrier
    ds_read_b64_tr_b16 a[136:137], v109 offset:0
    ds_read_b64_tr_b16 a[138:139], v109 offset:512
    ds_read_b64_tr_b16 a[140:141], v109 offset:8192
    ds_read_b64_tr_b16 a[142:143], v109 offset:8704
    ds_read_b64_tr_b16 a[200:201], v110 offset:0
    ds_read_b64_tr_b16 a[202:203], v110 offset:512
    ds_read_b64_tr_b16 a[204:205], v110 offset:8192
    ds_read_b64_tr_b16 a[206:207], v110 offset:8704
    v_xor_b32 v109, 0x4000, v109
    v_xor_b32 v110, 0x4000, v110
    ds_read_b64_tr_b16 a[168:169], v109 offset:0
    ds_read_b64_tr_b16 a[170:171], v109 offset:512
    ds_read_b64_tr_b16 a[172:173], v109 offset:8192
    ds_read_b64_tr_b16 a[174:175], v109 offset:8704
    ds_read_b64_tr_b16 a[232:233], v110 offset:0
    ds_read_b64_tr_b16 a[234:235], v110 offset:512
    ds_read_b64_tr_b16 a[236:237], v110 offset:8192
    ds_read_b64_tr_b16 a[238:239], v110 offset:8704
    v_xor_b32 v109, 0xc000, v109
    v_xor_b32 v110, 0xc000, v110
    ds_read_b64_tr_b16 a[176:177], v109 offset:0
    ds_read_b64_tr_b16 a[178:179], v109 offset:512
    ds_read_b64_tr_b16 a[180:181], v109 offset:8192
    ds_read_b64_tr_b16 a[182:183], v109 offset:8704
    ds_read_b64_tr_b16 a[240:241], v110 offset:0
    ds_read_b64_tr_b16 a[242:243], v110 offset:512
    ds_read_b64_tr_b16 a[244:245], v110 offset:8192
    ds_read_b64_tr_b16 a[246:247], v110 offset:8704
    v_xor_b32 v109, 0x4000, v109
    v_xor_b32 v110, 0x4000, v110
    ds_read_b64_tr_b16 a[184:185], v109 offset:0
    ds_read_b64_tr_b16 a[186:187], v109 offset:512
    ds_read_b64_tr_b16 a[188:189], v109 offset:8192
    ds_read_b64_tr_b16 a[190:191], v109 offset:8704
    ds_read_b64_tr_b16 a[248:249], v110 offset:0
    ds_read_b64_tr_b16 a[250:251], v110 offset:512
    ds_read_b64_tr_b16 a[252:253], v110 offset:8192
    ds_read_b64_tr_b16 a[254:255], v110 offset:8704
    v_xor_b32 v109, 0x1c000, v109
    v_xor_b32 v110, 0x1c000, v110
    s_waitcnt lgkmcnt(0)
    s_barrier
    v_and_b32 v50, 7, v0
    v_lshlrev_b32 v50, 3, v50
    buffer_load_dwordx2 v[48:49], v50, s[56:59], 0 offen offset:128 sc1
    s_lshl_b32 s14, s3, 7
    buffer_load_dwordx4 v[16:19], v54, s[76:79], s14 offen
    buffer_load_dwordx4 v[20:23], v54, s[76:79], s14 offen offset:512
    s_add_u32 m0, s84, 65536
    s_mov_b32 s50, 2097152
    buffer_load_dwordx4 v108, s[68:71], s50 offen  lds
    s_add_u32 m0, m0, 4096
    s_add_u32 s50, s50, 131072
    buffer_load_dwordx4 v108, s[68:71], s50 offen  lds
    s_add_u32 m0, m0, 4096
    s_add_u32 s50, s50, 131072
    buffer_load_dwordx4 v108, s[68:71], s50 offen  lds
    s_add_u32 m0, m0, 4096
    s_add_u32 s50, s50, 131072
    buffer_load_dwordx4 v108, s[68:71], s50 offen  lds
    s_add_u32 m0, m0, 4096
    s_add_u32 s50, s50, 131072
    buffer_load_dwordx4 v108, s[68:71], s50 offen  lds
    s_add_u32 m0, m0, 4096
    s_add_u32 s50, s50, 131072
    buffer_load_dwordx4 v108, s[68:71], s50 offen  lds
    s_add_u32 m0, m0, 4096
    s_add_u32 s50, s50, 131072
    buffer_load_dwordx4 v108, s[68:71], s50 offen  lds
    s_add_u32 m0, m0, 4096
    s_add_u32 s50, s50, 131072
    buffer_load_dwordx4 v108, s[68:71], s50 offen  lds
    s_add_u32 m0, m0, 4096
    s_add_u32 s50, s50, 131072
    buffer_load_dwordx4 v108, s[68:71], s50 offen  lds
    s_add_u32 m0, m0, 4096
    s_add_u32 s50, s50, 131072
    buffer_load_dwordx4 v108, s[68:71], s50 offen  lds
    s_add_u32 m0, m0, 4096
    s_add_u32 s50, s50, 131072
    buffer_load_dwordx4 v108, s[68:71], s50 offen  lds
    s_add_u32 m0, m0, 4096
    s_add_u32 s50, s50, 131072
    buffer_load_dwordx4 v108, s[68:71], s50 offen  lds
    s_add_u32 m0, m0, 4096
    s_add_u32 s50, s50, 131072
    buffer_load_dwordx4 v108, s[68:71], s50 offen  lds
    s_add_u32 m0, m0, 4096
    s_add_u32 s50, s50, 131072
    buffer_load_dwordx4 v108, s[68:71], s50 offen  lds
    s_add_u32 m0, m0, 4096
    s_add_u32 s50, s50, 131072
    buffer_load_dwordx4 v108, s[68:71], s50 offen  lds
    s_add_u32 m0, m0, 4096
    s_add_u32 s50, s50, 131072
    buffer_load_dwordx4 v108, s[68:71], s50 offen  lds
    s_waitcnt vmcnt(16)
    s_barrier
    ds_read_b64_tr_b16 v[84:85], v109 offset:0
    ds_read_b64_tr_b16 v[86:87], v109 offset:512
    ds_read_b64_tr_b16 v[88:89], v109 offset:8192
    ds_read_b64_tr_b16 v[90:91], v109 offset:8704
    ds_read_b64_tr_b16 v[92:93], v110 offset:0
    ds_read_b64_tr_b16 v[94:95], v110 offset:512
    ds_read_b64_tr_b16 v[96:97], v110 offset:8192
    ds_read_b64_tr_b16 v[98:99], v110 offset:8704
    v_xor_b32 v109, 0x4000, v109
    v_xor_b32 v110, 0x4000, v110
    ds_read_b64_tr_b16 v[144:145], v109 offset:0
    ds_read_b64_tr_b16 v[146:147], v109 offset:512
    ds_read_b64_tr_b16 v[148:149], v109 offset:8192
    ds_read_b64_tr_b16 v[150:151], v109 offset:8704
    ds_read_b64_tr_b16 v[208:209], v110 offset:0
    ds_read_b64_tr_b16 v[210:211], v110 offset:512
    ds_read_b64_tr_b16 v[212:213], v110 offset:8192
    ds_read_b64_tr_b16 v[214:215], v110 offset:8704
    v_xor_b32 v109, 0xc000, v109
    v_xor_b32 v110, 0xc000, v110
    ds_read_b64_tr_b16 v[152:153], v109 offset:0
    ds_read_b64_tr_b16 v[154:155], v109 offset:512
    ds_read_b64_tr_b16 v[156:157], v109 offset:8192
    ds_read_b64_tr_b16 v[158:159], v109 offset:8704
    ds_read_b64_tr_b16 v[216:217], v110 offset:0
    ds_read_b64_tr_b16 v[218:219], v110 offset:512
    ds_read_b64_tr_b16 v[220:221], v110 offset:8192
    ds_read_b64_tr_b16 v[222:223], v110 offset:8704
    v_xor_b32 v109, 0x4000, v109
    v_xor_b32 v110, 0x4000, v110
    ds_read_b64_tr_b16 v[160:161], v109 offset:0
    ds_read_b64_tr_b16 v[162:163], v109 offset:512
    ds_read_b64_tr_b16 v[164:165], v109 offset:8192
    ds_read_b64_tr_b16 v[166:167], v109 offset:8704
    ds_read_b64_tr_b16 v[224:225], v110 offset:0
    ds_read_b64_tr_b16 v[226:227], v110 offset:512
    ds_read_b64_tr_b16 v[228:229], v110 offset:8192
    ds_read_b64_tr_b16 v[230:231], v110 offset:8704
    v_xor_b32 v109, 0x1c000, v109
    v_xor_b32 v110, 0x1c000, v110
    v_cmp_eq_u32 vcc, -1, v48
    v_mov_b32 v51, 0x2000
    v_cmp_eq_u32 s[14:15], v51, v49
    s_nop 0
    s_and_b64 vcc, vcc, s[14:15]
    s_cmp_eq_u64 vcc, -1
    s_cselect_b32 s7, 1, s7
    v_min_u32 v16, -2, v16
    v_min_u32 v17, -2, v17
    v_min_u32 v18, -2, v18
    v_min_u32 v19, -2, v19
    v_min_u32 v20, -2, v20
    v_min_u32 v21, -2, v21
    v_min_u32 v22, -2, v22
    v_min_u32 v23, -2, v23
    v_mov_b64 v[56:57], 0
    v_mov_b64 v[58:59], 0
    v_mov_b64 v[60:61], 0
    v_mov_b64 v[62:63], 0
    v_mov_b64 v[64:65], 0
    v_mov_b64 v[66:67], 0
    v_mov_b64 v[68:69], 0
    v_mov_b64 v[70:71], 0
    s_lshl_b32 s92, s2, 12
    s_add_u32 s92, s92, 0x100000
    s_add_u32 s14, s92, s84
    buffer_store_dwordx4 v[20:23], v1, s[52:55], s14 offen sc1
    s_waitcnt lgkmcnt(0)
    s_barrier
    s_add_u32 m0, s85, 0
    s_mov_b32 s50, 0
    buffer_load_dwordx4 v113, s[72:75], s50 offen  lds
    s_add_u32 m0, s85, 2048
    s_mov_b32 s50, 2048
    buffer_load_dwordx4 v113, s[72:75], s50 offen  lds
    s_add_u32 m0, s85, 4096
    s_mov_b32 s50, 4096
    buffer_load_dwordx4 v113, s[72:75], s50 offen  lds
    s_add_u32 m0, s85, 6144
    s_mov_b32 s50, 6144
    buffer_load_dwordx4 v113, s[72:75], s50 offen  lds
    s_add_u32 m0, s85, 8192
    s_mov_b32 s50, 8192
    buffer_load_dwordx4 v113, s[72:75], s50 offen  lds
    s_add_u32 m0, s85, 10240
    s_mov_b32 s50, 10240
    buffer_load_dwordx4 v113, s[72:75], s50 offen  lds
    s_add_u32 m0, s85, 12288
    s_mov_b32 s50, 12288
    buffer_load_dwordx4 v113, s[72:75], s50 offen  lds
    s_add_u32 m0, s85, 14336
    s_mov_b32 s50, 14336
    buffer_load_dwordx4 v113, s[72:75], s50 offen  lds
    s_add_u32 m0, s85, 32768
    s_mov_b32 s50, 32768
    buffer_load_dwordx4 v113, s[72:75], s50 offen  lds
    s_add_u32 m0, s85, 34816
    s_mov_b32 s50, 34816
    buffer_load_dwordx4 v113, s[72:75], s50 offen  lds
    s_add_u32 m0, s85, 36864
    s_mov_b32 s50, 36864
    buffer_load_dwordx4 v113, s[72:75], s50 offen  lds
    s_add_u32 m0, s85, 38912
    s_mov_b32 s50, 38912
    buffer_load_dwordx4 v113, s[72:75], s50 offen  lds
    s_add_u32 m0, s85, 40960
    s_mov_b32 s50, 40960
    buffer_load_dwordx4 v113, s[72:75], s50 offen  lds
    s_add_u32 m0, s85, 43008
    s_mov_b32 s50, 43008
    buffer_load_dwordx4 v113, s[72:75], s50 offen  lds
    s_add_u32 m0, s85, 45056
    s_mov_b32 s50, 45056
    buffer_load_dwordx4 v113, s[72:75], s50 offen  lds
    s_add_u32 m0, s85, 47104
    s_mov_b32 s50, 47104
    buffer_load_dwordx4 v113, s[72:75], s50 offen  lds
    s_waitcnt vmcnt(16)
    s_barrier
    ds_read_b64_tr_b16 v[136:137], v109 offset:0
    ds_read_b64_tr_b16 v[138:139], v109 offset:512
    ds_read_b64_tr_b16 v[140:141], v109 offset:8192
    ds_read_b64_tr_b16 v[142:143], v109 offset:8704
    ds_read_b64_tr_b16 v[200:201], v110 offset:0
    ds_read_b64_tr_b16 v[202:203], v110 offset:512
    ds_read_b64_tr_b16 v[204:205], v110 offset:8192
    ds_read_b64_tr_b16 v[206:207], v110 offset:8704
    v_xor_b32 v109, 0x4000, v109
    v_xor_b32 v110, 0x4000, v110
    ds_read_b64_tr_b16 v[168:169], v109 offset:0
    ds_read_b64_tr_b16 v[170:171], v109 offset:512
    ds_read_b64_tr_b16 v[172:173], v109 offset:8192
    ds_read_b64_tr_b16 v[174:175], v109 offset:8704
    ds_read_b64_tr_b16 v[232:233], v110 offset:0
    ds_read_b64_tr_b16 v[234:235], v110 offset:512
    ds_read_b64_tr_b16 v[236:237], v110 offset:8192
    ds_read_b64_tr_b16 v[238:239], v110 offset:8704
    v_xor_b32 v109, 0xc000, v109
    v_xor_b32 v110, 0xc000, v110
    ds_read_b64_tr_b16 v[176:177], v109 offset:0
    ds_read_b64_tr_b16 v[178:179], v109 offset:512
    ds_read_b64_tr_b16 v[180:181], v109 offset:8192
    ds_read_b64_tr_b16 v[182:183], v109 offset:8704
    ds_read_b64_tr_b16 v[240:241], v110 offset:0
    ds_read_b64_tr_b16 v[242:243], v110 offset:512
    ds_read_b64_tr_b16 v[244:245], v110 offset:8192
    ds_read_b64_tr_b16 v[246:247], v110 offset:8704
    v_xor_b32 v109, 0x4000, v109
    v_xor_b32 v110, 0x4000, v110
    ds_read_b64_tr_b16 v[184:185], v109 offset:0
    ds_read_b64_tr_b16 v[186:187], v109 offset:512
    ds_read_b64_tr_b16 v[188:189], v109 offset:8192
    ds_read_b64_tr_b16 v[190:191], v109 offset:8704
    ds_read_b64_tr_b16 v[248:249], v110 offset:0
    ds_read_b64_tr_b16 v[250:251], v110 offset:512
    ds_read_b64_tr_b16 v[252:253], v110 offset:8192
    ds_read_b64_tr_b16 v[254:255], v110 offset:8704
    v_xor_b32 v109, 0x1c000, v109
    v_xor_b32 v110, 0x1c000, v110
    s_waitcnt lgkmcnt(0)
    s_barrier
    s_add_u32 m0, s85, 65536
    s_mov_b32 s50, 65536
    buffer_load_dwordx4 v113, s[72:75], s50 offen  lds
    s_add_u32 m0, s85, 67584
    s_mov_b32 s50, 67584
    buffer_load_dwordx4 v113, s[72:75], s50 offen  lds
    s_add_u32 m0, s85, 69632
    s_mov_b32 s50, 69632
    buffer_load_dwordx4 v113, s[72:75], s50 offen  lds
    s_add_u32 m0, s85, 71680
    s_mov_b32 s50, 71680
    buffer_load_dwordx4 v113, s[72:75], s50 offen  lds
    s_add_u32 m0, s85, 73728
    s_mov_b32 s50, 73728
    buffer_load_dwordx4 v113, s[72:75], s50 offen  lds
    s_add_u32 m0, s85, 75776
    s_mov_b32 s50, 75776
    buffer_load_dwordx4 v113, s[72:75], s50 offen  lds
    s_add_u32 m0, s85, 77824
    s_mov_b32 s50, 77824
    buffer_load_dwordx4 v113, s[72:75], s50 offen  lds
    s_add_u32 m0, s85, 79872
    s_mov_b32 s50, 79872
    buffer_load_dwordx4 v113, s[72:75], s50 offen  lds
    s_add_u32 m0, s85, 98304
    s_mov_b32 s50, 98304
    buffer_load_dwordx4 v113, s[72:75], s50 offen  lds
    s_add_u32 m0, s85, 100352
    s_mov_b32 s50, 100352
    buffer_load_dwordx4 v113, s[72:75], s50 offen  lds
    s_add_u32 m0, s85, 102400
    s_mov_b32 s50, 102400
    buffer_load_dwordx4 v113, s[72:75], s50 offen  lds
    s_add_u32 m0, s85, 104448
    s_mov_b32 s50, 104448
    buffer_load_dwordx4 v113, s[72:75], s50 offen  lds
    s_add_u32 m0, s85, 106496
    s_mov_b32 s50, 106496
    buffer_load_dwordx4 v113, s[72:75], s50 offen  lds
    s_add_u32 m0, s85, 108544
    s_mov_b32 s50, 108544
    buffer_load_dwordx4 v113, s[72:75], s50 offen  lds
    s_add_u32 m0, s85, 110592
    s_mov_b32 s50, 110592
    buffer_load_dwordx4 v113, s[72:75], s50 offen  lds
    s_add_u32 m0, s85, 112640
    s_mov_b32 s50, 112640
    buffer_load_dwordx4 v113, s[72:75], s50 offen  lds
    s_waitcnt vmcnt(16)
    s_barrier
    ds_read_b64_tr_b16 a[0:1], v114 offset:0
    ds_read_b64_tr_b16 a[2:3], v114 offset:2048
    ds_read_b64_tr_b16 a[4:5], v114 offset:8192
    ds_read_b64_tr_b16 a[6:7], v114 offset:10240
    ds_read_b64_tr_b16 a[64:65], v114 offset:32768
    ds_read_b64_tr_b16 a[66:67], v114 offset:34816
    ds_read_b64_tr_b16 a[68:69], v114 offset:40960
    ds_read_b64_tr_b16 a[70:71], v114 offset:43008
    ds_read_b64_tr_b16 a[128:129], v114 offset:256
    ds_read_b64_tr_b16 a[130:131], v114 offset:2304
    ds_read_b64_tr_b16 a[132:133], v114 offset:8448
    ds_read_b64_tr_b16 a[134:135], v114 offset:10496
    ds_read_b64_tr_b16 a[192:193], v114 offset:33024
    ds_read_b64_tr_b16 a[194:195], v114 offset:35072
    ds_read_b64_tr_b16 a[196:197], v114 offset:41216
    ds_read_b64_tr_b16 a[198:199], v114 offset:43264
    ds_read_b64_tr_b16 v[128:129], v114 offset:512
    ds_read_b64_tr_b16 v[130:131], v114 offset:2560
    ds_read_b64_tr_b16 v[132:133], v114 offset:8704
    ds_read_b64_tr_b16 v[134:135], v114 offset:10752
    ds_read_b64_tr_b16 v[192:193], v114 offset:33280
    ds_read_b64_tr_b16 v[194:195], v114 offset:35328
    ds_read_b64_tr_b16 v[196:197], v114 offset:41472
    ds_read_b64_tr_b16 v[198:199], v114 offset:43520
    ds_read_b64_tr_b16 v[100:101], v114 offset:768
    ds_read_b64_tr_b16 v[102:103], v114 offset:2816
    ds_read_b64_tr_b16 v[104:105], v114 offset:8960
    ds_read_b64_tr_b16 v[106:107], v114 offset:11008
    ds_read_b64_tr_b16 v[72:73], v114 offset:33536
    ds_read_b64_tr_b16 v[74:75], v114 offset:35584
    ds_read_b64_tr_b16 v[116:117], v114 offset:41728
    ds_read_b64_tr_b16 v[118:119], v114 offset:43776
    v_xor_b32 v114, 0x10000, v114
    s_waitcnt lgkmcnt(0)
    s_barrier
    ds_write_b128 v12, a[0:3] offset:0
    ds_write_b128 v12, a[4:7] offset:1024
    ds_write_b128 v12, a[64:67] offset:2048
    ds_write_b128 v12, a[68:71] offset:3072
    ds_write_b128 v12, a[128:131] offset:4096
    ds_write_b128 v12, a[132:135] offset:5120
    ds_write_b128 v12, a[192:195] offset:6144
    ds_write_b128 v12, a[196:199] offset:7168
    ds_write_b128 v12, v[128:131] offset:8192
    ds_write_b128 v12, v[132:135] offset:9216
    ds_write_b128 v12, v[192:195] offset:10240
    ds_write_b128 v12, v[196:199] offset:11264
    ds_write_b128 v12, v[100:103] offset:12288
    ds_write_b128 v12, v[104:107] offset:13312
    ds_write_b128 v12, v[72:75] offset:14336
    ds_write_b128 v12, v[116:119] offset:15360
    s_waitcnt lgkmcnt(0)
    buffer_load_dwordx2 v[54:55], off, s[52:55], s29 sc1
    s_waitcnt vmcnt(9)
    s_barrier
    ds_read_b64_tr_b16 a[0:1], v114 offset:0
    ds_read_b64_tr_b16 a[2:3], v114 offset:2048
    ds_read_b64_tr_b16 a[4:5], v114 offset:8192
    ds_read_b64_tr_b16 a[6:7], v114 offset:10240
    ds_read_b64_tr_b16 a[128:129], v114 offset:256
    ds_read_b64_tr_b16 a[130:131], v114 offset:2304
    ds_read_b64_tr_b16 a[132:133], v114 offset:8448
    ds_read_b64_tr_b16 a[134:135], v114 offset:10496
    ds_read_b64_tr_b16 v[128:129], v114 offset:512
    ds_read_b64_tr_b16 v[130:131], v114 offset:2560
    ds_read_b64_tr_b16 v[132:133], v114 offset:8704
    ds_read_b64_tr_b16 v[134:135], v114 offset:10752
    ds_read_b64_tr_b16 v[100:101], v114 offset:768
    ds_read_b64_tr_b16 v[102:103], v114 offset:2816
    ds_read_b64_tr_b16 v[104:105], v114 offset:8960
    ds_read_b64_tr_b16 v[106:107], v114 offset:11008
    s_waitcnt lgkmcnt(0)
    s_barrier
    ds_write_b128 v13, v[24:27] offset:0
    ds_write_b128 v13, v[28:31] offset:1024
    ds_write_b128 v13, v[32:35] offset:2048
    ds_write_b128 v13, v[36:39] offset:3072
    ds_write_b128 v13, v[40:43] offset:4096
    ds_write_b128 v13, v[44:47] offset:5120
    ds_write_b128 v13, v[76:79] offset:6144
    ds_write_b128 v13, v[80:83] offset:7168
    s_waitcnt vmcnt(0)
    s_barrier
    v_min_i32 v54, v54, v55
    s_nop 0
    v_readfirstlane_b32 s14, v54
    s_nop 0
    s_cmp_ge_i32 s14, 1
    s_cselect_b32 s91, s7, 0
    s_cmp_eq_u32 s91, 1
    s_cselect_b32 s51, s27, 0x40000000
    s_mov_b32 m0, s31
    s_nop 0
    buffer_load_dwordx4 v1, s[52:55], s51 offen sc1 lds
    buffer_load_dwordx4 v1, s[52:55], s51 offen offset:1024 sc1 lds
    s_add_u32 s50, s51, 8192
    buffer_load_dwordx4 v[56:59], v1, s[52:55], s50 offen sc1
    buffer_load_dwordx4 v[60:63], v1, s[52:55], s50 offen offset:1024 sc1
    ds_read_b64_tr_b16 a[64:65], v114 offset:32768
    ds_read_b64_tr_b16 a[66:67], v114 offset:34816
    ds_read_b64_tr_b16 a[68:69], v114 offset:40960
    ds_read_b64_tr_b16 a[70:71], v114 offset:43008
    ds_read_b64_tr_b16 a[192:193], v114 offset:33024
    ds_read_b64_tr_b16 a[194:195], v114 offset:35072
    ds_read_b64_tr_b16 a[196:197], v114 offset:41216
    ds_read_b64_tr_b16 a[198:199], v114 offset:43264
    ds_read_b64_tr_b16 v[192:193], v114 offset:33280
    ds_read_b64_tr_b16 v[194:195], v114 offset:35328
    ds_read_b64_tr_b16 v[196:197], v114 offset:41472
    ds_read_b64_tr_b16 v[198:199], v114 offset:43520
    ds_read_b64_tr_b16 v[72:73], v114 offset:33536
    ds_read_b64_tr_b16 v[74:75], v114 offset:35584
    ds_read_b64_tr_b16 v[116:117], v114 offset:41728
    ds_read_b64_tr_b16 v[118:119], v114 offset:43776
    v_xor_b32 v114, 0x10000, v114
    s_waitcnt lgkmcnt(0)
    s_barrier
    ds_write_b128 v13, v[84:87] offset:32768
    ds_write_b128 v13, v[88:91] offset:33792
    ds_write_b128 v13, v[92:95] offset:34816
    ds_write_b128 v13, v[96:99] offset:35840
    ds_write_b128 v13, v[100:103] offset:36864
    ds_write_b128 v13, v[104:107] offset:37888
    ds_write_b128 v13, v[72:75] offset:38912
    ds_write_b128 v13, v[116:119] offset:39936
    s_cmp_eq_u32 s7, 1
    s_cbranch_scc1 L_vdone_1
    s_mov_b32 s13, 0
    v_and_b32 v50, 7, v0
    v_lshlrev_b32 v50, 3, v50
L_vloop_2:
    buffer_load_dwordx2 v[48:49], v50, s[56:59], 0 offen offset:128 sc1
    s_waitcnt vmcnt(0)
    v_cmp_eq_u32 vcc, -1, v48
    v_mov_b32 v51, 0x2000
    v_cmp_eq_u32 s[14:15], v51, v49
    s_nop 0
    s_and_b64 vcc, vcc, s[14:15]
    s_cmp_eq_u64 vcc, -1
    s_cbranch_scc1 L_vdone_1
    v_lshrrev_b32 v49, 8, v49
    s_mov_b32 s50, 0
    v_readlane_b32 s51, v49, 0
    s_nop 0
    s_add_u32 s50, s50, s51
    v_readlane_b32 s51, v49, 1
    s_nop 0
    s_add_u32 s50, s50, s51
    v_readlane_b32 s51, v49, 2
    s_nop 0
    s_add_u32 s50, s50, s51
    v_readlane_b32 s51, v49, 3
    s_nop 0
    s_add_u32 s50, s50, s51
    v_readlane_b32 s51, v49, 4
    s_nop 0
    s_add_u32 s50, s50, s51
    v_readlane_b32 s51, v49, 5
    s_nop 0
    s_add_u32 s50, s50, s51
    v_readlane_b32 s51, v49, 6
    s_nop 0
    s_add_u32 s50, s50, s51
    v_readlane_b32 s51, v49, 7
    s_nop 0
    s_add_u32 s50, s50, s51
    s_cmp_ge_u32 s50, 256
    s_cbranch_scc1 L_vfb_3
    s_add_u32 s13, s13, 1
    s_cmp_lt_u32 s13, 1048576
    s_cbranch_scc1 L_vloop_2
    s_branch L_end
L_vfb_3:
    v_mov_b32 v52, 163328
    v_lshrrev_b32 v53, 8, v127
    s_cmp_eq_u32 s3, 0
    s_cselect_b64 exec, 1, 0
    ds_write_b32 v52, v53
    s_mov_b64 exec, -1
    s_waitcnt lgkmcnt(0)
    s_barrier
    ds_read_b32 v53, v52
    v_cmp_eq_u32 vcc, 32, v49
    s_waitcnt lgkmcnt(0)
    v_readfirstlane_b32 s14, v53
    s_barrier
    s_lshr_b32 s15, s2, 5
    s_and_b32 s50, s2, 31
    s_and_b32 s14, s14, 31
    s_cmp_eq_u64 vcc, -1
    s_cselect_b32 s4, s12, s15
    s_cselect_b32 s5, s14, s50
    s_cselect_b32 s6, 0, 1
    s_mov_b32 s7, 1
    s_branch L_reload
L_vdone_1:
    s_cmp_eq_u32 s91, 1
    s_cbranch_scc1 L_ckv0_4_go
    s_mov_b32 s13, 0
L_ckv0_4:
    buffer_load_dwordx2 v[54:55], off, s[52:55], s29 sc1
    s_waitcnt vmcnt(0)
    v_min_i32 v54, v54, v55
    s_nop 0
    v_readfirstlane_b32 s14, v54
    s_nop 0
    s_cmp_ge_i32 s14, 1
    s_cbranch_scc1 L_ckv0_4_ok
    s_add_u32 s13, s13, 1
    s_cmp_lt_u32 s13, 1048576
    s_cbranch_scc1 L_ckv0_4
    s_branch L_end
L_ckv0_4_ok:
    s_mov_b32 m0, s31
    s_nop 0
    buffer_load_dwordx4 v1, s[52:55], s27 offen sc1 lds
    buffer_load_dwordx4 v1, s[52:55], s27 offen offset:1024 sc1 lds
    s_add_u32 s50, s27, 8192
    buffer_load_dwordx4 v[56:59], v1, s[52:55], s50 offen sc1
    buffer_load_dwordx4 v[60:63], v1, s[52:55], s50 offen offset:1024 sc1
    s_waitcnt vmcnt(0)
L_ckv0_4_go:
    s_xor_b32 s31, s31, 0x6000
    s_mov_b32 m0, s31
    s_mov_b32 s13, 0
    s_mov_b32 s25, s23
    s_add_u32 s26, s23, 24576
    s_add_u32 s14, s21, 530432
    s_add_u32 s15, s21, 518144
    s_cmp_eq_u32 s3, 1
    s_cselect_b32 s85, s14, s15
    s_cmp_eq_u32 s3, 0
    s_cselect_b32 s85, s29, s85
    s_cmp_eq_u32 s3, 2
    s_cselect_b32 s14, 28, 7
    v_min_u32 v126, 4, v0
    s_cselect_b64 vcc, -1, 0
    v_cndmask_b32 v0, v0, v126, vcc
    v_lshlrev_b32 v0, s14, v0
    v_mov_b32 v126, -1
    s_add_u32 s20, s20, 524288
    s_waitcnt vmcnt(0)
    v_mov_b64 v[108:109], v[56:57]
    v_mov_b64 v[110:111], v[58:59]
    v_mov_b64 v[112:113], v[60:61]
    v_mov_b64 v[114:115], v[62:63]
    v_mov_b64 v[48:49], 0
    v_mov_b64 v[50:51], 0
    v_mov_b64 v[52:53], 0
    v_mov_b64 v[54:55], 0
    v_mov_b64 v[56:57], 0
    v_mov_b64 v[58:59], 0
    v_mov_b64 v[60:61], 0
    v_mov_b64 v[62:63], 0
    v_lshlrev_b32 v120, 1, v1
    v_lshlrev_b32 v124, 3, v1
    s_lshl_b32 s51, s34, 2
    s_add_u32 s50, s23, s51
    s_waitcnt vmcnt(0) lgkmcnt(0)
    buffer_load_dword v122, v120, s[52:55], s22 offen sc1
    buffer_load_dword v122, v124, s[52:55], s50 offen sc1
    s_lshl_b32 s14, s6, 2
    s_add_u32 s14, s14, s3
    s_cmp_eq_u32 s14, 0
    s_cbranch_scc1 L_h2a_f0_go
    s_cmp_eq_u32 s14, 1
    s_cbranch_scc1 L_h2a_f1_go
    s_cmp_eq_u32 s14, 2
    s_cbranch_scc1 L_h2a_f2_go
    s_cmp_eq_u32 s14, 3
    s_cbranch_scc1 L_h2a_f3_go
    s_cmp_eq_u32 s14, 4
    s_cbranch_scc1 L_h2a_s0_go
    s_cmp_eq_u32 s14, 5
    s_cbranch_scc1 L_h2a_s1_go
    s_cmp_eq_u32 s14, 6
    s_cbranch_scc1 L_h2a_s2_go
    s_cmp_eq_u32 s14, 7
    s_cbranch_scc1 L_h2a_s3_go
    s_branch L_end
L_h2b_f0_fail:
    buffer_load_dwordx4 v[20:23], v1, s[52:55], s25 offen offset:0 sc1
    s_add_u32 s13, s13, 1
    s_nop 4
    v_mov_b64 v[48:49], 0
    v_mov_b64 v[50:51], 0
    v_mov_b64 v[52:53], 0
    v_mov_b64 v[54:55], 0
    s_cmp_lt_u32 s13, 1048576
    s_cbranch_scc1 L_h2a_f0
    s_branch L_end
.p2align 6
    s_nop 0
    s_nop 0
    s_nop 0
L_h2b_f0:
    buffer_load_dwordx4 v[16:19], v1, s[52:55], s25 offen offset:0 sc1
    s_nop 5
    v_mov_b64 v[48:49], 0
    v_mov_b64 v[50:51], 0
    v_mov_b64 v[52:53], 0
    v_mov_b64 v[54:55], 0
    s_waitcnt vmcnt(1)
L_h2b_f0_go:
    v_max3_u32 v127, v20, v21, v22
    v_max_u32 v127, v127, v23
    v_cmp_eq_u32 vcc, -1, v127
    v_smfmac_f32_16x16x64_bf16 v[48:51], v[20:23], v[24:31], v2
    ds_write_b128 v14, v[20:23] offset:0
    v_smfmac_f32_16x16x64_bf16 v[52:55], v[20:23], v[32:39], v2
    s_cbranch_vccnz L_h2b_f0_fail
    v_smfmac_f32_16x16x64_bf16 v[56:59], v[20:23], v[40:47], v2
    buffer_load_dwordx4 v[104:107], v1, s[52:55], s92 offen offset:0 sc1
    s_waitcnt lgkmcnt(0)
    s_barrier
    ds_read_b128 v[24:27], v14 offset:1024
    v_smfmac_f32_16x16x64_bf16 v[60:63], v[20:23], v[76:83], v2
    ds_read_b128 v[28:31], v14 offset:2048
    v_smfmac_f32_16x16x64_bf16 v[64:67], v[20:23], v[84:91], v2
    ds_read_b128 v[32:35], v14 offset:3072
    v_smfmac_f32_16x16x64_bf16 v[68:71], v[20:23], v[92:99], v2
    s_branch L_cbody_f0
.p2align 6
    s_nop 0
    s_nop 0
    s_nop 0
L_h2a_f0:
    s_waitcnt vmcnt(1)
L_h2a_f0_go:
    v_max3_u32 v127, v16, v17, v18
    v_max_u32 v127, v127, v19
    v_cmp_eq_u32 vcc, -1, v127
    v_smfmac_f32_16x16x64_bf16 v[48:51], v[16:19], v[24:31], v2
    ds_write_b128 v14, v[16:19] offset:0
    v_smfmac_f32_16x16x64_bf16 v[52:55], v[16:19], v[32:39], v2
    s_cbranch_vccnz L_h2b_f0
    v_smfmac_f32_16x16x64_bf16 v[56:59], v[16:19], v[40:47], v2
    buffer_load_dwordx4 v[104:107], v1, s[52:55], s92 offen offset:0 sc1
    s_waitcnt lgkmcnt(0)
    s_barrier
    ds_read_b128 v[24:27], v14 offset:1024
    v_smfmac_f32_16x16x64_bf16 v[60:63], v[16:19], v[76:83], v2
    ds_read_b128 v[28:31], v14 offset:2048
    v_smfmac_f32_16x16x64_bf16 v[64:67], v[16:19], v[84:91], v2
    ds_read_b128 v[32:35], v14 offset:3072
    v_smfmac_f32_16x16x64_bf16 v[68:71], v[16:19], v[92:99], v2
L_cbody_f0:
    s_waitcnt lgkmcnt(2)
    v_smfmac_f32_16x16x64_bf16 v[48:51], v[24:27], a[16:23], v2
    buffer_load_dwordx4 v1, s[52:55], s21 offen sc1 lds
    v_smfmac_f32_16x16x64_bf16 v[52:55], v[24:27], a[80:87], v2
    buffer_load_dword v126, off, s[52:55], s85 sc1
    v_smfmac_f32_16x16x64_bf16 v[56:59], v[24:27], a[144:151], v2
    buffer_load_dwordx4 v[16:19], v1, s[52:55], s20 offen sc1
    s_waitcnt lgkmcnt(0)
    v_smfmac_f32_16x16x64_bf16 v[60:63], v[24:27], a[208:215], v2
    v_smfmac_f32_16x16x64_bf16 v[48:51], v[28:31], a[24:31], v2
    buffer_load_dwordx4 v1, s[52:55], s21 offen offset:1024 sc1 lds
    v_smfmac_f32_16x16x64_bf16 v[52:55], v[28:31], a[88:95], v2
    v_smfmac_f32_16x16x64_bf16 v[56:59], v[28:31], a[152:159], v2
    buffer_load_dwordx4 v[20:23], v1, s[52:55], s20 offen offset:1024 sc1
    v_smfmac_f32_16x16x64_bf16 v[60:63], v[28:31], a[216:223], v2
    s_waitcnt vmcnt(5)
    v_max3_u32 v127, v104, v105, v106
    v_max_u32 v127, v127, v107
    v_cmp_eq_u32 vcc, -1, v127
    v_smfmac_f32_16x16x64_bf16 v[48:51], v[32:35], a[32:39], v2
    ds_write_b128 v14, v[104:107] offset:4096
    v_smfmac_f32_16x16x64_bf16 v[52:55], v[32:35], a[96:103], v2
    s_cbranch_vccnz L_lf_f0
L_lr_f0:
    v_smfmac_f32_16x16x64_bf16 v[48:51], v[104:107], a[8:15], v2
    v_smfmac_f32_16x16x64_bf16 v[52:55], v[104:107], a[72:79], v2
    v_smfmac_f32_16x16x64_bf16 v[56:59], v[104:107], a[136:143], v2
    buffer_store_dwordx4 v[72:75], v10, s[52:55], s24 offen sc1
    s_waitcnt lgkmcnt(0)
    s_barrier
    ds_read_b128 v[36:39], v14 offset:5120
    v_smfmac_f32_16x16x64_bf16 v[60:63], v[104:107], a[200:207], v2
    ds_read_b128 v[40:43], v14 offset:6144
    v_smfmac_f32_16x16x64_bf16 v[64:67], v[104:107], v[136:143], v2
    ds_read_b128 v[44:47], v14 offset:7168
    v_smfmac_f32_16x16x64_bf16 v[68:71], v[104:107], v[200:207], v2
    v_smfmac_f32_16x16x64_bf16 v[56:59], v[32:35], a[160:167], v2
    buffer_store_dword v122, v11, s[52:55], s24 offen sc1
    v_smfmac_f32_16x16x64_bf16 v[60:63], v[32:35], a[224:231], v2
    s_waitcnt lgkmcnt(0)
    v_smfmac_f32_16x16x64_bf16 v[48:51], v[36:39], a[40:47], v2
    v_smfmac_f32_16x16x64_bf16 v[52:55], v[36:39], a[104:111], v2
    ds_read_b128 v[92:95], v15 offset:0
    v_smfmac_f32_16x16x64_bf16 v[48:51], v[40:43], a[48:55], v2
    buffer_store_dword v124, v11, s[52:55], s24 offen offset:256 sc1
    ds_read_b128 v[96:99], v15 offset:1024
    v_smfmac_f32_16x16x64_bf16 v[52:55], v[40:43], a[112:119], v2
    ds_read_b128 v[100:103], v15 offset:2048
    v_smfmac_f32_16x16x64_bf16 v[48:51], v[44:47], a[56:63], v2
    ds_read_b128 v[104:107], v15 offset:3072
    v_smfmac_f32_16x16x64_bf16 v[52:55], v[44:47], a[120:127], v2
    v_smfmac_f32_16x16x64_bf16 v[56:59], v[36:39], a[168:175], v2
    v_add_f32 v48, v48, v50
    v_smfmac_f32_16x16x64_bf16 v[60:63], v[36:39], a[232:239], v2
    v_add_f32 v49, v49, v51
    v_smfmac_f32_16x16x64_bf16 v[56:59], v[40:43], a[176:183], v2
    v_add_f32 v52, v52, v54
    v_smfmac_f32_16x16x64_bf16 v[60:63], v[40:43], a[240:247], v2
    v_add_f32 v53, v53, v55
    v_smfmac_f32_16x16x64_bf16 v[56:59], v[44:47], a[184:191], v2
    v_cvt_pk_bf16_f32 v118, v48, v52
    v_smfmac_f32_16x16x64_bf16 v[60:63], v[44:47], a[248:255], v2
    v_cvt_pk_bf16_f32 v119, v49, v53
    v_smfmac_f32_16x16x64_bf16 v[64:67], v[24:27], v[144:151], v2
    ds_write2_b32 v6, v118, v119 offset0:0 offset1:136
    v_add_f32 v56, v56, v58
    v_add_f32 v57, v57, v59
    v_smfmac_f32_16x16x64_bf16 v[68:71], v[24:27], v[208:215], v2
    v_add_f32 v60, v60, v62
    v_add_f32 v61, v61, v63
    v_cvt_pk_bf16_f32 v116, v56, v60
    v_cvt_pk_bf16_f32 v117, v57, v61
    v_smfmac_f32_16x16x64_bf16 v[64:67], v[28:31], v[152:159], v2
    ds_write2_b32 v6, v116, v117 offset0:64 offset1:200
    v_smfmac_f32_16x16x64_bf16 v[68:71], v[28:31], v[216:223], v2
    buffer_store_dword v5, v4, s[52:55], s26 offen
    v_smfmac_f32_16x16x64_bf16 v[64:67], v[32:35], v[160:167], v2
    v_smfmac_f32_16x16x64_bf16 v[68:71], v[32:35], v[224:231], v2
    s_cmp_eq_u32 s16, 63
    v_smfmac_f32_16x16x64_bf16 v[64:67], v[36:39], v[168:175], v2
    s_waitcnt lgkmcnt(0)
    s_barrier
    ds_read_b128 v[76:79], v8 offset:0
    v_smfmac_f32_16x16x64_bf16 v[68:71], v[36:39], v[232:239], v2
    ds_read_b128 v[80:83], v8 offset:64
    v_smfmac_f32_16x16x64_bf16 v[64:67], v[40:43], v[176:183], v2
    ds_read_b128 v[84:87], v8 offset:128
    v_smfmac_f32_16x16x64_bf16 v[68:71], v[40:43], v[240:247], v2
    ds_read_b128 v[88:91], v8 offset:192
    v_smfmac_f32_16x16x64_bf16 v[64:67], v[44:47], v[184:191], v2
    ds_read_b128 v[24:27], v8 offset:256
    v_smfmac_f32_16x16x64_bf16 v[68:71], v[44:47], v[248:255], v2
    s_cbranch_scc1 L_clast
    ds_read_b128 v[28:31], v8 offset:320
    s_waitcnt lgkmcnt(4)
    v_mfma_f32_16x16x32_bf16 v[48:51], v[92:95], v[76:79], 0
    ds_read_b128 v[56:59], v8 offset:384
    v_mfma_f32_16x16x32_bf16 v[48:51], v[96:99], v[80:83], v[48:51]
    ds_read_b128 v[60:63], v8 offset:448
    s_waitcnt lgkmcnt(4)
    v_mfma_f32_16x16x32_bf16 v[48:51], v[100:103], v[84:87], v[48:51]
    ds_read_b128 v[92:95], v15 offset:4096
    v_add_f32 v64, v64, v66
    v_mfma_f32_16x16x32_bf16 v[48:51], v[104:107], v[88:91], v[48:51]
    ds_read_b128 v[96:99], v15 offset:5120
    s_waitcnt lgkmcnt(4)
    v_mfma_f32_16x16x32_bf16 v[72:75], v[24:27], v[76:79], 0
    ds_read_b128 v[100:103], v15 offset:6144
    v_add_f32 v65, v65, v67
    v_mfma_f32_16x16x32_bf16 v[72:75], v[28:31], v[80:83], v[72:75]
    ds_read_b128 v[104:107], v15 offset:7168
    s_waitcnt lgkmcnt(4)
    v_mfma_f32_16x16x32_bf16 v[72:75], v[56:59], v[84:87], v[72:75]
    v_add_f32 v68, v68, v70
    v_add_f32 v69, v69, v71
    v_mfma_f32_16x16x32_bf16 v[72:75], v[60:63], v[88:91], v[72:75]
    s_waitcnt lgkmcnt(2)
    v_cvt_pk_bf16_f32 v122, v64, v65
    v_mfma_f32_16x16x32_bf16 v[52:55], v[92:95], v[76:79], 0
    v_cvt_pk_bf16_f32 v124, v68, v69
    v_max3_f32 v118, v48, v49, v50
    v_mfma_f32_16x16x32_bf16 v[52:55], v[96:99], v[80:83], v[52:55]
    s_waitcnt lgkmcnt(0)
    v_mov_b32 v64, 0x3f803f80
    v_mfma_f32_16x16x32_bf16 v[52:55], v[100:103], v[84:87], v[52:55]
    ds_read_b128 v[24:27], v12 offset:0
    v_max3_f32 v118, v118, v51, v72
    v_mfma_f32_16x16x32_bf16 v[52:55], v[104:107], v[88:91], v[52:55]
    ds_read_b128 v[28:31], v12 offset:1024
    ds_read_b128 v[32:35], v12 offset:4096
    v_mov_b32 v65, v64
    v_max_f32 v118, v118, v73
    v_mov_b64 v[66:67], v[64:65]
    v_mov_b64 v[68:69], 0
    v_mov_b64 v[70:71], 0
    s_nop 0
    v_max3_f32 v118, v118, v52, v53
    v_max3_f32 v74, v118, v54, v55
    v_mov_b32 v75, v74
    s_nop 1
    v_permlane16_swap_b32 v74, v75
    v_max_f32 v74, v74, v75
    v_mov_b32 v75, v74
    s_nop 1
    v_permlane32_swap_b32 v74, v75
    v_max_f32 v74, v74, v75
    v_mul_f32 v74, s32, v74
    v_pk_fma_f32 v[48:49], v[48:49], s[32:33], v[74:75] op_sel_hi:[1,1,0] neg_lo:[0,0,1] neg_hi:[0,0,1]
    v_pk_fma_f32 v[50:51], v[50:51], s[32:33], v[74:75] op_sel_hi:[1,1,0] neg_lo:[0,0,1] neg_hi:[0,0,1]
    v_pk_fma_f32 v[52:53], v[52:53], s[32:33], v[74:75] op_sel_hi:[1,1,0] neg_lo:[0,0,1] neg_hi:[0,0,1]
    v_pk_fma_f32 v[54:55], v[54:55], s[32:33], v[74:75] op_sel_hi:[1,1,0] neg_lo:[0,0,1] neg_hi:[0,0,1]
    v_pk_fma_f32 v[72:73], v[72:73], s[32:33], v[74:75] op_sel_hi:[1,1,0] neg_lo:[0,0,1] neg_hi:[0,0,1]
    v_exp_f32 v72, v72
    v_exp_f32 v73, v73
    v_exp_f32 v48, v48
    v_cvt_pk_bf16_f32 v120, v72, v73
    v_exp_f32 v49, v49
    v_exp_f32 v50, v50
    v_mfma_f32_16x16x16_bf16 v[72:75], v[64:65], v[120:121], 0
    ds_read_b128 v[36:39], v12 offset:5120
    v_exp_f32 v51, v51
    v_exp_f32 v52, v52
    v_mfma_f32_16x16x16_bf16 v[56:59], v[122:123], v[120:121], 0
    ds_read_b128 v[40:43], v12 offset:8192
    v_exp_f32 v53, v53
    v_exp_f32 v54, v54
    v_mfma_f32_16x16x16_bf16 v[60:63], v[124:125], v[120:121], 0
    ds_read_b128 v[44:47], v12 offset:9216
    v_exp_f32 v55, v55
    v_cvt_pk_bf16_f32 v116, v48, v49
    v_cvt_pk_bf16_f32 v117, v50, v51
    v_cvt_pk_bf16_f32 v118, v52, v53
    v_cvt_pk_bf16_f32 v119, v54, v55
    v_mov_b64 v[48:49], 0
    v_mov_b64 v[50:51], 0
    v_mfma_f32_16x16x32_bf16 v[72:75], v[64:67], v[116:119], v[72:75]
    ds_read_b128 v[76:79], v12 offset:12288
    v_mov_b64 v[52:53], 0
    v_mfma_f32_16x16x32_bf16 v[56:59], v[108:111], v[116:119], v[56:59]
    ds_read_b128 v[80:83], v12 offset:13312
    v_mov_b64 v[54:55], 0
    v_mfma_f32_16x16x32_bf16 v[60:63], v[112:115], v[116:119], v[60:63]
    ds_read_b128 v[84:87], v12 offset:2048
    v_rcp_f32 v120, v72
    v_mov_b64 v[116:117], 0
    s_nop 0
    v_pk_mul_f32 v[56:57], v[56:57], v[120:121] op_sel_hi:[1,0]
    v_pk_mul_f32 v[58:59], v[58:59], v[120:121] op_sel_hi:[1,0]
    v_cvt_pk_bf16_f32 v56, v56, v57
    v_cvt_pk_bf16_f32 v57, v58, v59
    v_pk_mul_f32 v[60:61], v[60:61], v[120:121] op_sel_hi:[1,0]
    v_pk_mul_f32 v[62:63], v[62:63], v[120:121] op_sel_hi:[1,0]
    v_cvt_pk_bf16_f32 v58, v60, v61
    v_cvt_pk_bf16_f32 v59, v62, v63
    v_cndmask_b32 v60, v56, v58, s[48:49]
    v_cndmask_b32 v61, v57, v59, s[48:49]
    ds_write_b64 v7, v[60:61] offset:0
    s_waitcnt lgkmcnt(1)
    v_smfmac_f32_16x16x64_bf16 v[48:51], v[56:59], v[24:31], v2
    ds_read_b128 v[88:91], v12 offset:3072
    v_mov_b64 v[118:119], 0
    v_smfmac_f32_16x16x64_bf16 v[52:55], v[56:59], v[32:39], v2
    ds_read_b128 v[92:95], v12 offset:6144
    v_smfmac_f32_16x16x64_bf16 v[68:71], v[56:59], v[40:47], v2
    ds_read_b128 v[96:99], v12 offset:7168
    s_waitcnt lgkmcnt(3)
    s_barrier
    ds_read_b128 v[60:63], v9 offset:512
    ds_read_b128 v[64:67], v9 offset:1024
    ds_read_b128 v[72:75], v9 offset:1536
    v_smfmac_f32_16x16x64_bf16 v[116:119], v[56:59], v[76:83], v2
    s_cmp_eq_u32 s16, 62
    s_cbranch_scc1 L_c62_f0
L_c62r_f0:
    s_waitcnt lgkmcnt(2)
    v_smfmac_f32_16x16x64_bf16 v[48:51], v[60:63], v[84:91], v2
    ds_read_b128 v[100:103], v12 offset:10240
    s_waitcnt lgkmcnt(2)
    v_smfmac_f32_16x16x64_bf16 v[48:51], v[64:67], a[0:7], v2
    ds_read_b128 v[104:107], v12 offset:11264
    s_waitcnt lgkmcnt(2)
    v_smfmac_f32_16x16x64_bf16 v[48:51], v[72:75], a[64:71], v2
    ds_read_b128 v[108:111], v12 offset:14336
    ds_read_b128 v[112:115], v12 offset:15360
    v_smfmac_f32_16x16x64_bf16 v[52:55], v[60:63], v[92:99], v2
    ds_read_b128 v[24:27], v13 offset:36864
    ds_read_b128 v[28:31], v13 offset:37888
    v_smfmac_f32_16x16x64_bf16 v[52:55], v[64:67], a[128:135], v2
    v_cvt_pk_bf16_f32 v48, v48, v49
    v_cvt_pk_bf16_f32 v49, v50, v51
    v_and_or_b32 v48, v48, -2, s17
    v_smfmac_f32_16x16x64_bf16 v[52:55], v[72:75], a[192:199], v2
    buffer_store_dwordx2 v[48:49], v3, s[52:55], s18 offen offset:0
    s_waitcnt lgkmcnt(4)
    v_smfmac_f32_16x16x64_bf16 v[68:71], v[60:63], v[100:107], v2
    ds_read_b128 v[32:35], v13 offset:38912
    ds_read_b128 v[36:39], v13 offset:39936
    v_smfmac_f32_16x16x64_bf16 v[68:71], v[64:67], v[128:135], v2
    v_cvt_pk_bf16_f32 v52, v52, v53
    v_cvt_pk_bf16_f32 v53, v54, v55
    v_and_or_b32 v52, v52, -2, s17
    v_smfmac_f32_16x16x64_bf16 v[68:71], v[72:75], v[192:199], v2
    buffer_store_dwordx2 v[52:53], v3, s[52:55], s18 offen offset:2048
    s_waitcnt lgkmcnt(2)
    v_smfmac_f32_16x16x64_bf16 v[116:119], v[60:63], v[108:115], v2
    v_smfmac_f32_16x16x64_bf16 v[116:119], v[64:67], v[24:31], v2
    v_cvt_pk_bf16_f32 v68, v68, v69
    v_cvt_pk_bf16_f32 v69, v70, v71
    v_and_or_b32 v68, v68, -2, s17
    s_waitcnt lgkmcnt(0)
    v_smfmac_f32_16x16x64_bf16 v[116:119], v[72:75], v[32:39], v2
    buffer_store_dwordx2 v[68:69], v3, s[52:55], s19 offen offset:0
    s_nop 6
    v_cvt_pk_bf16_f32 v116, v116, v117
    v_cvt_pk_bf16_f32 v117, v118, v119
    v_and_or_b32 v116, v116, -2, s17
    buffer_store_dwordx2 v[116:117], v3, s[52:55], s19 offen offset:2048
    ds_read_b128 v[72:75], v14 offset:31232
    s_waitcnt vmcnt(8)
    v_mov_b64 v[108:109], v[16:17]
    v_mov_b64 v[110:111], v[18:19]
    v_mov_b64 v[112:113], v[20:21]
    v_mov_b64 v[114:115], v[22:23]
    v_mov_b64 v[48:49], 0
    v_mov_b64 v[50:51], 0
    v_mov_b64 v[52:53], 0
    v_mov_b64 v[54:55], 0
    v_mov_b64 v[56:57], 0
    v_mov_b64 v[58:59], 0
    v_mov_b64 v[60:61], 0
    v_mov_b64 v[62:63], 0
    v_mov_b64 v[68:69], 0
    v_mov_b64 v[70:71], 0
    v_mov_b64 v[64:65], 0
    v_mov_b64 v[66:67], 0
    v_xor_b32 v15, 0x6000, v15
    s_add_u32 s16, s16, 1
    s_add_u32 s20, s20, 524288
    s_add_u32 s21, s21, 524288
    s_mov_b32 s24, s28
    s_add_u32 s28, s28, 131072
    s_xor_b32 s31, s31, 0x6000
    s_mov_b32 m0, s31
    s_mov_b32 s13, 0
    s_mov_b32 s26, s25
    s_and_b32 s15, s16, 3
    s_lshl_b32 s15, s15, 13
    s_add_u32 s25, s23, s15
    s_add_u32 s92, s25, 4096
    s_cmp_eq_u32 s16, 63
    s_cselect_b32 s21, 0x40000000, s21
    s_cselect_b32 s20, 0x40000000, s20
    s_add_u32 s35, s16, 3
    s_lshr_b32 s35, s35, 1
    s_min_u32 s35, s35, 32
    s_xor_b32 s85, s85, 4
    ds_read_b128 v[24:27], v13 offset:0
    buffer_load_dwordx4 v[16:19], v1, s[52:55], s22 offen sc1
    buffer_load_dwordx4 v[20:23], v1, s[52:55], s22 offen offset:1024 sc1
    ds_read_b128 v[28:31], v13 offset:1024
    ds_read_b128 v[32:35], v13 offset:2048
    ds_read_b128 v[36:39], v13 offset:3072
    ds_read_b128 v[40:43], v13 offset:4096
    ds_read_b128 v[44:47], v13 offset:5120
    ds_read_b128 v[76:79], v13 offset:6144
    ds_read_b128 v[80:83], v13 offset:7168
    ds_read_b128 v[84:87], v13 offset:32768
    ds_read_b128 v[88:91], v13 offset:33792
    ds_read_b128 v[92:95], v13 offset:34816
    ds_read_b128 v[96:99], v13 offset:35840
    s_nop 6
    buffer_load_dwordx4 v[100:103], v1, s[52:55], s22 offen sc1
    buffer_load_dwordx4 v[104:107], v1, s[52:55], s22 offen offset:1024 sc1
    s_waitcnt lgkmcnt(0)
L_h1_f0a:
    s_waitcnt vmcnt(3)
    v_mfma_f32_16x16x32_bf16 v[116:119], v[72:75], v[16:19], 0
    v_bitop3_b32 v127, v16, v18, s17 bitop3:0x7e
    s_waitcnt vmcnt(2)
    v_mfma_f32_16x16x32_bf16 v[116:119], v[72:75], v[20:23], v[116:119]
    v_bitop3_b32 v120, v20, v22, s17 bitop3:0x7e
    v_bitop3_b32 v127, v127, v120, 1 bitop3:0xa8
    v_cmp_ne_u32 vcc, 0, v127
    s_cbranch_vccnz L_h1_f0b
    v_add_f32_dpp v116, v116, v116 row_ror:4 row_mask:0xf bank_mask:0xf
    v_add_f32_dpp v117, v117, v117 row_ror:4 row_mask:0xf bank_mask:0xf
    s_nop 0
    v_add_f32_dpp v116, v116, v116 row_ror:8 row_mask:0xf bank_mask:0xf
    v_add_f32_dpp v117, v117, v117 row_ror:8 row_mask:0xf bank_mask:0xf
    v_cvt_pk_bf16_f32 v116, v116, v117
    v_min_u32 v116, -2, v116
    buffer_store_dword v116, v4, s[52:55], s25 offen
L_h1_f0_ok:
    s_xor_b32 s17, s17, 1
    v_readfirstlane_b32 s14, v126
    s_nop 0
    s_cmp_ge_i32 s14, s35
    s_cbranch_scc0 L_h1_f0_kv
L_h1_f0_kvok:
    s_mov_b32 s13, 0
    ds_read_b128 v[72:75], v8 offset:256
    s_nop 15
    s_nop 15
    s_nop 0
    buffer_load_dwordx4 v[16:19], v1, s[52:55], s25 offen offset:0 sc1
    s_nop 15
    s_nop 9
    buffer_load_dwordx4 v[20:23], v1, s[52:55], s25 offen offset:0 sc1
    s_waitcnt lgkmcnt(0)
    s_branch L_h2a_f0
L_h1_f0f:
    buffer_load_dwordx4 v[100:103], v1, s[52:55], s22 offen sc1
    buffer_load_dwordx4 v[104:107], v1, s[52:55], s22 offen offset:1024 sc1
    s_add_u32 s13, s13, 1
    s_cmp_lt_u32 s13, 1048576
    s_cbranch_scc1 L_h1_f0a
    s_branch L_end
L_h1_f0b:
    buffer_load_dwordx4 v[16:19], v1, s[52:55], s22 offen sc1
    buffer_load_dwordx4 v[20:23], v1, s[52:55], s22 offen offset:1024 sc1
    s_waitcnt vmcnt(3)
    v_mfma_f32_16x16x32_bf16 v[116:119], v[72:75], v[100:103], 0
    v_bitop3_b32 v127, v100, v102, s17 bitop3:0x7e
    s_waitcnt vmcnt(2)
    v_mfma_f32_16x16x32_bf16 v[116:119], v[72:75], v[104:107], v[116:119]
    v_bitop3_b32 v120, v104, v106, s17 bitop3:0x7e
    v_bitop3_b32 v127, v127, v120, 1 bitop3:0xa8
    v_cmp_ne_u32 vcc, 0, v127
    s_cbranch_vccnz L_h1_f0f
    v_add_f32_dpp v116, v116, v116 row_ror:4 row_mask:0xf bank_mask:0xf
    v_add_f32_dpp v117, v117, v117 row_ror:4 row_mask:0xf bank_mask:0xf
    s_nop 0
    v_add_f32_dpp v116, v116, v116 row_ror:8 row_mask:0xf bank_mask:0xf
    v_add_f32_dpp v117, v117, v117 row_ror:8 row_mask:0xf bank_mask:0xf
    v_cvt_pk_bf16_f32 v116, v116, v117
    v_min_u32 v116, -2, v116
    buffer_store_dword v116, v4, s[52:55], s25 offen
    s_branch L_h1_f0_ok
L_lf_f0:
    s_mov_b32 s13, 0
L_lf1_f0:
    buffer_load_dwordx4 v[104:107], v1, s[52:55], s92 offen offset:0 sc1
    s_waitcnt vmcnt(0)
    v_max3_u32 v127, v104, v105, v106
    v_max_u32 v127, v127, v107
    v_cmp_eq_u32 vcc, -1, v127
    ds_write_b128 v14, v[104:107] offset:4096
    s_cbranch_vccz L_lr_f0
    s_add_u32 s13, s13, 1
    s_cmp_lt_u32 s13, 1048576
    s_cbranch_scc1 L_lf1_f0
    s_branch L_end
L_c62_f0:
    s_mov_b32 s24, s28
    ds_read_b128 v[108:111], v8 offset:256
    buffer_store_dword v122, v11, s[52:55], s24 offen sc1
    buffer_store_dword v124, v11, s[52:55], s24 offen offset:256 sc1
    s_waitcnt lgkmcnt(0)
    buffer_store_dwordx4 v[108:111], v10, s[52:55], s24 offen sc1
    s_branch L_c62r_f0
L_h1_f0_kv:
    s_mov_b32 s13, 0
    s_xor_b32 s15, s85, 4
L_h1_f0_kvl:
    buffer_load_dword v126, off, s[52:55], s15 sc1
    s_waitcnt vmcnt(0)
    v_readfirstlane_b32 s14, v126
    s_nop 0
    s_cmp_ge_i32 s14, s35
    s_cbranch_scc1 L_h1_f0_kvok
    s_add_u32 s13, s13, 1
    s_cmp_lt_u32 s13, 1048576
    s_cbranch_scc1 L_h1_f0_kvl
    s_branch L_end
L_h2b_f1_fail:
    buffer_load_dwordx4 v[20:23], v1, s[52:55], s25 offen offset:1024 sc1
    s_add_u32 s13, s13, 1
    s_nop 4
    v_mov_b64 v[48:49], 0
    v_mov_b64 v[50:51], 0
    v_mov_b64 v[52:53], 0
    v_mov_b64 v[54:55], 0
    s_cmp_lt_u32 s13, 1048576
    s_cbranch_scc1 L_h2a_f1
    s_branch L_end
.p2align 6
    s_nop 0
    s_nop 0
    s_nop 0
L_h2b_f1:
    buffer_load_dwordx4 v[16:19], v1, s[52:55], s25 offen offset:1024 sc1
    s_nop 5
    v_mov_b64 v[48:49], 0
    v_mov_b64 v[50:51], 0
    v_mov_b64 v[52:53], 0
    v_mov_b64 v[54:55], 0
    s_waitcnt vmcnt(1)
L_h2b_f1_go:
    v_max3_u32 v127, v20, v21, v22
    v_max_u32 v127, v127, v23
    v_cmp_eq_u32 vcc, -1, v127
    v_smfmac_f32_16x16x64_bf16 v[48:51], v[20:23], v[24:31], v2
    ds_write_b128 v14, v[20:23] offset:1024
    v_smfmac_f32_16x16x64_bf16 v[52:55], v[20:23], v[32:39], v2
    s_cbranch_vccnz L_h2b_f1_fail
    v_smfmac_f32_16x16x64_bf16 v[56:59], v[20:23], v[40:47], v2
    buffer_load_dwordx4 v[104:107], v1, s[52:55], s92 offen offset:1024 sc1
    s_waitcnt lgkmcnt(0)
    s_barrier
    ds_read_b128 v[24:27], v14 offset:0
    v_smfmac_f32_16x16x64_bf16 v[60:63], v[20:23], v[76:83], v2
    ds_read_b128 v[28:31], v14 offset:3072
    v_smfmac_f32_16x16x64_bf16 v[64:67], v[20:23], v[84:91], v2
    ds_read_b128 v[32:35], v14 offset:2048
    v_smfmac_f32_16x16x64_bf16 v[68:71], v[20:23], v[92:99], v2
    s_branch L_cbody_f1
.p2align 6
    s_nop 0
    s_nop 0
    s_nop 0
L_h2a_f1:
    s_waitcnt vmcnt(1)
L_h2a_f1_go:
    v_max3_u32 v127, v16, v17, v18
    v_max_u32 v127, v127, v19
    v_cmp_eq_u32 vcc, -1, v127
    v_smfmac_f32_16x16x64_bf16 v[48:51], v[16:19], v[24:31], v2
    ds_write_b128 v14, v[16:19] offset:1024
    v_smfmac_f32_16x16x64_bf16 v[52:55], v[16:19], v[32:39], v2
    s_cbranch_vccnz L_h2b_f1
    v_smfmac_f32_16x16x64_bf16 v[56:59], v[16:19], v[40:47], v2
    buffer_load_dwordx4 v[104:107], v1, s[52:55], s92 offen offset:1024 sc1
    s_waitcnt lgkmcnt(0)
    s_barrier
    ds_read_b128 v[24:27], v14 offset:0
    v_smfmac_f32_16x16x64_bf16 v[60:63], v[16:19], v[76:83], v2
    ds_read_b128 v[28:31], v14 offset:3072
    v_smfmac_f32_16x16x64_bf16 v[64:67], v[16:19], v[84:91], v2
    ds_read_b128 v[32:35], v14 offset:2048
    v_smfmac_f32_16x16x64_bf16 v[68:71], v[16:19], v[92:99], v2
L_cbody_f1:
    s_waitcnt lgkmcnt(2)
    v_smfmac_f32_16x16x64_bf16 v[48:51], v[24:27], a[16:23], v2
    v_smfmac_f32_16x16x64_bf16 v[52:55], v[24:27], a[80:87], v2
    buffer_load_dwordx4 v1, s[52:55], s21 offen sc1 lds
    v_smfmac_f32_16x16x64_bf16 v[56:59], v[24:27], a[144:151], v2
    s_waitcnt lgkmcnt(0)
    v_smfmac_f32_16x16x64_bf16 v[60:63], v[24:27], a[208:215], v2
    buffer_load_dwordx4 v[16:19], v1, s[52:55], s20 offen sc1
    v_smfmac_f32_16x16x64_bf16 v[48:51], v[28:31], a[24:31], v2
    v_smfmac_f32_16x16x64_bf16 v[52:55], v[28:31], a[88:95], v2
    buffer_load_dwordx4 v1, s[52:55], s21 offen offset:1024 sc1 lds
    v_smfmac_f32_16x16x64_bf16 v[56:59], v[28:31], a[152:159], v2
    v_smfmac_f32_16x16x64_bf16 v[60:63], v[28:31], a[216:223], v2
    buffer_load_dwordx4 v[20:23], v1, s[52:55], s20 offen offset:1024 sc1
    s_waitcnt vmcnt(4)
    v_max3_u32 v127, v104, v105, v106
    v_max_u32 v127, v127, v107
    v_cmp_eq_u32 vcc, -1, v127
    v_smfmac_f32_16x16x64_bf16 v[48:51], v[32:35], a[32:39], v2
    ds_write_b128 v14, v[104:107] offset:5120
    v_smfmac_f32_16x16x64_bf16 v[52:55], v[32:35], a[96:103], v2
    s_cbranch_vccnz L_lf_f1
L_lr_f1:
    v_smfmac_f32_16x16x64_bf16 v[48:51], v[104:107], a[8:15], v2
    v_smfmac_f32_16x16x64_bf16 v[52:55], v[104:107], a[72:79], v2
    v_smfmac_f32_16x16x64_bf16 v[56:59], v[104:107], a[136:143], v2
    s_waitcnt lgkmcnt(0)
    s_barrier
    ds_read_b128 v[36:39], v14 offset:4096
    v_smfmac_f32_16x16x64_bf16 v[60:63], v[104:107], a[200:207], v2
    buffer_store_dwordx4 v[72:75], v10, s[52:55], s24 offen sc1
    ds_read_b128 v[40:43], v14 offset:7168
    v_smfmac_f32_16x16x64_bf16 v[64:67], v[104:107], v[136:143], v2
    ds_read_b128 v[44:47], v14 offset:6144
    v_smfmac_f32_16x16x64_bf16 v[68:71], v[104:107], v[200:207], v2
    v_smfmac_f32_16x16x64_bf16 v[56:59], v[32:35], a[160:167], v2
    v_smfmac_f32_16x16x64_bf16 v[60:63], v[32:35], a[224:231], v2
    buffer_store_dword v122, v11, s[52:55], s24 offen sc1
    s_waitcnt lgkmcnt(0)
    v_smfmac_f32_16x16x64_bf16 v[48:51], v[36:39], a[40:47], v2
    v_smfmac_f32_16x16x64_bf16 v[52:55], v[36:39], a[104:111], v2
    ds_read_b128 v[92:95], v15 offset:0
    v_smfmac_f32_16x16x64_bf16 v[48:51], v[40:43], a[48:55], v2
    ds_read_b128 v[96:99], v15 offset:1024
    v_smfmac_f32_16x16x64_bf16 v[52:55], v[40:43], a[112:119], v2
    buffer_store_dword v124, v11, s[52:55], s24 offen offset:256 sc1
    ds_read_b128 v[100:103], v15 offset:2048
    v_smfmac_f32_16x16x64_bf16 v[48:51], v[44:47], a[56:63], v2
    ds_read_b128 v[104:107], v15 offset:3072
    v_smfmac_f32_16x16x64_bf16 v[52:55], v[44:47], a[120:127], v2
    v_smfmac_f32_16x16x64_bf16 v[56:59], v[36:39], a[168:175], v2
    v_add_f32 v48, v48, v50
    v_smfmac_f32_16x16x64_bf16 v[60:63], v[36:39], a[232:239], v2
    v_add_f32 v49, v49, v51
    v_smfmac_f32_16x16x64_bf16 v[56:59], v[40:43], a[176:183], v2
    v_add_f32 v52, v52, v54
    v_smfmac_f32_16x16x64_bf16 v[60:63], v[40:43], a[240:247], v2
    v_add_f32 v53, v53, v55
    v_smfmac_f32_16x16x64_bf16 v[56:59], v[44:47], a[184:191], v2
    v_cvt_pk_bf16_f32 v118, v48, v52
    v_smfmac_f32_16x16x64_bf16 v[60:63], v[44:47], a[248:255], v2
    v_cvt_pk_bf16_f32 v119, v49, v53
    v_smfmac_f32_16x16x64_bf16 v[64:67], v[24:27], v[144:151], v2
    ds_write2_b32 v6, v118, v119 offset0:0 offset1:136
    v_add_f32 v56, v56, v58
    v_add_f32 v57, v57, v59
    v_smfmac_f32_16x16x64_bf16 v[68:71], v[24:27], v[208:215], v2
    v_add_f32 v60, v60, v62
    v_add_f32 v61, v61, v63
    v_cvt_pk_bf16_f32 v116, v56, v60
    v_cvt_pk_bf16_f32 v117, v57, v61
    v_smfmac_f32_16x16x64_bf16 v[64:67], v[28:31], v[152:159], v2
    ds_write2_b32 v6, v116, v117 offset0:64 offset1:200
    v_smfmac_f32_16x16x64_bf16 v[68:71], v[28:31], v[216:223], v2
    v_smfmac_f32_16x16x64_bf16 v[64:67], v[32:35], v[160:167], v2
    buffer_store_dword v5, v4, s[52:55], s26 offen
    v_smfmac_f32_16x16x64_bf16 v[68:71], v[32:35], v[224:231], v2
    s_cmp_eq_u32 s16, 63
    v_smfmac_f32_16x16x64_bf16 v[64:67], v[36:39], v[168:175], v2
    s_waitcnt lgkmcnt(0)
    s_barrier
    ds_read_b128 v[76:79], v8 offset:0
    v_smfmac_f32_16x16x64_bf16 v[68:71], v[36:39], v[232:239], v2
    ds_read_b128 v[80:83], v8 offset:64
    v_smfmac_f32_16x16x64_bf16 v[64:67], v[40:43], v[176:183], v2
    ds_read_b128 v[84:87], v8 offset:128
    v_smfmac_f32_16x16x64_bf16 v[68:71], v[40:43], v[240:247], v2
    ds_read_b128 v[88:91], v8 offset:192
    v_smfmac_f32_16x16x64_bf16 v[64:67], v[44:47], v[184:191], v2
    ds_read_b128 v[24:27], v8 offset:256
    v_smfmac_f32_16x16x64_bf16 v[68:71], v[44:47], v[248:255], v2
    s_cbranch_scc1 L_clast
    ds_read_b128 v[28:31], v8 offset:320
    s_waitcnt lgkmcnt(4)
    v_mfma_f32_16x16x32_bf16 v[48:51], v[92:95], v[76:79], 0
    ds_read_b128 v[56:59], v8 offset:384
    v_mfma_f32_16x16x32_bf16 v[48:51], v[96:99], v[80:83], v[48:51]
    ds_read_b128 v[60:63], v8 offset:448
    s_waitcnt lgkmcnt(4)
    v_mfma_f32_16x16x32_bf16 v[48:51], v[100:103], v[84:87], v[48:51]
    ds_read_b128 v[92:95], v15 offset:4096
    v_add_f32 v64, v64, v66
    v_mfma_f32_16x16x32_bf16 v[48:51], v[104:107], v[88:91], v[48:51]
    ds_read_b128 v[96:99], v15 offset:5120
    s_waitcnt lgkmcnt(4)
    v_mfma_f32_16x16x32_bf16 v[72:75], v[24:27], v[76:79], 0
    ds_read_b128 v[100:103], v15 offset:6144
    v_add_f32 v65, v65, v67
    v_mfma_f32_16x16x32_bf16 v[72:75], v[28:31], v[80:83], v[72:75]
    ds_read_b128 v[104:107], v15 offset:7168
    s_waitcnt lgkmcnt(4)
    v_mfma_f32_16x16x32_bf16 v[72:75], v[56:59], v[84:87], v[72:75]
    v_add_f32 v68, v68, v70
    v_add_f32 v69, v69, v71
    v_mfma_f32_16x16x32_bf16 v[72:75], v[60:63], v[88:91], v[72:75]
    s_waitcnt lgkmcnt(2)
    v_cvt_pk_bf16_f32 v122, v64, v65
    v_mfma_f32_16x16x32_bf16 v[52:55], v[92:95], v[76:79], 0
    v_cvt_pk_bf16_f32 v124, v68, v69
    v_max3_f32 v118, v48, v49, v50
    v_mfma_f32_16x16x32_bf16 v[52:55], v[96:99], v[80:83], v[52:55]
    s_waitcnt lgkmcnt(0)
    v_mov_b32 v64, 0x3f803f80
    v_mfma_f32_16x16x32_bf16 v[52:55], v[100:103], v[84:87], v[52:55]
    ds_read_b128 v[24:27], v12 offset:2048
    v_max3_f32 v118, v118, v51, v72
    v_mfma_f32_16x16x32_bf16 v[52:55], v[104:107], v[88:91], v[52:55]
    ds_read_b128 v[28:31], v12 offset:3072
    ds_read_b128 v[32:35], v12 offset:6144
    v_mov_b32 v65, v64
    v_max_f32 v118, v118, v73
    v_mov_b64 v[66:67], v[64:65]
    v_mov_b64 v[68:69], 0
    v_mov_b64 v[70:71], 0
    s_nop 0
    v_max3_f32 v118, v118, v52, v53
    v_max3_f32 v74, v118, v54, v55
    v_mov_b32 v75, v74
    s_nop 1
    v_permlane16_swap_b32 v74, v75
    v_max_f32 v74, v74, v75
    v_mov_b32 v75, v74
    s_nop 1
    v_permlane32_swap_b32 v74, v75
    v_max_f32 v74, v74, v75
    v_mul_f32 v74, s32, v74
    v_pk_fma_f32 v[48:49], v[48:49], s[32:33], v[74:75] op_sel_hi:[1,1,0] neg_lo:[0,0,1] neg_hi:[0,0,1]
    v_pk_fma_f32 v[50:51], v[50:51], s[32:33], v[74:75] op_sel_hi:[1,1,0] neg_lo:[0,0,1] neg_hi:[0,0,1]
    v_pk_fma_f32 v[52:53], v[52:53], s[32:33], v[74:75] op_sel_hi:[1,1,0] neg_lo:[0,0,1] neg_hi:[0,0,1]
    v_pk_fma_f32 v[54:55], v[54:55], s[32:33], v[74:75] op_sel_hi:[1,1,0] neg_lo:[0,0,1] neg_hi:[0,0,1]
    v_pk_fma_f32 v[72:73], v[72:73], s[32:33], v[74:75] op_sel_hi:[1,1,0] neg_lo:[0,0,1] neg_hi:[0,0,1]
    v_exp_f32 v72, v72
    v_exp_f32 v73, v73
    v_exp_f32 v48, v48
    v_cvt_pk_bf16_f32 v120, v72, v73
    v_exp_f32 v49, v49
    v_exp_f32 v50, v50
    v_mfma_f32_16x16x16_bf16 v[72:75], v[64:65], v[120:121], 0
    ds_read_b128 v[36:39], v12 offset:7168
    v_exp_f32 v51, v51
    v_exp_f32 v52, v52
    v_mfma_f32_16x16x16_bf16 v[56:59], v[122:123], v[120:121], 0
    ds_read_b128 v[40:43], v12 offset:10240
    v_exp_f32 v53, v53
    v_exp_f32 v54, v54
    v_mfma_f32_16x16x16_bf16 v[60:63], v[124:125], v[120:121], 0
    ds_read_b128 v[44:47], v12 offset:11264
    v_exp_f32 v55, v55
    v_cvt_pk_bf16_f32 v116, v48, v49
    v_cvt_pk_bf16_f32 v117, v50, v51
    v_cvt_pk_bf16_f32 v118, v52, v53
    v_cvt_pk_bf16_f32 v119, v54, v55
    v_mov_b64 v[48:49], 0
    v_mov_b64 v[50:51], 0
    v_mfma_f32_16x16x32_bf16 v[72:75], v[64:67], v[116:119], v[72:75]
    ds_read_b128 v[76:79], v12 offset:14336
    v_mov_b64 v[52:53], 0
    v_mfma_f32_16x16x32_bf16 v[56:59], v[108:111], v[116:119], v[56:59]
    ds_read_b128 v[80:83], v12 offset:15360
    v_mov_b64 v[54:55], 0
    v_mfma_f32_16x16x32_bf16 v[60:63], v[112:115], v[116:119], v[60:63]
    ds_read_b128 v[84:87], v12 offset:0
    v_rcp_f32 v120, v72
    v_mov_b64 v[116:117], 0
    s_nop 0
    v_pk_mul_f32 v[56:57], v[56:57], v[120:121] op_sel_hi:[1,0]
    v_pk_mul_f32 v[58:59], v[58:59], v[120:121] op_sel_hi:[1,0]
    v_cvt_pk_bf16_f32 v56, v56, v57
    v_cvt_pk_bf16_f32 v57, v58, v59
    v_pk_mul_f32 v[60:61], v[60:61], v[120:121] op_sel_hi:[1,0]
    v_pk_mul_f32 v[62:63], v[62:63], v[120:121] op_sel_hi:[1,0]
    v_cvt_pk_bf16_f32 v58, v60, v61
    v_cvt_pk_bf16_f32 v59, v62, v63
    v_cndmask_b32 v60, v56, v58, s[48:49]
    v_cndmask_b32 v61, v57, v59, s[48:49]
    ds_write_b64 v7, v[60:61] offset:512
    s_waitcnt lgkmcnt(1)
    v_smfmac_f32_16x16x64_bf16 v[48:51], v[56:59], v[24:31], v2
    ds_read_b128 v[88:91], v12 offset:1024
    v_mov_b64 v[118:119], 0
    v_smfmac_f32_16x16x64_bf16 v[52:55], v[56:59], v[32:39], v2
    ds_read_b128 v[92:95], v12 offset:4096
    v_smfmac_f32_16x16x64_bf16 v[68:71], v[56:59], v[40:47], v2
    ds_read_b128 v[96:99], v12 offset:5120
    s_waitcnt lgkmcnt(3)
    s_barrier
    ds_read_b128 v[60:63], v9 offset:0
    ds_read_b128 v[64:67], v9 offset:1536
    ds_read_b128 v[72:75], v9 offset:1024
    v_smfmac_f32_16x16x64_bf16 v[116:119], v[56:59], v[76:83], v2
    s_cmp_eq_u32 s16, 62
    s_cbranch_scc1 L_c62_f1
L_c62r_f1:
    s_waitcnt lgkmcnt(2)
    v_smfmac_f32_16x16x64_bf16 v[48:51], v[60:63], v[84:91], v2
    ds_read_b128 v[100:103], v12 offset:8192
    s_waitcnt lgkmcnt(2)
    v_smfmac_f32_16x16x64_bf16 v[48:51], v[64:67], a[64:71], v2
    ds_read_b128 v[104:107], v12 offset:9216
    s_waitcnt lgkmcnt(2)
    v_smfmac_f32_16x16x64_bf16 v[48:51], v[72:75], a[0:7], v2
    ds_read_b128 v[108:111], v12 offset:12288
    ds_read_b128 v[112:115], v12 offset:13312
    v_smfmac_f32_16x16x64_bf16 v[52:55], v[60:63], v[92:99], v2
    ds_read_b128 v[24:27], v13 offset:38912
    ds_read_b128 v[28:31], v13 offset:39936
    v_smfmac_f32_16x16x64_bf16 v[52:55], v[64:67], a[192:199], v2
    v_cvt_pk_bf16_f32 v48, v48, v49
    v_cvt_pk_bf16_f32 v49, v50, v51
    v_and_or_b32 v48, v48, -2, s17
    v_smfmac_f32_16x16x64_bf16 v[52:55], v[72:75], a[128:135], v2
    buffer_store_dwordx2 v[48:49], v3, s[52:55], s18 offen offset:0
    s_waitcnt lgkmcnt(4)
    v_smfmac_f32_16x16x64_bf16 v[68:71], v[60:63], v[100:107], v2
    ds_read_b128 v[32:35], v13 offset:36864
    ds_read_b128 v[36:39], v13 offset:37888
    v_smfmac_f32_16x16x64_bf16 v[68:71], v[64:67], v[192:199], v2
    v_cvt_pk_bf16_f32 v52, v52, v53
    v_cvt_pk_bf16_f32 v53, v54, v55
    v_and_or_b32 v52, v52, -2, s17
    v_smfmac_f32_16x16x64_bf16 v[68:71], v[72:75], v[128:135], v2
    buffer_store_dwordx2 v[52:53], v3, s[52:55], s18 offen offset:2048
    s_waitcnt lgkmcnt(2)
    v_smfmac_f32_16x16x64_bf16 v[116:119], v[60:63], v[108:115], v2
    v_smfmac_f32_16x16x64_bf16 v[116:119], v[64:67], v[24:31], v2
    v_cvt_pk_bf16_f32 v68, v68, v69
    v_cvt_pk_bf16_f32 v69, v70, v71
    v_and_or_b32 v68, v68, -2, s17
    s_waitcnt lgkmcnt(0)
    v_smfmac_f32_16x16x64_bf16 v[116:119], v[72:75], v[32:39], v2
    buffer_store_dwordx2 v[68:69], v3, s[52:55], s19 offen offset:0
    s_nop 6
    v_cvt_pk_bf16_f32 v116, v116, v117
    v_cvt_pk_bf16_f32 v117, v118, v119
    v_and_or_b32 v116, v116, -2, s17
    buffer_store_dwordx2 v[116:117], v3, s[52:55], s19 offen offset:2048
    ds_read_b128 v[72:75], v14 offset:31232
    s_waitcnt vmcnt(8)
    v_mov_b64 v[108:109], v[16:17]
    v_mov_b64 v[110:111], v[18:19]
    v_mov_b64 v[112:113], v[20:21]
    v_mov_b64 v[114:115], v[22:23]
    v_mov_b64 v[48:49], 0
    v_mov_b64 v[50:51], 0
    v_mov_b64 v[52:53], 0
    v_mov_b64 v[54:55], 0
    v_mov_b64 v[56:57], 0
    v_mov_b64 v[58:59], 0
    v_mov_b64 v[60:61], 0
    v_mov_b64 v[62:63], 0
    v_mov_b64 v[68:69], 0
    v_mov_b64 v[70:71], 0
    v_mov_b64 v[64:65], 0
    v_mov_b64 v[66:67], 0
    v_xor_b32 v15, 0x6000, v15
    s_add_u32 s16, s16, 1
    s_add_u32 s20, s20, 524288
    s_add_u32 s21, s21, 524288
    s_mov_b32 s24, s28
    s_add_u32 s28, s28, 131072
    s_xor_b32 s31, s31, 0x6000
    s_mov_b32 m0, s31
    s_mov_b32 s13, 0
    s_mov_b32 s26, s25
    s_and_b32 s15, s16, 3
    s_lshl_b32 s15, s15, 13
    s_add_u32 s25, s23, s15
    s_add_u32 s92, s25, 4096
    s_cmp_eq_u32 s16, 63
    s_cselect_b32 s21, 0x40000000, s21
    s_cselect_b32 s20, 0x40000000, s20
    ds_read_b128 v[24:27], v13 offset:0
    ds_read_b128 v[28:31], v13 offset:1024
    buffer_load_dwordx4 v[16:19], v1, s[52:55], s22 offen sc1
    buffer_load_dwordx4 v[20:23], v1, s[52:55], s22 offen offset:1024 sc1
    ds_read_b128 v[32:35], v13 offset:2048
    ds_read_b128 v[36:39], v13 offset:3072
    ds_read_b128 v[40:43], v13 offset:4096
    ds_read_b128 v[44:47], v13 offset:5120
    ds_read_b128 v[76:79], v13 offset:6144
    ds_read_b128 v[80:83], v13 offset:7168
    ds_read_b128 v[84:87], v13 offset:32768
    ds_read_b128 v[88:91], v13 offset:33792
    ds_read_b128 v[92:95], v13 offset:34816
    ds_read_b128 v[96:99], v13 offset:35840
    s_nop 8
    buffer_load_dwordx4 v[100:103], v1, s[52:55], s22 offen sc1
    buffer_load_dwordx4 v[104:107], v1, s[52:55], s22 offen offset:1024 sc1
    s_waitcnt lgkmcnt(0)
L_h1_f1a:
    s_waitcnt vmcnt(3)
    v_mfma_f32_16x16x32_bf16 v[116:119], v[72:75], v[16:19], 0
    v_bitop3_b32 v127, v16, v18, s17 bitop3:0x7e
    s_waitcnt vmcnt(2)
    v_mfma_f32_16x16x32_bf16 v[116:119], v[72:75], v[20:23], v[116:119]
    v_bitop3_b32 v120, v20, v22, s17 bitop3:0x7e
    v_bitop3_b32 v127, v127, v120, 1 bitop3:0xa8
    v_cmp_ne_u32 vcc, 0, v127
    s_cbranch_vccnz L_h1_f1b
    v_add_f32_dpp v116, v116, v116 row_ror:4 row_mask:0xf bank_mask:0xf
    v_add_f32_dpp v117, v117, v117 row_ror:4 row_mask:0xf bank_mask:0xf
    s_nop 0
    v_add_f32_dpp v116, v116, v116 row_ror:8 row_mask:0xf bank_mask:0xf
    v_add_f32_dpp v117, v117, v117 row_ror:8 row_mask:0xf bank_mask:0xf
    v_cvt_pk_bf16_f32 v116, v116, v117
    v_min_u32 v116, -2, v116
    buffer_store_dword v116, v4, s[52:55], s25 offen
L_h1_f1_ok:
    s_xor_b32 s17, s17, 1
    s_mov_b32 s13, 0
    ds_read_b128 v[72:75], v8 offset:320
    s_nop 15
    s_nop 15
    s_nop 4
    buffer_load_dwordx4 v[16:19], v1, s[52:55], s25 offen offset:1024 sc1
    s_nop 15
    s_nop 9
    buffer_load_dwordx4 v[20:23], v1, s[52:55], s25 offen offset:1024 sc1
    s_waitcnt lgkmcnt(0)
    s_branch L_h2a_f1
L_h1_f1f:
    buffer_load_dwordx4 v[100:103], v1, s[52:55], s22 offen sc1
    buffer_load_dwordx4 v[104:107], v1, s[52:55], s22 offen offset:1024 sc1
    s_add_u32 s13, s13, 1
    s_cmp_lt_u32 s13, 1048576
    s_cbranch_scc1 L_h1_f1a
    s_branch L_end
L_h1_f1b:
    buffer_load_dwordx4 v[16:19], v1, s[52:55], s22 offen sc1
    buffer_load_dwordx4 v[20:23], v1, s[52:55], s22 offen offset:1024 sc1
    s_waitcnt vmcnt(3)
    v_mfma_f32_16x16x32_bf16 v[116:119], v[72:75], v[100:103], 0
    v_bitop3_b32 v127, v100, v102, s17 bitop3:0x7e
    s_waitcnt vmcnt(2)
    v_mfma_f32_16x16x32_bf16 v[116:119], v[72:75], v[104:107], v[116:119]
    v_bitop3_b32 v120, v104, v106, s17 bitop3:0x7e
    v_bitop3_b32 v127, v127, v120, 1 bitop3:0xa8
    v_cmp_ne_u32 vcc, 0, v127
    s_cbranch_vccnz L_h1_f1f
    v_add_f32_dpp v116, v116, v116 row_ror:4 row_mask:0xf bank_mask:0xf
    v_add_f32_dpp v117, v117, v117 row_ror:4 row_mask:0xf bank_mask:0xf
    s_nop 0
    v_add_f32_dpp v116, v116, v116 row_ror:8 row_mask:0xf bank_mask:0xf
    v_add_f32_dpp v117, v117, v117 row_ror:8 row_mask:0xf bank_mask:0xf
    v_cvt_pk_bf16_f32 v116, v116, v117
    v_min_u32 v116, -2, v116
    buffer_store_dword v116, v4, s[52:55], s25 offen
    s_branch L_h1_f1_ok
L_lf_f1:
    s_mov_b32 s13, 0
L_lf1_f1:
    buffer_load_dwordx4 v[104:107], v1, s[52:55], s92 offen offset:1024 sc1
    s_waitcnt vmcnt(0)
    v_max3_u32 v127, v104, v105, v106
    v_max_u32 v127, v127, v107
    v_cmp_eq_u32 vcc, -1, v127
    ds_write_b128 v14, v[104:107] offset:5120
    s_cbranch_vccz L_lr_f1
    s_add_u32 s13, s13, 1
    s_cmp_lt_u32 s13, 1048576
    s_cbranch_scc1 L_lf1_f1
    s_branch L_end
L_c62_f1:
    s_mov_b32 s24, s28
    ds_read_b128 v[108:111], v8 offset:320
    buffer_store_dword v122, v11, s[52:55], s24 offen sc1
    buffer_store_dword v124, v11, s[52:55], s24 offen offset:256 sc1
    s_waitcnt lgkmcnt(0)
    buffer_store_dwordx4 v[108:111], v10, s[52:55], s24 offen sc1
    s_branch L_c62r_f1
L_h2b_f2_fail:
    buffer_load_dwordx4 v[20:23], v1, s[52:55], s25 offen offset:2048 sc1
    s_add_u32 s13, s13, 1
    s_nop 4
    v_mov_b64 v[48:49], 0
    v_mov_b64 v[50:51], 0
    v_mov_b64 v[52:53], 0
    v_mov_b64 v[54:55], 0
    s_cmp_lt_u32 s13, 1048576
    s_cbranch_scc1 L_h2a_f2
    s_branch L_end
.p2align 6
    s_nop 0
    s_nop 0
    s_nop 0
L_h2b_f2:
    buffer_load_dwordx4 v[16:19], v1, s[52:55], s25 offen offset:2048 sc1
    s_nop 5
    v_mov_b64 v[48:49], 0
    v_mov_b64 v[50:51], 0
    v_mov_b64 v[52:53], 0
    v_mov_b64 v[54:55], 0
    s_waitcnt vmcnt(1)
L_h2b_f2_go:
    v_max3_u32 v127, v20, v21, v22
    v_max_u32 v127, v127, v23
    v_cmp_eq_u32 vcc, -1, v127
    v_smfmac_f32_16x16x64_bf16 v[48:51], v[20:23], v[24:31], v2
    ds_write_b128 v14, v[20:23] offset:2048
    v_smfmac_f32_16x16x64_bf16 v[52:55], v[20:23], v[32:39], v2
    s_cbranch_vccnz L_h2b_f2_fail
    v_smfmac_f32_16x16x64_bf16 v[56:59], v[20:23], v[40:47], v2
    buffer_load_dwordx4 v[104:107], v1, s[52:55], s92 offen offset:2048 sc1
    s_waitcnt lgkmcnt(0)
    s_barrier
    ds_read_b128 v[24:27], v14 offset:3072
    v_smfmac_f32_16x16x64_bf16 v[60:63], v[20:23], v[76:83], v2
    ds_read_b128 v[28:31], v14 offset:0
    v_smfmac_f32_16x16x64_bf16 v[64:67], v[20:23], v[84:91], v2
    ds_read_b128 v[32:35], v14 offset:1024
    v_smfmac_f32_16x16x64_bf16 v[68:71], v[20:23], v[92:99], v2
    buffer_store_dword v126, v0, s[52:55], s30 offen sc1
    s_branch L_cbody_f2
.p2align 6
    s_nop 0
    s_nop 0
    s_nop 0
L_h2a_f2:
    s_waitcnt vmcnt(1)
L_h2a_f2_go:
    v_max3_u32 v127, v16, v17, v18
    v_max_u32 v127, v127, v19
    v_cmp_eq_u32 vcc, -1, v127
    v_smfmac_f32_16x16x64_bf16 v[48:51], v[16:19], v[24:31], v2
    ds_write_b128 v14, v[16:19] offset:2048
    v_smfmac_f32_16x16x64_bf16 v[52:55], v[16:19], v[32:39], v2
    s_cbranch_vccnz L_h2b_f2
    v_smfmac_f32_16x16x64_bf16 v[56:59], v[16:19], v[40:47], v2
    buffer_load_dwordx4 v[104:107], v1, s[52:55], s92 offen offset:2048 sc1
    s_waitcnt lgkmcnt(0)
    s_barrier
    ds_read_b128 v[24:27], v14 offset:3072
    v_smfmac_f32_16x16x64_bf16 v[60:63], v[16:19], v[76:83], v2
    ds_read_b128 v[28:31], v14 offset:0
    v_smfmac_f32_16x16x64_bf16 v[64:67], v[16:19], v[84:91], v2
    ds_read_b128 v[32:35], v14 offset:1024
    v_smfmac_f32_16x16x64_bf16 v[68:71], v[16:19], v[92:99], v2
    buffer_store_dword v126, v0, s[52:55], s30 offen sc1
L_cbody_f2:
    s_waitcnt lgkmcnt(2)
    v_smfmac_f32_16x16x64_bf16 v[48:51], v[24:27], a[16:23], v2
    v_smfmac_f32_16x16x64_bf16 v[52:55], v[24:27], a[80:87], v2
    v_smfmac_f32_16x16x64_bf16 v[56:59], v[24:27], a[144:151], v2
    buffer_load_dwordx4 v1, s[52:55], s21 offen sc1 lds
    s_waitcnt lgkmcnt(0)
    v_smfmac_f32_16x16x64_bf16 v[60:63], v[24:27], a[208:215], v2
    v_smfmac_f32_16x16x64_bf16 v[48:51], v[28:31], a[24:31], v2
    buffer_load_dwordx4 v[16:19], v1, s[52:55], s20 offen sc1
    v_smfmac_f32_16x16x64_bf16 v[52:55], v[28:31], a[88:95], v2
    v_smfmac_f32_16x16x64_bf16 v[56:59], v[28:31], a[152:159], v2
    buffer_load_dwordx4 v1, s[52:55], s21 offen offset:1024 sc1 lds
    v_smfmac_f32_16x16x64_bf16 v[60:63], v[28:31], a[216:223], v2
    s_waitcnt vmcnt(4)
    v_max3_u32 v127, v104, v105, v106
    v_max_u32 v127, v127, v107
    v_cmp_eq_u32 vcc, -1, v127
    v_smfmac_f32_16x16x64_bf16 v[48:51], v[32:35], a[32:39], v2
    buffer_load_dwordx4 v[20:23], v1, s[52:55], s20 offen offset:1024 sc1
    ds_write_b128 v14, v[104:107] offset:6144
    v_smfmac_f32_16x16x64_bf16 v[52:55], v[32:35], a[96:103], v2
    s_cbranch_vccnz L_lf_f2
L_lr_f2:
    v_smfmac_f32_16x16x64_bf16 v[48:51], v[104:107], a[8:15], v2
    buffer_store_dwordx4 v[72:75], v10, s[52:55], s24 offen sc1
    v_smfmac_f32_16x16x64_bf16 v[52:55], v[104:107], a[72:79], v2
    v_smfmac_f32_16x16x64_bf16 v[56:59], v[104:107], a[136:143], v2
    s_waitcnt lgkmcnt(0)
    s_barrier
    ds_read_b128 v[36:39], v14 offset:7168
    v_smfmac_f32_16x16x64_bf16 v[60:63], v[104:107], a[200:207], v2
    ds_read_b128 v[40:43], v14 offset:4096
    v_smfmac_f32_16x16x64_bf16 v[64:67], v[104:107], v[136:143], v2
    ds_read_b128 v[44:47], v14 offset:5120
    v_smfmac_f32_16x16x64_bf16 v[68:71], v[104:107], v[200:207], v2
    v_smfmac_f32_16x16x64_bf16 v[56:59], v[32:35], a[160:167], v2
    v_smfmac_f32_16x16x64_bf16 v[60:63], v[32:35], a[224:231], v2
    s_waitcnt lgkmcnt(0)
    v_smfmac_f32_16x16x64_bf16 v[48:51], v[36:39], a[40:47], v2
    buffer_store_dword v122, v11, s[52:55], s24 offen sc1
    v_smfmac_f32_16x16x64_bf16 v[52:55], v[36:39], a[104:111], v2
    ds_read_b128 v[92:95], v15 offset:0
    v_smfmac_f32_16x16x64_bf16 v[48:51], v[40:43], a[48:55], v2
    ds_read_b128 v[96:99], v15 offset:1024
    v_smfmac_f32_16x16x64_bf16 v[52:55], v[40:43], a[112:119], v2
    ds_read_b128 v[100:103], v15 offset:2048
    v_smfmac_f32_16x16x64_bf16 v[48:51], v[44:47], a[56:63], v2
    buffer_store_dword v124, v11, s[52:55], s24 offen offset:256 sc1
    ds_read_b128 v[104:107], v15 offset:3072
    v_smfmac_f32_16x16x64_bf16 v[52:55], v[44:47], a[120:127], v2
    v_smfmac_f32_16x16x64_bf16 v[56:59], v[36:39], a[168:175], v2
    v_add_f32 v48, v48, v50
    v_smfmac_f32_16x16x64_bf16 v[60:63], v[36:39], a[232:239], v2
    v_add_f32 v49, v49, v51
    v_smfmac_f32_16x16x64_bf16 v[56:59], v[40:43], a[176:183], v2
    v_add_f32 v52, v52, v54
    v_smfmac_f32_16x16x64_bf16 v[60:63], v[40:43], a[240:247], v2
    v_add_f32 v53, v53, v55
    v_smfmac_f32_16x16x64_bf16 v[56:59], v[44:47], a[184:191], v2
    v_cvt_pk_bf16_f32 v118, v48, v52
    v_smfmac_f32_16x16x64_bf16 v[60:63], v[44:47], a[248:255], v2
    v_cvt_pk_bf16_f32 v119, v49, v53
    v_smfmac_f32_16x16x64_bf16 v[64:67], v[24:27], v[144:151], v2
    ds_write2_b32 v6, v118, v119 offset0:0 offset1:136
    v_add_f32 v56, v56, v58
    v_add_f32 v57, v57, v59
    v_smfmac_f32_16x16x64_bf16 v[68:71], v[24:27], v[208:215], v2
    v_add_f32 v60, v60, v62
    v_add_f32 v61, v61, v63
    v_cvt_pk_bf16_f32 v116, v56, v60
    v_cvt_pk_bf16_f32 v117, v57, v61
    v_smfmac_f32_16x16x64_bf16 v[64:67], v[28:31], v[152:159], v2
    ds_write2_b32 v6, v116, v117 offset0:64 offset1:200
    v_smfmac_f32_16x16x64_bf16 v[68:71], v[28:31], v[216:223], v2
    v_smfmac_f32_16x16x64_bf16 v[64:67], v[32:35], v[160:167], v2
    buffer_store_dword v5, v4, s[52:55], s26 offen
    v_smfmac_f32_16x16x64_bf16 v[68:71], v[32:35], v[224:231], v2
    s_cmp_eq_u32 s16, 63
    v_smfmac_f32_16x16x64_bf16 v[64:67], v[36:39], v[168:175], v2
    s_waitcnt lgkmcnt(0)
    s_barrier
    ds_read_b128 v[76:79], v8 offset:0
    v_smfmac_f32_16x16x64_bf16 v[68:71], v[36:39], v[232:239], v2
    ds_read_b128 v[80:83], v8 offset:64
    v_smfmac_f32_16x16x64_bf16 v[64:67], v[40:43], v[176:183], v2
    ds_read_b128 v[84:87], v8 offset:128
    v_smfmac_f32_16x16x64_bf16 v[68:71], v[40:43], v[240:247], v2
    ds_read_b128 v[88:91], v8 offset:192
    v_smfmac_f32_16x16x64_bf16 v[64:67], v[44:47], v[184:191], v2
    ds_read_b128 v[24:27], v8 offset:256
    v_smfmac_f32_16x16x64_bf16 v[68:71], v[44:47], v[248:255], v2
    s_cbranch_scc1 L_clast
    ds_read_b128 v[28:31], v8 offset:320
    s_waitcnt lgkmcnt(4)
    v_mfma_f32_16x16x32_bf16 v[48:51], v[92:95], v[76:79], 0
    ds_read_b128 v[56:59], v8 offset:384
    v_mfma_f32_16x16x32_bf16 v[48:51], v[96:99], v[80:83], v[48:51]
    ds_read_b128 v[60:63], v8 offset:448
    s_waitcnt lgkmcnt(4)
    v_mfma_f32_16x16x32_bf16 v[48:51], v[100:103], v[84:87], v[48:51]
    ds_read_b128 v[92:95], v15 offset:4096
    v_add_f32 v64, v64, v66
    v_mfma_f32_16x16x32_bf16 v[48:51], v[104:107], v[88:91], v[48:51]
    ds_read_b128 v[96:99], v15 offset:5120
    s_waitcnt lgkmcnt(4)
    v_mfma_f32_16x16x32_bf16 v[72:75], v[24:27], v[76:79], 0
    ds_read_b128 v[100:103], v15 offset:6144
    v_add_f32 v65, v65, v67
    v_mfma_f32_16x16x32_bf16 v[72:75], v[28:31], v[80:83], v[72:75]
    ds_read_b128 v[104:107], v15 offset:7168
    s_waitcnt lgkmcnt(4)
    v_mfma_f32_16x16x32_bf16 v[72:75], v[56:59], v[84:87], v[72:75]
    v_add_f32 v68, v68, v70
    v_add_f32 v69, v69, v71
    v_mfma_f32_16x16x32_bf16 v[72:75], v[60:63], v[88:91], v[72:75]
    s_waitcnt lgkmcnt(2)
    v_cvt_pk_bf16_f32 v122, v64, v65
    v_mfma_f32_16x16x32_bf16 v[52:55], v[92:95], v[76:79], 0
    v_cvt_pk_bf16_f32 v124, v68, v69
    v_max3_f32 v118, v48, v49, v50
    v_mfma_f32_16x16x32_bf16 v[52:55], v[96:99], v[80:83], v[52:55]
    s_waitcnt lgkmcnt(0)
    v_mov_b32 v64, 0x3f803f80
    v_mfma_f32_16x16x32_bf16 v[52:55], v[100:103], v[84:87], v[52:55]
    ds_read_b128 v[24:27], v13 offset:36864
    v_max3_f32 v118, v118, v51, v72
    v_mfma_f32_16x16x32_bf16 v[52:55], v[104:107], v[88:91], v[52:55]
    ds_read_b128 v[28:31], v13 offset:37888
    ds_read_b128 v[32:35], v12 offset:0
    v_mov_b32 v65, v64
    v_max_f32 v118, v118, v73
    v_mov_b64 v[66:67], v[64:65]
    v_mov_b64 v[68:69], 0
    v_mov_b64 v[70:71], 0
    s_nop 0
    v_max3_f32 v118, v118, v52, v53
    v_max3_f32 v74, v118, v54, v55
    v_mov_b32 v75, v74
    s_nop 1
    v_permlane16_swap_b32 v74, v75
    v_max_f32 v74, v74, v75
    v_mov_b32 v75, v74
    s_nop 1
    v_permlane32_swap_b32 v74, v75
    v_max_f32 v74, v74, v75
    v_mul_f32 v74, s32, v74
    v_pk_fma_f32 v[48:49], v[48:49], s[32:33], v[74:75] op_sel_hi:[1,1,0] neg_lo:[0,0,1] neg_hi:[0,0,1]
    v_pk_fma_f32 v[50:51], v[50:51], s[32:33], v[74:75] op_sel_hi:[1,1,0] neg_lo:[0,0,1] neg_hi:[0,0,1]
    v_pk_fma_f32 v[52:53], v[52:53], s[32:33], v[74:75] op_sel_hi:[1,1,0] neg_lo:[0,0,1] neg_hi:[0,0,1]
    v_pk_fma_f32 v[54:55], v[54:55], s[32:33], v[74:75] op_sel_hi:[1,1,0] neg_lo:[0,0,1] neg_hi:[0,0,1]
    v_pk_fma_f32 v[72:73], v[72:73], s[32:33], v[74:75] op_sel_hi:[1,1,0] neg_lo:[0,0,1] neg_hi:[0,0,1]
    v_exp_f32 v72, v72
    v_exp_f32 v73, v73
    v_exp_f32 v48, v48
    v_cvt_pk_bf16_f32 v120, v72, v73
    v_exp_f32 v49, v49
    v_exp_f32 v50, v50
    v_mfma_f32_16x16x16_bf16 v[72:75], v[64:65], v[120:121], 0
    ds_read_b128 v[36:39], v12 offset:1024
    v_exp_f32 v51, v51
    v_exp_f32 v52, v52
    v_mfma_f32_16x16x16_bf16 v[56:59], v[122:123], v[120:121], 0
    ds_read_b128 v[40:43], v12 offset:2048
    v_exp_f32 v53, v53
    v_exp_f32 v54, v54
    v_mfma_f32_16x16x16_bf16 v[60:63], v[124:125], v[120:121], 0
    ds_read_b128 v[44:47], v12 offset:3072
    v_exp_f32 v55, v55
    v_cvt_pk_bf16_f32 v116, v48, v49
    v_cvt_pk_bf16_f32 v117, v50, v51
    v_cvt_pk_bf16_f32 v118, v52, v53
    v_cvt_pk_bf16_f32 v119, v54, v55
    v_mov_b64 v[48:49], 0
    v_mov_b64 v[50:51], 0
    v_mfma_f32_16x16x32_bf16 v[72:75], v[64:67], v[116:119], v[72:75]
    ds_read_b128 v[76:79], v12 offset:4096
    v_mov_b64 v[52:53], 0
    v_mfma_f32_16x16x32_bf16 v[56:59], v[108:111], v[116:119], v[56:59]
    ds_read_b128 v[80:83], v12 offset:5120
    v_mov_b64 v[54:55], 0
    v_mfma_f32_16x16x32_bf16 v[60:63], v[112:115], v[116:119], v[60:63]
    ds_read_b128 v[84:87], v12 offset:6144
    v_rcp_f32 v120, v72
    v_mov_b64 v[116:117], 0
    s_nop 0
    v_pk_mul_f32 v[56:57], v[56:57], v[120:121] op_sel_hi:[1,0]
    v_pk_mul_f32 v[58:59], v[58:59], v[120:121] op_sel_hi:[1,0]
    v_cvt_pk_bf16_f32 v56, v56, v57
    v_cvt_pk_bf16_f32 v57, v58, v59
    v_pk_mul_f32 v[60:61], v[60:61], v[120:121] op_sel_hi:[1,0]
    v_pk_mul_f32 v[62:63], v[62:63], v[120:121] op_sel_hi:[1,0]
    v_cvt_pk_bf16_f32 v58, v60, v61
    v_cvt_pk_bf16_f32 v59, v62, v63
    v_cndmask_b32 v60, v56, v58, s[48:49]
    v_cndmask_b32 v61, v57, v59, s[48:49]
    ds_write_b64 v7, v[60:61] offset:1024
    s_waitcnt lgkmcnt(1)
    v_smfmac_f32_16x16x64_bf16 v[48:51], v[56:59], a[0:7], v2
    ds_read_b128 v[88:91], v12 offset:7168
    v_mov_b64 v[118:119], 0
    v_smfmac_f32_16x16x64_bf16 v[52:55], v[56:59], a[128:135], v2
    ds_read_b128 v[92:95], v12 offset:8192
    v_smfmac_f32_16x16x64_bf16 v[68:71], v[56:59], v[128:135], v2
    ds_read_b128 v[96:99], v12 offset:9216
    s_waitcnt lgkmcnt(3)
    s_barrier
    ds_read_b128 v[60:63], v9 offset:1536
    ds_read_b128 v[64:67], v9 offset:0
    ds_read_b128 v[72:75], v9 offset:512
    v_smfmac_f32_16x16x64_bf16 v[116:119], v[56:59], v[24:31], v2
    s_cmp_eq_u32 s16, 62
    s_cbranch_scc1 L_c62_f2
L_c62r_f2:
    s_waitcnt lgkmcnt(2)
    v_smfmac_f32_16x16x64_bf16 v[48:51], v[60:63], a[64:71], v2
    ds_read_b128 v[100:103], v12 offset:10240
    s_waitcnt lgkmcnt(2)
    v_smfmac_f32_16x16x64_bf16 v[48:51], v[64:67], v[32:39], v2
    ds_read_b128 v[104:107], v12 offset:11264
    s_waitcnt lgkmcnt(2)
    v_smfmac_f32_16x16x64_bf16 v[48:51], v[72:75], v[40:47], v2
    ds_read_b128 v[108:111], v13 offset:38912
    ds_read_b128 v[112:115], v13 offset:39936
    v_smfmac_f32_16x16x64_bf16 v[52:55], v[60:63], a[192:199], v2
    ds_read_b128 v[24:27], v12 offset:12288
    ds_read_b128 v[28:31], v12 offset:13312
    v_smfmac_f32_16x16x64_bf16 v[52:55], v[64:67], v[76:83], v2
    v_cvt_pk_bf16_f32 v48, v48, v49
    v_cvt_pk_bf16_f32 v49, v50, v51
    v_and_or_b32 v48, v48, -2, s17
    v_smfmac_f32_16x16x64_bf16 v[52:55], v[72:75], v[84:91], v2
    buffer_store_dwordx2 v[48:49], v3, s[52:55], s18 offen offset:0
    s_waitcnt lgkmcnt(4)
    v_smfmac_f32_16x16x64_bf16 v[68:71], v[60:63], v[192:199], v2
    ds_read_b128 v[32:35], v12 offset:14336
    ds_read_b128 v[36:39], v12 offset:15360
    v_smfmac_f32_16x16x64_bf16 v[68:71], v[64:67], v[92:99], v2
    v_cvt_pk_bf16_f32 v52, v52, v53
    v_cvt_pk_bf16_f32 v53, v54, v55
    v_and_or_b32 v52, v52, -2, s17
    v_smfmac_f32_16x16x64_bf16 v[68:71], v[72:75], v[100:107], v2
    buffer_store_dwordx2 v[52:53], v3, s[52:55], s18 offen offset:2048
    s_waitcnt lgkmcnt(2)
    v_smfmac_f32_16x16x64_bf16 v[116:119], v[60:63], v[108:115], v2
    v_smfmac_f32_16x16x64_bf16 v[116:119], v[64:67], v[24:31], v2
    v_cvt_pk_bf16_f32 v68, v68, v69
    v_cvt_pk_bf16_f32 v69, v70, v71
    v_and_or_b32 v68, v68, -2, s17
    s_waitcnt lgkmcnt(0)
    v_smfmac_f32_16x16x64_bf16 v[116:119], v[72:75], v[32:39], v2
    buffer_store_dwordx2 v[68:69], v3, s[52:55], s19 offen offset:0
    s_nop 6
    v_cvt_pk_bf16_f32 v116, v116, v117
    v_cvt_pk_bf16_f32 v117, v118, v119
    v_and_or_b32 v116, v116, -2, s17
    buffer_store_dwordx2 v[116:117], v3, s[52:55], s19 offen offset:2048
    ds_read_b128 v[72:75], v14 offset:31232
    s_waitcnt vmcnt(8)
    v_mov_b64 v[108:109], v[16:17]
    v_mov_b64 v[110:111], v[18:19]
    v_mov_b64 v[112:113], v[20:21]
    v_mov_b64 v[114:115], v[22:23]
    v_mov_b64 v[48:49], 0
    v_mov_b64 v[50:51], 0
    v_mov_b64 v[52:53], 0
    v_mov_b64 v[54:55], 0
    v_mov_b64 v[56:57], 0
    v_mov_b64 v[58:59], 0
    v_mov_b64 v[60:61], 0
    v_mov_b64 v[62:63], 0
    v_mov_b64 v[68:69], 0
    v_mov_b64 v[70:71], 0
    v_mov_b64 v[64:65], 0
    v_mov_b64 v[66:67], 0
    v_xor_b32 v15, 0x6000, v15
    s_add_u32 s16, s16, 1
    s_add_u32 s20, s20, 524288
    s_add_u32 s21, s21, 524288
    s_mov_b32 s24, s28
    s_add_u32 s28, s28, 131072
    s_xor_b32 s31, s31, 0x6000
    s_mov_b32 m0, s31
    s_mov_b32 s13, 0
    s_mov_b32 s26, s25
    s_and_b32 s15, s16, 3
    s_lshl_b32 s15, s15, 13
    s_add_u32 s25, s23, s15
    s_add_u32 s92, s25, 4096
    s_cmp_eq_u32 s16, 63
    s_cselect_b32 s21, 0x40000000, s21
    s_cselect_b32 s20, 0x40000000, s20
    v_add_u32 v126, 1, v126
    ds_read_b128 v[24:27], v13 offset:0
    ds_read_b128 v[28:31], v13 offset:1024
    ds_read_b128 v[32:35], v13 offset:2048
    ds_read_b128 v[36:39], v13 offset:3072
    ds_read_b128 v[40:43], v13 offset:4096
    ds_read_b128 v[44:47], v13 offset:5120
    ds_read_b128 v[76:79], v13 offset:6144
    ds_read_b128 v[80:83], v13 offset:7168
    ds_read_b128 v[84:87], v13 offset:32768
    ds_read_b128 v[88:91], v13 offset:33792
    buffer_load_dwordx4 v[16:19], v1, s[52:55], s22 offen sc1
    buffer_load_dwordx4 v[20:23], v1, s[52:55], s22 offen offset:1024 sc1
    ds_read_b128 v[92:95], v13 offset:34816
    ds_read_b128 v[96:99], v13 offset:35840
    s_nop 15
    s_nop 8
    buffer_load_dwordx4 v[100:103], v1, s[52:55], s22 offen sc1
    buffer_load_dwordx4 v[104:107], v1, s[52:55], s22 offen offset:1024 sc1
    s_waitcnt lgkmcnt(0)
L_h1_f2a:
    s_waitcnt vmcnt(3)
    v_mfma_f32_16x16x32_bf16 v[116:119], v[72:75], v[16:19], 0
    v_bitop3_b32 v127, v16, v18, s17 bitop3:0x7e
    s_waitcnt vmcnt(2)
    v_mfma_f32_16x16x32_bf16 v[116:119], v[72:75], v[20:23], v[116:119]
    v_bitop3_b32 v120, v20, v22, s17 bitop3:0x7e
    v_bitop3_b32 v127, v127, v120, 1 bitop3:0xa8
    v_cmp_ne_u32 vcc, 0, v127
    s_cbranch_vccnz L_h1_f2b
    v_add_f32_dpp v116, v116, v116 row_ror:4 row_mask:0xf bank_mask:0xf
    v_add_f32_dpp v117, v117, v117 row_ror:4 row_mask:0xf bank_mask:0xf
    s_nop 0
    v_add_f32_dpp v116, v116, v116 row_ror:8 row_mask:0xf bank_mask:0xf
    v_add_f32_dpp v117, v117, v117 row_ror:8 row_mask:0xf bank_mask:0xf
    v_cvt_pk_bf16_f32 v116, v116, v117
    v_min_u32 v116, -2, v116
    buffer_store_dword v116, v4, s[52:55], s25 offen
L_h1_f2_ok:
    s_xor_b32 s17, s17, 1
    s_mov_b32 s13, 0
    ds_read_b128 v[72:75], v8 offset:384
    s_nop 14
    buffer_load_dwordx4 v[16:19], v1, s[52:55], s25 offen offset:2048 sc1
    s_nop 15
    s_nop 15
    buffer_load_dwordx4 v[20:23], v1, s[52:55], s25 offen offset:2048 sc1
    s_waitcnt lgkmcnt(0)
    s_branch L_h2a_f2
L_h1_f2f:
    buffer_load_dwordx4 v[100:103], v1, s[52:55], s22 offen sc1
    buffer_load_dwordx4 v[104:107], v1, s[52:55], s22 offen offset:1024 sc1
    s_add_u32 s13, s13, 1
    s_cmp_lt_u32 s13, 1048576
    s_cbranch_scc1 L_h1_f2a
    s_branch L_end
L_h1_f2b:
    buffer_load_dwordx4 v[16:19], v1, s[52:55], s22 offen sc1
    buffer_load_dwordx4 v[20:23], v1, s[52:55], s22 offen offset:1024 sc1
    s_waitcnt vmcnt(3)
    v_mfma_f32_16x16x32_bf16 v[116:119], v[72:75], v[100:103], 0
    v_bitop3_b32 v127, v100, v102, s17 bitop3:0x7e
    s_waitcnt vmcnt(2)
    v_mfma_f32_16x16x32_bf16 v[116:119], v[72:75], v[104:107], v[116:119]
    v_bitop3_b32 v120, v104, v106, s17 bitop3:0x7e
    v_bitop3_b32 v127, v127, v120, 1 bitop3:0xa8
    v_cmp_ne_u32 vcc, 0, v127
    s_cbranch_vccnz L_h1_f2f
    v_add_f32_dpp v116, v116, v116 row_ror:4 row_mask:0xf bank_mask:0xf
    v_add_f32_dpp v117, v117, v117 row_ror:4 row_mask:0xf bank_mask:0xf
    s_nop 0
    v_add_f32_dpp v116, v116, v116 row_ror:8 row_mask:0xf bank_mask:0xf
    v_add_f32_dpp v117, v117, v117 row_ror:8 row_mask:0xf bank_mask:0xf
    v_cvt_pk_bf16_f32 v116, v116, v117
    v_min_u32 v116, -2, v116
    buffer_store_dword v116, v4, s[52:55], s25 offen
    s_branch L_h1_f2_ok
L_lf_f2:
    s_mov_b32 s13, 0
L_lf1_f2:
    buffer_load_dwordx4 v[104:107], v1, s[52:55], s92 offen offset:2048 sc1
    s_waitcnt vmcnt(0)
    v_max3_u32 v127, v104, v105, v106
    v_max_u32 v127, v127, v107
    v_cmp_eq_u32 vcc, -1, v127
    ds_write_b128 v14, v[104:107] offset:6144
    s_cbranch_vccz L_lr_f2
    s_add_u32 s13, s13, 1
    s_cmp_lt_u32 s13, 1048576
    s_cbranch_scc1 L_lf1_f2
    s_branch L_end
L_c62_f2:
    s_mov_b32 s24, s28
    ds_read_b128 v[108:111], v8 offset:384
    buffer_store_dword v122, v11, s[52:55], s24 offen sc1
    buffer_store_dword v124, v11, s[52:55], s24 offen offset:256 sc1
    s_waitcnt lgkmcnt(0)
    buffer_store_dwordx4 v[108:111], v10, s[52:55], s24 offen sc1
    s_branch L_c62r_f2
L_h2b_f3_fail:
    buffer_load_dwordx4 v[20:23], v1, s[52:55], s25 offen offset:3072 sc1
    s_add_u32 s13, s13, 1
    s_nop 4
    v_mov_b64 v[48:49], 0
    v_mov_b64 v[50:51], 0
    v_mov_b64 v[52:53], 0
    v_mov_b64 v[54:55], 0
    s_cmp_lt_u32 s13, 1048576
    s_cbranch_scc1 L_h2a_f3
    s_branch L_end
.p2align 6
    s_nop 0
    s_nop 0
    s_nop 0
L_h2b_f3:
    buffer_load_dwordx4 v[16:19], v1, s[52:55], s25 offen offset:3072 sc1
    s_nop 5
    v_mov_b64 v[48:49], 0
    v_mov_b64 v[50:51], 0
    v_mov_b64 v[52:53], 0
    v_mov_b64 v[54:55], 0
    s_waitcnt vmcnt(1)
L_h2b_f3_go:
    v_max3_u32 v127, v20, v21, v22
    v_max_u32 v127, v127, v23
    v_cmp_eq_u32 vcc, -1, v127
    v_smfmac_f32_16x16x64_bf16 v[48:51], v[20:23], v[24:31], v2
    ds_write_b128 v14, v[20:23] offset:3072
    v_smfmac_f32_16x16x64_bf16 v[52:55], v[20:23], v[32:39], v2
    s_cbranch_vccnz L_h2b_f3_fail
    v_smfmac_f32_16x16x64_bf16 v[56:59], v[20:23], v[40:47], v2
    buffer_load_dwordx4 v[104:107], v1, s[52:55], s92 offen offset:3072 sc1
    s_waitcnt lgkmcnt(0)
    s_barrier
    ds_read_b128 v[24:27], v14 offset:2048
    v_smfmac_f32_16x16x64_bf16 v[60:63], v[20:23], v[76:83], v2
    ds_read_b128 v[28:31], v14 offset:1024
    v_smfmac_f32_16x16x64_bf16 v[64:67], v[20:23], v[84:91], v2
    ds_read_b128 v[32:35], v14 offset:0
    v_smfmac_f32_16x16x64_bf16 v[68:71], v[20:23], v[92:99], v2
    s_branch L_cbody_f3
.p2align 6
    s_nop 0
    s_nop 0
    s_nop 0
L_h2a_f3:
    s_waitcnt vmcnt(1)
L_h2a_f3_go:
    v_max3_u32 v127, v16, v17, v18
    v_max_u32 v127, v127, v19
    v_cmp_eq_u32 vcc, -1, v127
    v_smfmac_f32_16x16x64_bf16 v[48:51], v[16:19], v[24:31], v2
    ds_write_b128 v14, v[16:19] offset:3072
    v_smfmac_f32_16x16x64_bf16 v[52:55], v[16:19], v[32:39], v2
    s_cbranch_vccnz L_h2b_f3
    v_smfmac_f32_16x16x64_bf16 v[56:59], v[16:19], v[40:47], v2
    buffer_load_dwordx4 v[104:107], v1, s[52:55], s92 offen offset:3072 sc1
    s_waitcnt lgkmcnt(0)
    s_barrier
    ds_read_b128 v[24:27], v14 offset:2048
    v_smfmac_f32_16x16x64_bf16 v[60:63], v[16:19], v[76:83], v2
    ds_read_b128 v[28:31], v14 offset:1024
    v_smfmac_f32_16x16x64_bf16 v[64:67], v[16:19], v[84:91], v2
    ds_read_b128 v[32:35], v14 offset:0
    v_smfmac_f32_16x16x64_bf16 v[68:71], v[16:19], v[92:99], v2
L_cbody_f3:
    s_waitcnt lgkmcnt(2)
    v_smfmac_f32_16x16x64_bf16 v[48:51], v[24:27], a[16:23], v2
    v_smfmac_f32_16x16x64_bf16 v[52:55], v[24:27], a[80:87], v2
    v_smfmac_f32_16x16x64_bf16 v[56:59], v[24:27], a[144:151], v2
    s_waitcnt lgkmcnt(0)
    v_smfmac_f32_16x16x64_bf16 v[60:63], v[24:27], a[208:215], v2
    buffer_load_dwordx4 v1, s[52:55], s21 offen sc1 lds
    v_smfmac_f32_16x16x64_bf16 v[48:51], v[28:31], a[24:31], v2
    v_smfmac_f32_16x16x64_bf16 v[52:55], v[28:31], a[88:95], v2
    buffer_load_dwordx4 v[16:19], v1, s[52:55], s20 offen sc1
    v_smfmac_f32_16x16x64_bf16 v[56:59], v[28:31], a[152:159], v2
    v_smfmac_f32_16x16x64_bf16 v[60:63], v[28:31], a[216:223], v2
    buffer_load_dwordx4 v1, s[52:55], s21 offen offset:1024 sc1 lds
    s_waitcnt vmcnt(3)
    v_max3_u32 v127, v104, v105, v106
    v_max_u32 v127, v127, v107
    v_cmp_eq_u32 vcc, -1, v127
    v_smfmac_f32_16x16x64_bf16 v[48:51], v[32:35], a[32:39], v2
    buffer_load_dwordx4 v[20:23], v1, s[52:55], s20 offen offset:1024 sc1
    ds_write_b128 v14, v[104:107] offset:7168
    v_smfmac_f32_16x16x64_bf16 v[52:55], v[32:35], a[96:103], v2
    s_cbranch_vccnz L_lf_f3
L_lr_f3:
    v_smfmac_f32_16x16x64_bf16 v[48:51], v[104:107], a[8:15], v2
    v_smfmac_f32_16x16x64_bf16 v[52:55], v[104:107], a[72:79], v2
    v_smfmac_f32_16x16x64_bf16 v[56:59], v[104:107], a[136:143], v2
    s_waitcnt lgkmcnt(0)
    s_barrier
    ds_read_b128 v[36:39], v14 offset:6144
    v_smfmac_f32_16x16x64_bf16 v[60:63], v[104:107], a[200:207], v2
    ds_read_b128 v[40:43], v14 offset:5120
    v_smfmac_f32_16x16x64_bf16 v[64:67], v[104:107], v[136:143], v2
    ds_read_b128 v[44:47], v14 offset:4096
    v_smfmac_f32_16x16x64_bf16 v[68:71], v[104:107], v[200:207], v2
    buffer_store_dwordx4 v[72:75], v10, s[52:55], s24 offen sc1
    v_smfmac_f32_16x16x64_bf16 v[56:59], v[32:35], a[160:167], v2
    v_smfmac_f32_16x16x64_bf16 v[60:63], v[32:35], a[224:231], v2
    s_waitcnt lgkmcnt(0)
    v_smfmac_f32_16x16x64_bf16 v[48:51], v[36:39], a[40:47], v2
    v_smfmac_f32_16x16x64_bf16 v[52:55], v[36:39], a[104:111], v2
    buffer_store_dword v122, v11, s[52:55], s24 offen sc1
    ds_read_b128 v[92:95], v15 offset:0
    v_smfmac_f32_16x16x64_bf16 v[48:51], v[40:43], a[48:55], v2
    ds_read_b128 v[96:99], v15 offset:1024
    v_smfmac_f32_16x16x64_bf16 v[52:55], v[40:43], a[112:119], v2
    ds_read_b128 v[100:103], v15 offset:2048
    v_smfmac_f32_16x16x64_bf16 v[48:51], v[44:47], a[56:63], v2
    ds_read_b128 v[104:107], v15 offset:3072
    v_smfmac_f32_16x16x64_bf16 v[52:55], v[44:47], a[120:127], v2
    buffer_store_dword v124, v11, s[52:55], s24 offen offset:256 sc1
    v_smfmac_f32_16x16x64_bf16 v[56:59], v[36:39], a[168:175], v2
    v_add_f32 v48, v48, v50
    v_smfmac_f32_16x16x64_bf16 v[60:63], v[36:39], a[232:239], v2
    v_add_f32 v49, v49, v51
    v_smfmac_f32_16x16x64_bf16 v[56:59], v[40:43], a[176:183], v2
    v_add_f32 v52, v52, v54
    v_smfmac_f32_16x16x64_bf16 v[60:63], v[40:43], a[240:247], v2
    v_add_f32 v53, v53, v55
    v_smfmac_f32_16x16x64_bf16 v[56:59], v[44:47], a[184:191], v2
    v_cvt_pk_bf16_f32 v118, v48, v52
    v_smfmac_f32_16x16x64_bf16 v[60:63], v[44:47], a[248:255], v2
    v_cvt_pk_bf16_f32 v119, v49, v53
    v_smfmac_f32_16x16x64_bf16 v[64:67], v[24:27], v[144:151], v2
    ds_write2_b32 v6, v118, v119 offset0:0 offset1:136
    v_add_f32 v56, v56, v58
    v_add_f32 v57, v57, v59
    v_smfmac_f32_16x16x64_bf16 v[68:71], v[24:27], v[208:215], v2
    v_add_f32 v60, v60, v62
    v_add_f32 v61, v61, v63
    v_cvt_pk_bf16_f32 v116, v56, v60
    v_cvt_pk_bf16_f32 v117, v57, v61
    v_smfmac_f32_16x16x64_bf16 v[64:67], v[28:31], v[152:159], v2
    ds_write2_b32 v6, v116, v117 offset0:64 offset1:200
    v_smfmac_f32_16x16x64_bf16 v[68:71], v[28:31], v[216:223], v2
    buffer_store_dword v5, v4, s[52:55], s26 offen
    v_smfmac_f32_16x16x64_bf16 v[64:67], v[32:35], v[160:167], v2
    v_smfmac_f32_16x16x64_bf16 v[68:71], v[32:35], v[224:231], v2
    s_cmp_eq_u32 s16, 63
    v_smfmac_f32_16x16x64_bf16 v[64:67], v[36:39], v[168:175], v2
    s_waitcnt lgkmcnt(0)
    s_barrier
    ds_read_b128 v[76:79], v8 offset:0
    v_smfmac_f32_16x16x64_bf16 v[68:71], v[36:39], v[232:239], v2
    ds_read_b128 v[80:83], v8 offset:64
    v_smfmac_f32_16x16x64_bf16 v[64:67], v[40:43], v[176:183], v2
    ds_read_b128 v[84:87], v8 offset:128
    v_smfmac_f32_16x16x64_bf16 v[68:71], v[40:43], v[240:247], v2
    ds_read_b128 v[88:91], v8 offset:192
    v_smfmac_f32_16x16x64_bf16 v[64:67], v[44:47], v[184:191], v2
    ds_read_b128 v[24:27], v8 offset:256
    v_smfmac_f32_16x16x64_bf16 v[68:71], v[44:47], v[248:255], v2
    s_cbranch_scc1 L_clast
    ds_read_b128 v[28:31], v8 offset:320
    s_waitcnt lgkmcnt(4)
    v_mfma_f32_16x16x32_bf16 v[48:51], v[92:95], v[76:79], 0
    ds_read_b128 v[56:59], v8 offset:384
    v_mfma_f32_16x16x32_bf16 v[48:51], v[96:99], v[80:83], v[48:51]
    ds_read_b128 v[60:63], v8 offset:448
    s_waitcnt lgkmcnt(4)
    v_mfma_f32_16x16x32_bf16 v[48:51], v[100:103], v[84:87], v[48:51]
    ds_read_b128 v[92:95], v15 offset:4096
    v_add_f32 v64, v64, v66
    v_mfma_f32_16x16x32_bf16 v[48:51], v[104:107], v[88:91], v[48:51]
    ds_read_b128 v[96:99], v15 offset:5120
    s_waitcnt lgkmcnt(4)
    v_mfma_f32_16x16x32_bf16 v[72:75], v[24:27], v[76:79], 0
    ds_read_b128 v[100:103], v15 offset:6144
    v_add_f32 v65, v65, v67
    v_mfma_f32_16x16x32_bf16 v[72:75], v[28:31], v[80:83], v[72:75]
    ds_read_b128 v[104:107], v15 offset:7168
    s_waitcnt lgkmcnt(4)
    v_mfma_f32_16x16x32_bf16 v[72:75], v[56:59], v[84:87], v[72:75]
    v_add_f32 v68, v68, v70
    v_add_f32 v69, v69, v71
    v_mfma_f32_16x16x32_bf16 v[72:75], v[60:63], v[88:91], v[72:75]
    s_waitcnt lgkmcnt(2)
    v_cvt_pk_bf16_f32 v122, v64, v65
    v_mfma_f32_16x16x32_bf16 v[52:55], v[92:95], v[76:79], 0
    v_cvt_pk_bf16_f32 v124, v68, v69
    v_max3_f32 v118, v48, v49, v50
    v_mfma_f32_16x16x32_bf16 v[52:55], v[96:99], v[80:83], v[52:55]
    s_waitcnt lgkmcnt(0)
    v_mov_b32 v64, 0x3f803f80
    v_mfma_f32_16x16x32_bf16 v[52:55], v[100:103], v[84:87], v[52:55]
    ds_read_b128 v[24:27], v13 offset:38912
    v_max3_f32 v118, v118, v51, v72
    v_mfma_f32_16x16x32_bf16 v[52:55], v[104:107], v[88:91], v[52:55]
    ds_read_b128 v[28:31], v13 offset:39936
    ds_read_b128 v[32:35], v12 offset:2048
    v_mov_b32 v65, v64
    v_max_f32 v118, v118, v73
    v_mov_b64 v[66:67], v[64:65]
    v_mov_b64 v[68:69], 0
    v_mov_b64 v[70:71], 0
    s_nop 0
    v_max3_f32 v118, v118, v52, v53
    v_max3_f32 v74, v118, v54, v55
    v_mov_b32 v75, v74
    s_nop 1
    v_permlane16_swap_b32 v74, v75
    v_max_f32 v74, v74, v75
    v_mov_b32 v75, v74
    s_nop 1
    v_permlane32_swap_b32 v74, v75
    v_max_f32 v74, v74, v75
    v_mul_f32 v74, s32, v74
    v_pk_fma_f32 v[48:49], v[48:49], s[32:33], v[74:75] op_sel_hi:[1,1,0] neg_lo:[0,0,1] neg_hi:[0,0,1]
    v_pk_fma_f32 v[50:51], v[50:51], s[32:33], v[74:75] op_sel_hi:[1,1,0] neg_lo:[0,0,1] neg_hi:[0,0,1]
    v_pk_fma_f32 v[52:53], v[52:53], s[32:33], v[74:75] op_sel_hi:[1,1,0] neg_lo:[0,0,1] neg_hi:[0,0,1]
    v_pk_fma_f32 v[54:55], v[54:55], s[32:33], v[74:75] op_sel_hi:[1,1,0] neg_lo:[0,0,1] neg_hi:[0,0,1]
    v_pk_fma_f32 v[72:73], v[72:73], s[32:33], v[74:75] op_sel_hi:[1,1,0] neg_lo:[0,0,1] neg_hi:[0,0,1]
    v_exp_f32 v72, v72
    v_exp_f32 v73, v73
    v_exp_f32 v48, v48
    v_cvt_pk_bf16_f32 v120, v72, v73
    v_exp_f32 v49, v49
    v_exp_f32 v50, v50
    v_mfma_f32_16x16x16_bf16 v[72:75], v[64:65], v[120:121], 0
    ds_read_b128 v[36:39], v12 offset:3072
    v_exp_f32 v51, v51
    v_exp_f32 v52, v52
    v_mfma_f32_16x16x16_bf16 v[56:59], v[122:123], v[120:121], 0
    ds_read_b128 v[40:43], v12 offset:0
    v_exp_f32 v53, v53
    v_exp_f32 v54, v54
    v_mfma_f32_16x16x16_bf16 v[60:63], v[124:125], v[120:121], 0
    ds_read_b128 v[44:47], v12 offset:1024
    v_exp_f32 v55, v55
    v_cvt_pk_bf16_f32 v116, v48, v49
    v_cvt_pk_bf16_f32 v117, v50, v51
    v_cvt_pk_bf16_f32 v118, v52, v53
    v_cvt_pk_bf16_f32 v119, v54, v55
    v_mov_b64 v[48:49], 0
    v_mov_b64 v[50:51], 0
    v_mfma_f32_16x16x32_bf16 v[72:75], v[64:67], v[116:119], v[72:75]
    ds_read_b128 v[76:79], v12 offset:6144
    v_mov_b64 v[52:53], 0
    v_mfma_f32_16x16x32_bf16 v[56:59], v[108:111], v[116:119], v[56:59]
    ds_read_b128 v[80:83], v12 offset:7168
    v_mov_b64 v[54:55], 0
    v_mfma_f32_16x16x32_bf16 v[60:63], v[112:115], v[116:119], v[60:63]
    ds_read_b128 v[84:87], v12 offset:4096
    v_rcp_f32 v120, v72
    v_mov_b64 v[116:117], 0
    s_nop 0
    v_pk_mul_f32 v[56:57], v[56:57], v[120:121] op_sel_hi:[1,0]
    v_pk_mul_f32 v[58:59], v[58:59], v[120:121] op_sel_hi:[1,0]
    v_cvt_pk_bf16_f32 v56, v56, v57
    v_cvt_pk_bf16_f32 v57, v58, v59
    v_pk_mul_f32 v[60:61], v[60:61], v[120:121] op_sel_hi:[1,0]
    v_pk_mul_f32 v[62:63], v[62:63], v[120:121] op_sel_hi:[1,0]
    v_cvt_pk_bf16_f32 v58, v60, v61
    v_cvt_pk_bf16_f32 v59, v62, v63
    v_cndmask_b32 v60, v56, v58, s[48:49]
    v_cndmask_b32 v61, v57, v59, s[48:49]
    ds_write_b64 v7, v[60:61] offset:1536
    s_waitcnt lgkmcnt(1)
    v_smfmac_f32_16x16x64_bf16 v[48:51], v[56:59], a[64:71], v2
    ds_read_b128 v[88:91], v12 offset:5120
    v_mov_b64 v[118:119], 0
    v_smfmac_f32_16x16x64_bf16 v[52:55], v[56:59], a[192:199], v2
    ds_read_b128 v[92:95], v12 offset:10240
    v_smfmac_f32_16x16x64_bf16 v[68:71], v[56:59], v[192:199], v2
    ds_read_b128 v[96:99], v12 offset:11264
    s_waitcnt lgkmcnt(3)
    s_barrier
    ds_read_b128 v[60:63], v9 offset:1024
    ds_read_b128 v[64:67], v9 offset:512
    ds_read_b128 v[72:75], v9 offset:0
    v_smfmac_f32_16x16x64_bf16 v[116:119], v[56:59], v[24:31], v2
    s_cmp_eq_u32 s16, 62
    s_cbranch_scc1 L_c62_f3
L_c62r_f3:
    s_waitcnt lgkmcnt(2)
    v_smfmac_f32_16x16x64_bf16 v[48:51], v[60:63], a[0:7], v2
    ds_read_b128 v[100:103], v12 offset:8192
    s_waitcnt lgkmcnt(2)
    v_smfmac_f32_16x16x64_bf16 v[48:51], v[64:67], v[32:39], v2
    ds_read_b128 v[104:107], v12 offset:9216
    s_waitcnt lgkmcnt(2)
    v_smfmac_f32_16x16x64_bf16 v[48:51], v[72:75], v[40:47], v2
    ds_read_b128 v[108:111], v13 offset:36864
    ds_read_b128 v[112:115], v13 offset:37888
    v_smfmac_f32_16x16x64_bf16 v[52:55], v[60:63], a[128:135], v2
    ds_read_b128 v[24:27], v12 offset:14336
    ds_read_b128 v[28:31], v12 offset:15360
    v_smfmac_f32_16x16x64_bf16 v[52:55], v[64:67], v[76:83], v2
    v_cvt_pk_bf16_f32 v48, v48, v49
    v_cvt_pk_bf16_f32 v49, v50, v51
    v_and_or_b32 v48, v48, -2, s17
    v_smfmac_f32_16x16x64_bf16 v[52:55], v[72:75], v[84:91], v2
    buffer_store_dwordx2 v[48:49], v3, s[52:55], s18 offen offset:0
    s_waitcnt lgkmcnt(4)
    v_smfmac_f32_16x16x64_bf16 v[68:71], v[60:63], v[128:135], v2
    ds_read_b128 v[32:35], v12 offset:12288
    ds_read_b128 v[36:39], v12 offset:13312
    v_smfmac_f32_16x16x64_bf16 v[68:71], v[64:67], v[92:99], v2
    v_cvt_pk_bf16_f32 v52, v52, v53
    v_cvt_pk_bf16_f32 v53, v54, v55
    v_and_or_b32 v52, v52, -2, s17
    v_smfmac_f32_16x16x64_bf16 v[68:71], v[72:75], v[100:107], v2
    buffer_store_dwordx2 v[52:53], v3, s[52:55], s18 offen offset:2048
    s_waitcnt lgkmcnt(2)
    v_smfmac_f32_16x16x64_bf16 v[116:119], v[60:63], v[108:115], v2
    v_smfmac_f32_16x16x64_bf16 v[116:119], v[64:67], v[24:31], v2
    v_cvt_pk_bf16_f32 v68, v68, v69
    v_cvt_pk_bf16_f32 v69, v70, v71
    v_and_or_b32 v68, v68, -2, s17
    s_waitcnt lgkmcnt(0)
    v_smfmac_f32_16x16x64_bf16 v[116:119], v[72:75], v[32:39], v2
    buffer_store_dwordx2 v[68:69], v3, s[52:55], s19 offen offset:0
    s_nop 6
    v_cvt_pk_bf16_f32 v116, v116, v117
    v_cvt_pk_bf16_f32 v117, v118, v119
    v_and_or_b32 v116, v116, -2, s17
    buffer_store_dwordx2 v[116:117], v3, s[52:55], s19 offen offset:2048
    ds_read_b128 v[72:75], v14 offset:31232
    s_waitcnt vmcnt(8)
    v_mov_b64 v[108:109], v[16:17]
    v_mov_b64 v[110:111], v[18:19]
    v_mov_b64 v[112:113], v[20:21]
    v_mov_b64 v[114:115], v[22:23]
    v_mov_b64 v[48:49], 0
    v_mov_b64 v[50:51], 0
    v_mov_b64 v[52:53], 0
    v_mov_b64 v[54:55], 0
    v_mov_b64 v[56:57], 0
    v_mov_b64 v[58:59], 0
    v_mov_b64 v[60:61], 0
    v_mov_b64 v[62:63], 0
    v_mov_b64 v[68:69], 0
    v_mov_b64 v[70:71], 0
    v_mov_b64 v[64:65], 0
    v_mov_b64 v[66:67], 0
    v_xor_b32 v15, 0x6000, v15
    s_add_u32 s16, s16, 1
    s_add_u32 s20, s20, 524288
    s_add_u32 s21, s21, 524288
    s_mov_b32 s24, s28
    s_add_u32 s28, s28, 131072
    s_xor_b32 s31, s31, 0x6000
    s_mov_b32 m0, s31
    s_mov_b32 s13, 0
    s_mov_b32 s26, s25
    s_and_b32 s15, s16, 3
    s_lshl_b32 s15, s15, 13
    s_add_u32 s25, s23, s15
    s_add_u32 s92, s25, 4096
    s_cmp_eq_u32 s16, 63
    s_cselect_b32 s21, 0x40000000, s21
    s_cselect_b32 s20, 0x40000000, s20
    ds_read_b128 v[24:27], v13 offset:0
    ds_read_b128 v[28:31], v13 offset:1024
    ds_read_b128 v[32:35], v13 offset:2048
    ds_read_b128 v[36:39], v13 offset:3072
    ds_read_b128 v[40:43], v13 offset:4096
    ds_read_b128 v[44:47], v13 offset:5120
    ds_read_b128 v[76:79], v13 offset:6144
    ds_read_b128 v[80:83], v13 offset:7168
    ds_read_b128 v[84:87], v13 offset:32768
    ds_read_b128 v[88:91], v13 offset:33792
    ds_read_b128 v[92:95], v13 offset:34816
    buffer_load_dwordx4 v[16:19], v1, s[52:55], s22 offen sc1
    buffer_load_dwordx4 v[20:23], v1, s[52:55], s22 offen offset:1024 sc1
    ds_read_b128 v[96:99], v13 offset:35840
    s_nop 15
    s_nop 13
    buffer_load_dwordx4 v[100:103], v1, s[52:55], s22 offen sc1
    buffer_load_dwordx4 v[104:107], v1, s[52:55], s22 offen offset:1024 sc1
    s_waitcnt lgkmcnt(0)
L_h1_f3a:
    s_waitcnt vmcnt(3)
    v_mfma_f32_16x16x32_bf16 v[116:119], v[72:75], v[16:19], 0
    v_bitop3_b32 v127, v16, v18, s17 bitop3:0x7e
    s_waitcnt vmcnt(2)
    v_mfma_f32_16x16x32_bf16 v[116:119], v[72:75], v[20:23], v[116:119]
    v_bitop3_b32 v120, v20, v22, s17 bitop3:0x7e
    v_bitop3_b32 v127, v127, v120, 1 bitop3:0xa8
    v_cmp_ne_u32 vcc, 0, v127
    s_cbranch_vccnz L_h1_f3b
    v_add_f32_dpp v116, v116, v116 row_ror:4 row_mask:0xf bank_mask:0xf
    v_add_f32_dpp v117, v117, v117 row_ror:4 row_mask:0xf bank_mask:0xf
    s_nop 0
    v_add_f32_dpp v116, v116, v116 row_ror:8 row_mask:0xf bank_mask:0xf
    v_add_f32_dpp v117, v117, v117 row_ror:8 row_mask:0xf bank_mask:0xf
    v_cvt_pk_bf16_f32 v116, v116, v117
    v_min_u32 v116, -2, v116
    buffer_store_dword v116, v4, s[52:55], s25 offen
L_h1_f3_ok:
    s_xor_b32 s17, s17, 1
    s_mov_b32 s13, 0
    ds_read_b128 v[72:75], v8 offset:448
    s_nop 15
    s_nop 2
    buffer_load_dwordx4 v[16:19], v1, s[52:55], s25 offen offset:3072 sc1
    s_nop 15
    s_nop 12
    buffer_load_dwordx4 v[20:23], v1, s[52:55], s25 offen offset:3072 sc1
    s_waitcnt lgkmcnt(0)
    s_branch L_h2a_f3
L_h1_f3f:
    buffer_load_dwordx4 v[100:103], v1, s[52:55], s22 offen sc1
    buffer_load_dwordx4 v[104:107], v1, s[52:55], s22 offen offset:1024 sc1
    s_add_u32 s13, s13, 1
    s_cmp_lt_u32 s13, 1048576
    s_cbranch_scc1 L_h1_f3a
    s_branch L_end
L_h1_f3b:
    buffer_load_dwordx4 v[16:19], v1, s[52:55], s22 offen sc1
    buffer_load_dwordx4 v[20:23], v1, s[52:55], s22 offen offset:1024 sc1
    s_waitcnt vmcnt(3)
    v_mfma_f32_16x16x32_bf16 v[116:119], v[72:75], v[100:103], 0
    v_bitop3_b32 v127, v100, v102, s17 bitop3:0x7e
    s_waitcnt vmcnt(2)
    v_mfma_f32_16x16x32_bf16 v[116:119], v[72:75], v[104:107], v[116:119]
    v_bitop3_b32 v120, v104, v106, s17 bitop3:0x7e
    v_bitop3_b32 v127, v127, v120, 1 bitop3:0xa8
    v_cmp_ne_u32 vcc, 0, v127
    s_cbranch_vccnz L_h1_f3f
    v_add_f32_dpp v116, v116, v116 row_ror:4 row_mask:0xf bank_mask:0xf
    v_add_f32_dpp v117, v117, v117 row_ror:4 row_mask:0xf bank_mask:0xf
    s_nop 0
    v_add_f32_dpp v116, v116, v116 row_ror:8 row_mask:0xf bank_mask:0xf
    v_add_f32_dpp v117, v117, v117 row_ror:8 row_mask:0xf bank_mask:0xf
    v_cvt_pk_bf16_f32 v116, v116, v117
    v_min_u32 v116, -2, v116
    buffer_store_dword v116, v4, s[52:55], s25 offen
    s_branch L_h1_f3_ok
L_lf_f3:
    s_mov_b32 s13, 0
L_lf1_f3:
    buffer_load_dwordx4 v[104:107], v1, s[52:55], s92 offen offset:3072 sc1
    s_waitcnt vmcnt(0)
    v_max3_u32 v127, v104, v105, v106
    v_max_u32 v127, v127, v107
    v_cmp_eq_u32 vcc, -1, v127
    ds_write_b128 v14, v[104:107] offset:7168
    s_cbranch_vccz L_lr_f3
    s_add_u32 s13, s13, 1
    s_cmp_lt_u32 s13, 1048576
    s_cbranch_scc1 L_lf1_f3
    s_branch L_end
L_c62_f3:
    s_mov_b32 s24, s28
    ds_read_b128 v[108:111], v8 offset:448
    buffer_store_dword v122, v11, s[52:55], s24 offen sc1
    buffer_store_dword v124, v11, s[52:55], s24 offen offset:256 sc1
    s_waitcnt lgkmcnt(0)
    buffer_store_dwordx4 v[108:111], v10, s[52:55], s24 offen sc1
    s_branch L_c62r_f3
L_h2b_s0_fail:
    buffer_load_dwordx4 v[20:23], v1, s[52:55], s25 offen offset:0 sc1
    s_add_u32 s13, s13, 1
    s_nop 4
    v_mov_b64 v[48:49], 0
    v_mov_b64 v[50:51], 0
    v_mov_b64 v[52:53], 0
    v_mov_b64 v[54:55], 0
    s_cmp_lt_u32 s13, 1048576
    s_cbranch_scc1 L_h2a_s0
    s_branch L_end
.p2align 6
    s_nop 0
    s_nop 0
    s_nop 0
L_h2b_s0:
    buffer_load_dwordx4 v[16:19], v1, s[52:55], s25 offen offset:0 sc1
    s_nop 5
    v_mov_b64 v[48:49], 0
    v_mov_b64 v[50:51], 0
    v_mov_b64 v[52:53], 0
    v_mov_b64 v[54:55], 0
    s_waitcnt vmcnt(1)
L_h2b_s0_go:
    v_max3_u32 v127, v20, v21, v22
    v_max_u32 v127, v127, v23
    v_cmp_eq_u32 vcc, -1, v127
    v_smfmac_f32_16x16x64_bf16 v[48:51], v[20:23], v[24:31], v2
    ds_write_b128 v14, v[20:23] offset:0
    v_smfmac_f32_16x16x64_bf16 v[52:55], v[20:23], v[32:39], v2
    s_cbranch_vccnz L_h2b_s0_fail
    v_smfmac_f32_16x16x64_bf16 v[56:59], v[20:23], v[40:47], v2
    buffer_load_dwordx4 v[104:107], v1, s[52:55], s92 offen offset:0 sc1
    s_waitcnt lgkmcnt(0)
    s_barrier
    ds_read_b128 v[24:27], v14 offset:1024
    v_smfmac_f32_16x16x64_bf16 v[60:63], v[20:23], v[76:83], v2
    ds_read_b128 v[28:31], v14 offset:2048
    v_smfmac_f32_16x16x64_bf16 v[64:67], v[20:23], v[84:91], v2
    ds_read_b128 v[32:35], v14 offset:3072
    v_smfmac_f32_16x16x64_bf16 v[68:71], v[20:23], v[92:99], v2
    s_branch L_cbody_s0
.p2align 6
    s_nop 0
    s_nop 0
    s_nop 0
L_h2a_s0:
    s_waitcnt vmcnt(1)
L_h2a_s0_go:
    v_max3_u32 v127, v16, v17, v18
    v_max_u32 v127, v127, v19
    v_cmp_eq_u32 vcc, -1, v127
    v_smfmac_f32_16x16x64_bf16 v[48:51], v[16:19], v[24:31], v2
    ds_write_b128 v14, v[16:19] offset:0
    v_smfmac_f32_16x16x64_bf16 v[52:55], v[16:19], v[32:39], v2
    s_cbranch_vccnz L_h2b_s0
    v_smfmac_f32_16x16x64_bf16 v[56:59], v[16:19], v[40:47], v2
    buffer_load_dwordx4 v[104:107], v1, s[52:55], s92 offen offset:0 sc1
    s_waitcnt lgkmcnt(0)
    s_barrier
    ds_read_b128 v[24:27], v14 offset:1024
    v_smfmac_f32_16x16x64_bf16 v[60:63], v[16:19], v[76:83], v2
    ds_read_b128 v[28:31], v14 offset:2048
    v_smfmac_f32_16x16x64_bf16 v[64:67], v[16:19], v[84:91], v2
    ds_read_b128 v[32:35], v14 offset:3072
    v_smfmac_f32_16x16x64_bf16 v[68:71], v[16:19], v[92:99], v2
L_cbody_s0:
    s_waitcnt lgkmcnt(2)
    v_smfmac_f32_16x16x64_bf16 v[48:51], v[24:27], a[16:23], v2
    buffer_load_dwordx4 v1, s[52:55], s21 offen sc1 lds
    v_smfmac_f32_16x16x64_bf16 v[52:55], v[24:27], a[80:87], v2
    buffer_load_dword v126, off, s[52:55], s85 sc1
    v_smfmac_f32_16x16x64_bf16 v[56:59], v[24:27], a[144:151], v2
    buffer_load_dwordx4 v[16:19], v1, s[52:55], s20 offen sc1
    s_waitcnt lgkmcnt(0)
    v_smfmac_f32_16x16x64_bf16 v[60:63], v[24:27], a[208:215], v2
    v_smfmac_f32_16x16x64_bf16 v[48:51], v[28:31], a[24:31], v2
    buffer_load_dwordx4 v1, s[52:55], s21 offen offset:1024 sc1 lds
    v_smfmac_f32_16x16x64_bf16 v[52:55], v[28:31], a[88:95], v2
    v_smfmac_f32_16x16x64_bf16 v[56:59], v[28:31], a[152:159], v2
    buffer_load_dwordx4 v[20:23], v1, s[52:55], s20 offen offset:1024 sc1
    v_smfmac_f32_16x16x64_bf16 v[60:63], v[28:31], a[216:223], v2
    s_waitcnt vmcnt(5)
    v_max3_u32 v127, v104, v105, v106
    v_max_u32 v127, v127, v107
    v_cmp_eq_u32 vcc, -1, v127
    v_smfmac_f32_16x16x64_bf16 v[48:51], v[32:35], a[32:39], v2
    ds_write_b128 v14, v[104:107] offset:4096
    v_smfmac_f32_16x16x64_bf16 v[52:55], v[32:35], a[96:103], v2
    s_cbranch_vccnz L_lf_s0
L_lr_s0:
    v_smfmac_f32_16x16x64_bf16 v[48:51], v[104:107], a[8:15], v2
    v_smfmac_f32_16x16x64_bf16 v[52:55], v[104:107], a[72:79], v2
    v_smfmac_f32_16x16x64_bf16 v[56:59], v[104:107], a[136:143], v2
    buffer_store_dwordx4 v[72:75], v10, s[52:55], s24 offen sc1
    s_waitcnt lgkmcnt(0)
    s_barrier
    ds_read_b128 v[36:39], v14 offset:5120
    v_smfmac_f32_16x16x64_bf16 v[60:63], v[104:107], a[200:207], v2
    ds_read_b128 v[40:43], v14 offset:6144
    v_smfmac_f32_16x16x64_bf16 v[64:67], v[104:107], v[136:143], v2
    ds_read_b128 v[44:47], v14 offset:7168
    v_smfmac_f32_16x16x64_bf16 v[68:71], v[104:107], v[200:207], v2
    v_smfmac_f32_16x16x64_bf16 v[56:59], v[32:35], a[160:167], v2
    buffer_store_dword v122, v11, s[52:55], s24 offen sc1
    v_smfmac_f32_16x16x64_bf16 v[60:63], v[32:35], a[224:231], v2
    s_waitcnt lgkmcnt(0)
    v_smfmac_f32_16x16x64_bf16 v[48:51], v[36:39], a[40:47], v2
    v_smfmac_f32_16x16x64_bf16 v[52:55], v[36:39], a[104:111], v2
    ds_read_b128 v[92:95], v15 offset:0
    v_smfmac_f32_16x16x64_bf16 v[48:51], v[40:43], a[48:55], v2
    buffer_store_dword v124, v11, s[52:55], s24 offen offset:256 sc1
    ds_read_b128 v[96:99], v15 offset:1024
    v_smfmac_f32_16x16x64_bf16 v[52:55], v[40:43], a[112:119], v2
    ds_read_b128 v[100:103], v15 offset:2048
    v_smfmac_f32_16x16x64_bf16 v[48:51], v[44:47], a[56:63], v2
    ds_read_b128 v[104:107], v15 offset:3072
    v_smfmac_f32_16x16x64_bf16 v[52:55], v[44:47], a[120:127], v2
    v_smfmac_f32_16x16x64_bf16 v[56:59], v[36:39], a[168:175], v2
    v_add_f32 v48, v48, v50
    v_smfmac_f32_16x16x64_bf16 v[60:63], v[36:39], a[232:239], v2
    v_add_f32 v49, v49, v51
    v_smfmac_f32_16x16x64_bf16 v[56:59], v[40:43], a[176:183], v2
    v_add_f32 v52, v52, v54
    v_smfmac_f32_16x16x64_bf16 v[60:63], v[40:43], a[240:247], v2
    v_add_f32 v53, v53, v55
    v_smfmac_f32_16x16x64_bf16 v[56:59], v[44:47], a[184:191], v2
    v_cvt_pk_bf16_f32 v118, v48, v52
    v_smfmac_f32_16x16x64_bf16 v[60:63], v[44:47], a[248:255], v2
    v_cvt_pk_bf16_f32 v119, v49, v53
    v_smfmac_f32_16x16x64_bf16 v[64:67], v[24:27], v[144:151], v2
    ds_write2_b32 v6, v118, v119 offset0:0 offset1:136
    v_add_f32 v56, v56, v58
    v_add_f32 v57, v57, v59
    v_smfmac_f32_16x16x64_bf16 v[68:71], v[24:27], v[208:215], v2
    v_add_f32 v60, v60, v62
    v_add_f32 v61, v61, v63
    v_cvt_pk_bf16_f32 v116, v56, v60
    v_cvt_pk_bf16_f32 v117, v57, v61
    v_smfmac_f32_16x16x64_bf16 v[64:67], v[28:31], v[152:159], v2
    ds_write2_b32 v6, v116, v117 offset0:64 offset1:200
    v_smfmac_f32_16x16x64_bf16 v[68:71], v[28:31], v[216:223], v2
    buffer_store_dword v5, v4, s[52:55], s26 offen sc1
    v_smfmac_f32_16x16x64_bf16 v[64:67], v[32:35], v[160:167], v2
    v_smfmac_f32_16x16x64_bf16 v[68:71], v[32:35], v[224:231], v2
    s_cmp_eq_u32 s16, 63
    v_smfmac_f32_16x16x64_bf16 v[64:67], v[36:39], v[168:175], v2
    s_waitcnt lgkmcnt(0)
    s_barrier
    ds_read_b128 v[76:79], v8 offset:0
    v_smfmac_f32_16x16x64_bf16 v[68:71], v[36:39], v[232:239], v2
    ds_read_b128 v[80:83], v8 offset:64
    v_smfmac_f32_16x16x64_bf16 v[64:67], v[40:43], v[176:183], v2
    ds_read_b128 v[84:87], v8 offset:128
    v_smfmac_f32_16x16x64_bf16 v[68:71], v[40:43], v[240:247], v2
    ds_read_b128 v[88:91], v8 offset:192
    v_smfmac_f32_16x16x64_bf16 v[64:67], v[44:47], v[184:191], v2
    ds_read_b128 v[24:27], v8 offset:256
    v_smfmac_f32_16x16x64_bf16 v[68:71], v[44:47], v[248:255], v2
    s_cbranch_scc1 L_clast
    ds_read_b128 v[28:31], v8 offset:320
    s_waitcnt lgkmcnt(4)
    v_mfma_f32_16x16x32_bf16 v[48:51], v[92:95], v[76:79], 0
    ds_read_b128 v[56:59], v8 offset:384
    v_mfma_f32_16x16x32_bf16 v[48:51], v[96:99], v[80:83], v[48:51]
    ds_read_b128 v[60:63], v8 offset:448
    s_waitcnt lgkmcnt(4)
    v_mfma_f32_16x16x32_bf16 v[48:51], v[100:103], v[84:87], v[48:51]
    ds_read_b128 v[92:95], v15 offset:4096
    v_add_f32 v64, v64, v66
    v_mfma_f32_16x16x32_bf16 v[48:51], v[104:107], v[88:91], v[48:51]
    ds_read_b128 v[96:99], v15 offset:5120
    s_waitcnt lgkmcnt(4)
    v_mfma_f32_16x16x32_bf16 v[72:75], v[24:27], v[76:79], 0
    ds_read_b128 v[100:103], v15 offset:6144
    v_add_f32 v65, v65, v67
    v_mfma_f32_16x16x32_bf16 v[72:75], v[28:31], v[80:83], v[72:75]
    ds_read_b128 v[104:107], v15 offset:7168
    s_waitcnt lgkmcnt(4)
    v_mfma_f32_16x16x32_bf16 v[72:75], v[56:59], v[84:87], v[72:75]
    v_add_f32 v68, v68, v70
    v_add_f32 v69, v69, v71
    v_mfma_f32_16x16x32_bf16 v[72:75], v[60:63], v[88:91], v[72:75]
    s_waitcnt lgkmcnt(2)
    v_cvt_pk_bf16_f32 v122, v64, v65
    v_mfma_f32_16x16x32_bf16 v[52:55], v[92:95], v[76:79], 0
    v_cvt_pk_bf16_f32 v124, v68, v69
    v_max3_f32 v118, v48, v49, v50
    v_mfma_f32_16x16x32_bf16 v[52:55], v[96:99], v[80:83], v[52:55]
    s_waitcnt lgkmcnt(0)
    v_mov_b32 v64, 0x3f803f80
    v_mfma_f32_16x16x32_bf16 v[52:55], v[100:103], v[84:87], v[52:55]
    ds_read_b128 v[24:27], v12 offset:0
    v_max3_f32 v118, v118, v51, v72
    v_mfma_f32_16x16x32_bf16 v[52:55], v[104:107], v[88:91], v[52:55]
    ds_read_b128 v[28:31], v12 offset:1024
    ds_read_b128 v[32:35], v12 offset:4096
    v_mov_b32 v65, v64
    v_max_f32 v118, v118, v73
    v_mov_b64 v[66:67], v[64:65]
    v_mov_b64 v[68:69], 0
    v_mov_b64 v[70:71], 0
    s_nop 0
    v_max3_f32 v118, v118, v52, v53
    v_max3_f32 v74, v118, v54, v55
    v_mov_b32 v75, v74
    s_nop 1
    v_permlane16_swap_b32 v74, v75
    v_max_f32 v74, v74, v75
    v_mov_b32 v75, v74
    s_nop 1
    v_permlane32_swap_b32 v74, v75
    v_max_f32 v74, v74, v75
    v_mul_f32 v74, s32, v74
    v_pk_fma_f32 v[48:49], v[48:49], s[32:33], v[74:75] op_sel_hi:[1,1,0] neg_lo:[0,0,1] neg_hi:[0,0,1]
    v_pk_fma_f32 v[50:51], v[50:51], s[32:33], v[74:75] op_sel_hi:[1,1,0] neg_lo:[0,0,1] neg_hi:[0,0,1]
    v_pk_fma_f32 v[52:53], v[52:53], s[32:33], v[74:75] op_sel_hi:[1,1,0] neg_lo:[0,0,1] neg_hi:[0,0,1]
    v_pk_fma_f32 v[54:55], v[54:55], s[32:33], v[74:75] op_sel_hi:[1,1,0] neg_lo:[0,0,1] neg_hi:[0,0,1]
    v_pk_fma_f32 v[72:73], v[72:73], s[32:33], v[74:75] op_sel_hi:[1,1,0] neg_lo:[0,0,1] neg_hi:[0,0,1]
    v_exp_f32 v72, v72
    v_exp_f32 v73, v73
    v_exp_f32 v48, v48
    v_cvt_pk_bf16_f32 v120, v72, v73
    v_exp_f32 v49, v49
    v_exp_f32 v50, v50
    v_mfma_f32_16x16x16_bf16 v[72:75], v[64:65], v[120:121], 0
    ds_read_b128 v[36:39], v12 offset:5120
    v_exp_f32 v51, v51
    v_exp_f32 v52, v52
    v_mfma_f32_16x16x16_bf16 v[56:59], v[122:123], v[120:121], 0
    ds_read_b128 v[40:43], v12 offset:8192
    v_exp_f32 v53, v53
    v_exp_f32 v54, v54
    v_mfma_f32_16x16x16_bf16 v[60:63], v[124:125], v[120:121], 0
    ds_read_b128 v[44:47], v12 offset:9216
    v_exp_f32 v55, v55
    v_cvt_pk_bf16_f32 v116, v48, v49
    v_cvt_pk_bf16_f32 v117, v50, v51
    v_cvt_pk_bf16_f32 v118, v52, v53
    v_cvt_pk_bf16_f32 v119, v54, v55
    v_mov_b64 v[48:49], 0
    v_mov_b64 v[50:51], 0
    v_mfma_f32_16x16x32_bf16 v[72:75], v[64:67], v[116:119], v[72:75]
    ds_read_b128 v[76:79], v12 offset:12288
    v_mov_b64 v[52:53], 0
    v_mfma_f32_16x16x32_bf16 v[56:59], v[108:111], v[116:119], v[56:59]
    ds_read_b128 v[80:83], v12 offset:13312
    v_mov_b64 v[54:55], 0
    v_mfma_f32_16x16x32_bf16 v[60:63], v[112:115], v[116:119], v[60:63]
    ds_read_b128 v[84:87], v12 offset:2048
    v_rcp_f32 v120, v72
    v_mov_b64 v[116:117], 0
    s_nop 0
    v_pk_mul_f32 v[56:57], v[56:57], v[120:121] op_sel_hi:[1,0]
    v_pk_mul_f32 v[58:59], v[58:59], v[120:121] op_sel_hi:[1,0]
    v_cvt_pk_bf16_f32 v56, v56, v57
    v_cvt_pk_bf16_f32 v57, v58, v59
    v_pk_mul_f32 v[60:61], v[60:61], v[120:121] op_sel_hi:[1,0]
    v_pk_mul_f32 v[62:63], v[62:63], v[120:121] op_sel_hi:[1,0]
    v_cvt_pk_bf16_f32 v58, v60, v61
    v_cvt_pk_bf16_f32 v59, v62, v63
    v_cndmask_b32 v60, v56, v58, s[48:49]
    v_cndmask_b32 v61, v57, v59, s[48:49]
    ds_write_b64 v7, v[60:61] offset:0
    s_waitcnt lgkmcnt(1)
    v_smfmac_f32_16x16x64_bf16 v[48:51], v[56:59], v[24:31], v2
    ds_read_b128 v[88:91], v12 offset:3072
    v_mov_b64 v[118:119], 0
    v_smfmac_f32_16x16x64_bf16 v[52:55], v[56:59], v[32:39], v2
    ds_read_b128 v[92:95], v12 offset:6144
    v_smfmac_f32_16x16x64_bf16 v[68:71], v[56:59], v[40:47], v2
    ds_read_b128 v[96:99], v12 offset:7168
    s_waitcnt lgkmcnt(3)
    s_barrier
    ds_read_b128 v[60:63], v9 offset:512
    ds_read_b128 v[64:67], v9 offset:1024
    ds_read_b128 v[72:75], v9 offset:1536
    v_smfmac_f32_16x16x64_bf16 v[116:119], v[56:59], v[76:83], v2
    s_cmp_eq_u32 s16, 62
    s_cbranch_scc1 L_c62_s0
L_c62r_s0:
    s_waitcnt lgkmcnt(2)
    v_smfmac_f32_16x16x64_bf16 v[48:51], v[60:63], v[84:91], v2
    ds_read_b128 v[100:103], v12 offset:10240
    s_waitcnt lgkmcnt(2)
    v_smfmac_f32_16x16x64_bf16 v[48:51], v[64:67], a[0:7], v2
    ds_read_b128 v[104:107], v12 offset:11264
    s_waitcnt lgkmcnt(2)
    v_smfmac_f32_16x16x64_bf16 v[48:51], v[72:75], a[64:71], v2
    ds_read_b128 v[108:111], v12 offset:14336
    ds_read_b128 v[112:115], v12 offset:15360
    v_smfmac_f32_16x16x64_bf16 v[52:55], v[60:63], v[92:99], v2
    ds_read_b128 v[24:27], v13 offset:36864
    ds_read_b128 v[28:31], v13 offset:37888
    v_smfmac_f32_16x16x64_bf16 v[52:55], v[64:67], a[128:135], v2
    v_cvt_pk_bf16_f32 v48, v48, v49
    v_cvt_pk_bf16_f32 v49, v50, v51
    v_and_or_b32 v48, v48, -2, s17
    v_smfmac_f32_16x16x64_bf16 v[52:55], v[72:75], a[192:199], v2
    buffer_store_dwordx2 v[48:49], v3, s[52:55], s18 offen offset:0 sc1
    s_waitcnt lgkmcnt(4)
    v_smfmac_f32_16x16x64_bf16 v[68:71], v[60:63], v[100:107], v2
    ds_read_b128 v[32:35], v13 offset:38912
    ds_read_b128 v[36:39], v13 offset:39936
    v_smfmac_f32_16x16x64_bf16 v[68:71], v[64:67], v[128:135], v2
    v_cvt_pk_bf16_f32 v52, v52, v53
    v_cvt_pk_bf16_f32 v53, v54, v55
    v_and_or_b32 v52, v52, -2, s17
    v_smfmac_f32_16x16x64_bf16 v[68:71], v[72:75], v[192:199], v2
    buffer_store_dwordx2 v[52:53], v3, s[52:55], s18 offen offset:2048 sc1
    s_waitcnt lgkmcnt(2)
    v_smfmac_f32_16x16x64_bf16 v[116:119], v[60:63], v[108:115], v2
    v_smfmac_f32_16x16x64_bf16 v[116:119], v[64:67], v[24:31], v2
    v_cvt_pk_bf16_f32 v68, v68, v69
    v_cvt_pk_bf16_f32 v69, v70, v71
    v_and_or_b32 v68, v68, -2, s17
    s_waitcnt lgkmcnt(0)
    v_smfmac_f32_16x16x64_bf16 v[116:119], v[72:75], v[32:39], v2
    buffer_store_dwordx2 v[68:69], v3, s[52:55], s19 offen offset:0 sc1
    s_nop 6
    v_cvt_pk_bf16_f32 v116, v116, v117
    v_cvt_pk_bf16_f32 v117, v118, v119
    v_and_or_b32 v116, v116, -2, s17
    buffer_store_dwordx2 v[116:117], v3, s[52:55], s19 offen offset:2048 sc1
    ds_read_b128 v[72:75], v14 offset:31232
    s_waitcnt vmcnt(8)
    v_mov_b64 v[108:109], v[16:17]
    v_mov_b64 v[110:111], v[18:19]
    v_mov_b64 v[112:113], v[20:21]
    v_mov_b64 v[114:115], v[22:23]
    v_mov_b64 v[48:49], 0
    v_mov_b64 v[50:51], 0
    v_mov_b64 v[52:53], 0
    v_mov_b64 v[54:55], 0
    v_mov_b64 v[56:57], 0
    v_mov_b64 v[58:59], 0
    v_mov_b64 v[60:61], 0
    v_mov_b64 v[62:63], 0
    v_mov_b64 v[68:69], 0
    v_mov_b64 v[70:71], 0
    v_mov_b64 v[64:65], 0
    v_mov_b64 v[66:67], 0
    v_xor_b32 v15, 0x6000, v15
    s_add_u32 s16, s16, 1
    s_add_u32 s20, s20, 524288
    s_add_u32 s21, s21, 524288
    s_mov_b32 s24, s28
    s_add_u32 s28, s28, 131072
    s_xor_b32 s31, s31, 0x6000
    s_mov_b32 m0, s31
    s_mov_b32 s13, 0
    s_mov_b32 s26, s25
    s_and_b32 s15, s16, 3
    s_lshl_b32 s15, s15, 13
    s_add_u32 s25, s23, s15
    s_add_u32 s92, s25, 4096
    s_cmp_eq_u32 s16, 63
    s_cselect_b32 s21, 0x40000000, s21
    s_cselect_b32 s20, 0x40000000, s20
    s_add_u32 s35, s16, 3
    s_lshr_b32 s35, s35, 1
    s_min_u32 s35, s35, 32
    s_xor_b32 s85, s85, 4
    ds_read_b128 v[24:27], v13 offset:0
    buffer_load_dwordx4 v[16:19], v1, s[52:55], s22 offen sc1
    buffer_load_dwordx4 v[20:23], v1, s[52:55], s22 offen offset:1024 sc1
    ds_read_b128 v[28:31], v13 offset:1024
    ds_read_b128 v[32:35], v13 offset:2048
    ds_read_b128 v[36:39], v13 offset:3072
    ds_read_b128 v[40:43], v13 offset:4096
    ds_read_b128 v[44:47], v13 offset:5120
    ds_read_b128 v[76:79], v13 offset:6144
    ds_read_b128 v[80:83], v13 offset:7168
    ds_read_b128 v[84:87], v13 offset:32768
    ds_read_b128 v[88:91], v13 offset:33792
    ds_read_b128 v[92:95], v13 offset:34816
    ds_read_b128 v[96:99], v13 offset:35840
    s_nop 6
    buffer_load_dwordx4 v[100:103], v1, s[52:55], s22 offen sc1
    buffer_load_dwordx4 v[104:107], v1, s[52:55], s22 offen offset:1024 sc1
    s_waitcnt lgkmcnt(0)
L_h1_s0a:
    s_waitcnt vmcnt(3)
    v_mfma_f32_16x16x32_bf16 v[116:119], v[72:75], v[16:19], 0
    v_bitop3_b32 v127, v16, v18, s17 bitop3:0x7e
    s_waitcnt vmcnt(2)
    v_mfma_f32_16x16x32_bf16 v[116:119], v[72:75], v[20:23], v[116:119]
    v_bitop3_b32 v120, v20, v22, s17 bitop3:0x7e
    v_bitop3_b32 v127, v127, v120, 1 bitop3:0xa8
    v_cmp_ne_u32 vcc, 0, v127
    s_cbranch_vccnz L_h1_s0b
    v_add_f32_dpp v116, v116, v116 row_ror:4 row_mask:0xf bank_mask:0xf
    v_add_f32_dpp v117, v117, v117 row_ror:4 row_mask:0xf bank_mask:0xf
    s_nop 0
    v_add_f32_dpp v116, v116, v116 row_ror:8 row_mask:0xf bank_mask:0xf
    v_add_f32_dpp v117, v117, v117 row_ror:8 row_mask:0xf bank_mask:0xf
    v_cvt_pk_bf16_f32 v116, v116, v117
    v_min_u32 v116, -2, v116
    buffer_store_dword v116, v4, s[52:55], s25 offen sc1
L_h1_s0_ok:
    s_xor_b32 s17, s17, 1
    v_readfirstlane_b32 s14, v126
    s_nop 0
    s_cmp_ge_i32 s14, s35
    s_cbranch_scc0 L_h1_s0_kv
L_h1_s0_kvok:
    s_mov_b32 s13, 0
    ds_read_b128 v[72:75], v8 offset:256
    s_nop 15
    s_nop 15
    s_nop 0
    buffer_load_dwordx4 v[16:19], v1, s[52:55], s25 offen offset:0 sc1
    s_nop 15
    s_nop 9
    buffer_load_dwordx4 v[20:23], v1, s[52:55], s25 offen offset:0 sc1
    s_waitcnt lgkmcnt(0)
    s_branch L_h2a_s0
L_h1_s0f:
    buffer_load_dwordx4 v[100:103], v1, s[52:55], s22 offen sc1
    buffer_load_dwordx4 v[104:107], v1, s[52:55], s22 offen offset:1024 sc1
    s_add_u32 s13, s13, 1
    s_cmp_lt_u32 s13, 1048576
    s_cbranch_scc1 L_h1_s0a
    s_branch L_end
L_h1_s0b:
    buffer_load_dwordx4 v[16:19], v1, s[52:55], s22 offen sc1
    buffer_load_dwordx4 v[20:23], v1, s[52:55], s22 offen offset:1024 sc1
    s_waitcnt vmcnt(3)
    v_mfma_f32_16x16x32_bf16 v[116:119], v[72:75], v[100:103], 0
    v_bitop3_b32 v127, v100, v102, s17 bitop3:0x7e
    s_waitcnt vmcnt(2)
    v_mfma_f32_16x16x32_bf16 v[116:119], v[72:75], v[104:107], v[116:119]
    v_bitop3_b32 v120, v104, v106, s17 bitop3:0x7e
    v_bitop3_b32 v127, v127, v120, 1 bitop3:0xa8
    v_cmp_ne_u32 vcc, 0, v127
    s_cbranch_vccnz L_h1_s0f
    v_add_f32_dpp v116, v116, v116 row_ror:4 row_mask:0xf bank_mask:0xf
    v_add_f32_dpp v117, v117, v117 row_ror:4 row_mask:0xf bank_mask:0xf
    s_nop 0
    v_add_f32_dpp v116, v116, v116 row_ror:8 row_mask:0xf bank_mask:0xf
    v_add_f32_dpp v117, v117, v117 row_ror:8 row_mask:0xf bank_mask:0xf
    v_cvt_pk_bf16_f32 v116, v116, v117
    v_min_u32 v116, -2, v116
    buffer_store_dword v116, v4, s[52:55], s25 offen sc1
    s_branch L_h1_s0_ok
L_lf_s0:
    s_mov_b32 s13, 0
L_lf1_s0:
    buffer_load_dwordx4 v[104:107], v1, s[52:55], s92 offen offset:0 sc1
    s_waitcnt vmcnt(0)
    v_max3_u32 v127, v104, v105, v106
    v_max_u32 v127, v127, v107
    v_cmp_eq_u32 vcc, -1, v127
    ds_write_b128 v14, v[104:107] offset:4096
    s_cbranch_vccz L_lr_s0
    s_add_u32 s13, s13, 1
    s_cmp_lt_u32 s13, 1048576
    s_cbranch_scc1 L_lf1_s0
    s_branch L_end
L_c62_s0:
    s_mov_b32 s24, s28
    ds_read_b128 v[108:111], v8 offset:256
    buffer_store_dword v122, v11, s[52:55], s24 offen sc1
    buffer_store_dword v124, v11, s[52:55], s24 offen offset:256 sc1
    s_waitcnt lgkmcnt(0)
    buffer_store_dwordx4 v[108:111], v10, s[52:55], s24 offen sc1
    s_branch L_c62r_s0
L_h1_s0_kv:
    s_mov_b32 s13, 0
    s_xor_b32 s15, s85, 4
L_h1_s0_kvl:
    buffer_load_dword v126, off, s[52:55], s15 sc1
    s_waitcnt vmcnt(0)
    v_readfirstlane_b32 s14, v126
    s_nop 0
    s_cmp_ge_i32 s14, s35
    s_cbranch_scc1 L_h1_s0_kvok
    s_add_u32 s13, s13, 1
    s_cmp_lt_u32 s13, 1048576
    s_cbranch_scc1 L_h1_s0_kvl
    s_branch L_end
L_h2b_s1_fail:
    buffer_load_dwordx4 v[20:23], v1, s[52:55], s25 offen offset:1024 sc1
    s_add_u32 s13, s13, 1
    s_nop 4
    v_mov_b64 v[48:49], 0
    v_mov_b64 v[50:51], 0
    v_mov_b64 v[52:53], 0
    v_mov_b64 v[54:55], 0
    s_cmp_lt_u32 s13, 1048576
    s_cbranch_scc1 L_h2a_s1
    s_branch L_end
.p2align 6
    s_nop 0
    s_nop 0
    s_nop 0
L_h2b_s1:
    buffer_load_dwordx4 v[16:19], v1, s[52:55], s25 offen offset:1024 sc1
    s_nop 5
    v_mov_b64 v[48:49], 0
    v_mov_b64 v[50:51], 0
    v_mov_b64 v[52:53], 0
    v_mov_b64 v[54:55], 0
    s_waitcnt vmcnt(1)
L_h2b_s1_go:
    v_max3_u32 v127, v20, v21, v22
    v_max_u32 v127, v127, v23
    v_cmp_eq_u32 vcc, -1, v127
    v_smfmac_f32_16x16x64_bf16 v[48:51], v[20:23], v[24:31], v2
    ds_write_b128 v14, v[20:23] offset:1024
    v_smfmac_f32_16x16x64_bf16 v[52:55], v[20:23], v[32:39], v2
    s_cbranch_vccnz L_h2b_s1_fail
    v_smfmac_f32_16x16x64_bf16 v[56:59], v[20:23], v[40:47], v2
    buffer_load_dwordx4 v[104:107], v1, s[52:55], s92 offen offset:1024 sc1
    s_waitcnt lgkmcnt(0)
    s_barrier
    ds_read_b128 v[24:27], v14 offset:0
    v_smfmac_f32_16x16x64_bf16 v[60:63], v[20:23], v[76:83], v2
    ds_read_b128 v[28:31], v14 offset:3072
    v_smfmac_f32_16x16x64_bf16 v[64:67], v[20:23], v[84:91], v2
    ds_read_b128 v[32:35], v14 offset:2048
    v_smfmac_f32_16x16x64_bf16 v[68:71], v[20:23], v[92:99], v2
    s_branch L_cbody_s1
.p2align 6
    s_nop 0
    s_nop 0
    s_nop 0
L_h2a_s1:
    s_waitcnt vmcnt(1)
L_h2a_s1_go:
    v_max3_u32 v127, v16, v17, v18
    v_max_u32 v127, v127, v19
    v_cmp_eq_u32 vcc, -1, v127
    v_smfmac_f32_16x16x64_bf16 v[48:51], v[16:19], v[24:31], v2
    ds_write_b128 v14, v[16:19] offset:1024
    v_smfmac_f32_16x16x64_bf16 v[52:55], v[16:19], v[32:39], v2
    s_cbranch_vccnz L_h2b_s1
    v_smfmac_f32_16x16x64_bf16 v[56:59], v[16:19], v[40:47], v2
    buffer_load_dwordx4 v[104:107], v1, s[52:55], s92 offen offset:1024 sc1
    s_waitcnt lgkmcnt(0)
    s_barrier
    ds_read_b128 v[24:27], v14 offset:0
    v_smfmac_f32_16x16x64_bf16 v[60:63], v[16:19], v[76:83], v2
    ds_read_b128 v[28:31], v14 offset:3072
    v_smfmac_f32_16x16x64_bf16 v[64:67], v[16:19], v[84:91], v2
    ds_read_b128 v[32:35], v14 offset:2048
    v_smfmac_f32_16x16x64_bf16 v[68:71], v[16:19], v[92:99], v2
L_cbody_s1:
    s_waitcnt lgkmcnt(2)
    v_smfmac_f32_16x16x64_bf16 v[48:51], v[24:27], a[16:23], v2
    v_smfmac_f32_16x16x64_bf16 v[52:55], v[24:27], a[80:87], v2
    buffer_load_dwordx4 v1, s[52:55], s21 offen sc1 lds
    v_smfmac_f32_16x16x64_bf16 v[56:59], v[24:27], a[144:151], v2
    s_waitcnt lgkmcnt(0)
    v_smfmac_f32_16x16x64_bf16 v[60:63], v[24:27], a[208:215], v2
    buffer_load_dwordx4 v[16:19], v1, s[52:55], s20 offen sc1
    v_smfmac_f32_16x16x64_bf16 v[48:51], v[28:31], a[24:31], v2
    v_smfmac_f32_16x16x64_bf16 v[52:55], v[28:31], a[88:95], v2
    buffer_load_dwordx4 v1, s[52:55], s21 offen offset:1024 sc1 lds
    v_smfmac_f32_16x16x64_bf16 v[56:59], v[28:31], a[152:159], v2
    v_smfmac_f32_16x16x64_bf16 v[60:63], v[28:31], a[216:223], v2
    buffer_load_dwordx4 v[20:23], v1, s[52:55], s20 offen offset:1024 sc1
    s_waitcnt vmcnt(4)
    v_max3_u32 v127, v104, v105, v106
    v_max_u32 v127, v127, v107
    v_cmp_eq_u32 vcc, -1, v127
    v_smfmac_f32_16x16x64_bf16 v[48:51], v[32:35], a[32:39], v2
    ds_write_b128 v14, v[104:107] offset:5120
    v_smfmac_f32_16x16x64_bf16 v[52:55], v[32:35], a[96:103], v2
    s_cbranch_vccnz L_lf_s1
L_lr_s1:
    v_smfmac_f32_16x16x64_bf16 v[48:51], v[104:107], a[8:15], v2
    v_smfmac_f32_16x16x64_bf16 v[52:55], v[104:107], a[72:79], v2
    v_smfmac_f32_16x16x64_bf16 v[56:59], v[104:107], a[136:143], v2
    s_waitcnt lgkmcnt(0)
    s_barrier
    ds_read_b128 v[36:39], v14 offset:4096
    v_smfmac_f32_16x16x64_bf16 v[60:63], v[104:107], a[200:207], v2
    buffer_store_dwordx4 v[72:75], v10, s[52:55], s24 offen sc1
    ds_read_b128 v[40:43], v14 offset:7168
    v_smfmac_f32_16x16x64_bf16 v[64:67], v[104:107], v[136:143], v2
    ds_read_b128 v[44:47], v14 offset:6144
    v_smfmac_f32_16x16x64_bf16 v[68:71], v[104:107], v[200:207], v2
    v_smfmac_f32_16x16x64_bf16 v[56:59], v[32:35], a[160:167], v2
    v_smfmac_f32_16x16x64_bf16 v[60:63], v[32:35], a[224:231], v2
    buffer_store_dword v122, v11, s[52:55], s24 offen sc1
    s_waitcnt lgkmcnt(0)
    v_smfmac_f32_16x16x64_bf16 v[48:51], v[36:39], a[40:47], v2
    v_smfmac_f32_16x16x64_bf16 v[52:55], v[36:39], a[104:111], v2
    ds_read_b128 v[92:95], v15 offset:0
    v_smfmac_f32_16x16x64_bf16 v[48:51], v[40:43], a[48:55], v2
    ds_read_b128 v[96:99], v15 offset:1024
    v_smfmac_f32_16x16x64_bf16 v[52:55], v[40:43], a[112:119], v2
    buffer_store_dword v124, v11, s[52:55], s24 offen offset:256 sc1
    ds_read_b128 v[100:103], v15 offset:2048
    v_smfmac_f32_16x16x64_bf16 v[48:51], v[44:47], a[56:63], v2
    ds_read_b128 v[104:107], v15 offset:3072
    v_smfmac_f32_16x16x64_bf16 v[52:55], v[44:47], a[120:127], v2
    v_smfmac_f32_16x16x64_bf16 v[56:59], v[36:39], a[168:175], v2
    v_add_f32 v48, v48, v50
    v_smfmac_f32_16x16x64_bf16 v[60:63], v[36:39], a[232:239], v2
    v_add_f32 v49, v49, v51
    v_smfmac_f32_16x16x64_bf16 v[56:59], v[40:43], a[176:183], v2
    v_add_f32 v52, v52, v54
    v_smfmac_f32_16x16x64_bf16 v[60:63], v[40:43], a[240:247], v2
    v_add_f32 v53, v53, v55
    v_smfmac_f32_16x16x64_bf16 v[56:59], v[44:47], a[184:191], v2
    v_cvt_pk_bf16_f32 v118, v48, v52
    v_smfmac_f32_16x16x64_bf16 v[60:63], v[44:47], a[248:255], v2
    v_cvt_pk_bf16_f32 v119, v49, v53
    v_smfmac_f32_16x16x64_bf16 v[64:67], v[24:27], v[144:151], v2
    ds_write2_b32 v6, v118, v119 offset0:0 offset1:136
    v_add_f32 v56, v56, v58
    v_add_f32 v57, v57, v59
    v_smfmac_f32_16x16x64_bf16 v[68:71], v[24:27], v[208:215], v2
    v_add_f32 v60, v60, v62
    v_add_f32 v61, v61, v63
    v_cvt_pk_bf16_f32 v116, v56, v60
    v_cvt_pk_bf16_f32 v117, v57, v61
    v_smfmac_f32_16x16x64_bf16 v[64:67], v[28:31], v[152:159], v2
    ds_write2_b32 v6, v116, v117 offset0:64 offset1:200
    v_smfmac_f32_16x16x64_bf16 v[68:71], v[28:31], v[216:223], v2
    v_smfmac_f32_16x16x64_bf16 v[64:67], v[32:35], v[160:167], v2
    buffer_store_dword v5, v4, s[52:55], s26 offen sc1
    v_smfmac_f32_16x16x64_bf16 v[68:71], v[32:35], v[224:231], v2
    s_cmp_eq_u32 s16, 63
    v_smfmac_f32_16x16x64_bf16 v[64:67], v[36:39], v[168:175], v2
    s_waitcnt lgkmcnt(0)
    s_barrier
    ds_read_b128 v[76:79], v8 offset:0
    v_smfmac_f32_16x16x64_bf16 v[68:71], v[36:39], v[232:239], v2
    ds_read_b128 v[80:83], v8 offset:64
    v_smfmac_f32_16x16x64_bf16 v[64:67], v[40:43], v[176:183], v2
    ds_read_b128 v[84:87], v8 offset:128
    v_smfmac_f32_16x16x64_bf16 v[68:71], v[40:43], v[240:247], v2
    ds_read_b128 v[88:91], v8 offset:192
    v_smfmac_f32_16x16x64_bf16 v[64:67], v[44:47], v[184:191], v2
    ds_read_b128 v[24:27], v8 offset:256
    v_smfmac_f32_16x16x64_bf16 v[68:71], v[44:47], v[248:255], v2
    s_cbranch_scc1 L_clast
    ds_read_b128 v[28:31], v8 offset:320
    s_waitcnt lgkmcnt(4)
    v_mfma_f32_16x16x32_bf16 v[48:51], v[92:95], v[76:79], 0
    ds_read_b128 v[56:59], v8 offset:384
    v_mfma_f32_16x16x32_bf16 v[48:51], v[96:99], v[80:83], v[48:51]
    ds_read_b128 v[60:63], v8 offset:448
    s_waitcnt lgkmcnt(4)
    v_mfma_f32_16x16x32_bf16 v[48:51], v[100:103], v[84:87], v[48:51]
    ds_read_b128 v[92:95], v15 offset:4096
    v_add_f32 v64, v64, v66
    v_mfma_f32_16x16x32_bf16 v[48:51], v[104:107], v[88:91], v[48:51]
    ds_read_b128 v[96:99], v15 offset:5120
    s_waitcnt lgkmcnt(4)
    v_mfma_f32_16x16x32_bf16 v[72:75], v[24:27], v[76:79], 0
    ds_read_b128 v[100:103], v15 offset:6144
    v_add_f32 v65, v65, v67
    v_mfma_f32_16x16x32_bf16 v[72:75], v[28:31], v[80:83], v[72:75]
    ds_read_b128 v[104:107], v15 offset:7168
    s_waitcnt lgkmcnt(4)
    v_mfma_f32_16x16x32_bf16 v[72:75], v[56:59], v[84:87], v[72:75]
    v_add_f32 v68, v68, v70
    v_add_f32 v69, v69, v71
    v_mfma_f32_16x16x32_bf16 v[72:75], v[60:63], v[88:91], v[72:75]
    s_waitcnt lgkmcnt(2)
    v_cvt_pk_bf16_f32 v122, v64, v65
    v_mfma_f32_16x16x32_bf16 v[52:55], v[92:95], v[76:79], 0
    v_cvt_pk_bf16_f32 v124, v68, v69
    v_max3_f32 v118, v48, v49, v50
    v_mfma_f32_16x16x32_bf16 v[52:55], v[96:99], v[80:83], v[52:55]
    s_waitcnt lgkmcnt(0)
    v_mov_b32 v64, 0x3f803f80
    v_mfma_f32_16x16x32_bf16 v[52:55], v[100:103], v[84:87], v[52:55]
    ds_read_b128 v[24:27], v12 offset:2048
    v_max3_f32 v118, v118, v51, v72
    v_mfma_f32_16x16x32_bf16 v[52:55], v[104:107], v[88:91], v[52:55]
    ds_read_b128 v[28:31], v12 offset:3072
    ds_read_b128 v[32:35], v12 offset:6144
    v_mov_b32 v65, v64
    v_max_f32 v118, v118, v73
    v_mov_b64 v[66:67], v[64:65]
    v_mov_b64 v[68:69], 0
    v_mov_b64 v[70:71], 0
    s_nop 0
    v_max3_f32 v118, v118, v52, v53
    v_max3_f32 v74, v118, v54, v55
    v_mov_b32 v75, v74
    s_nop 1
    v_permlane16_swap_b32 v74, v75
    v_max_f32 v74, v74, v75
    v_mov_b32 v75, v74
    s_nop 1
    v_permlane32_swap_b32 v74, v75
    v_max_f32 v74, v74, v75
    v_mul_f32 v74, s32, v74
    v_pk_fma_f32 v[48:49], v[48:49], s[32:33], v[74:75] op_sel_hi:[1,1,0] neg_lo:[0,0,1] neg_hi:[0,0,1]
    v_pk_fma_f32 v[50:51], v[50:51], s[32:33], v[74:75] op_sel_hi:[1,1,0] neg_lo:[0,0,1] neg_hi:[0,0,1]
    v_pk_fma_f32 v[52:53], v[52:53], s[32:33], v[74:75] op_sel_hi:[1,1,0] neg_lo:[0,0,1] neg_hi:[0,0,1]
    v_pk_fma_f32 v[54:55], v[54:55], s[32:33], v[74:75] op_sel_hi:[1,1,0] neg_lo:[0,0,1] neg_hi:[0,0,1]
    v_pk_fma_f32 v[72:73], v[72:73], s[32:33], v[74:75] op_sel_hi:[1,1,0] neg_lo:[0,0,1] neg_hi:[0,0,1]
    v_exp_f32 v72, v72
    v_exp_f32 v73, v73
    v_exp_f32 v48, v48
    v_cvt_pk_bf16_f32 v120, v72, v73
    v_exp_f32 v49, v49
    v_exp_f32 v50, v50
    v_mfma_f32_16x16x16_bf16 v[72:75], v[64:65], v[120:121], 0
    ds_read_b128 v[36:39], v12 offset:7168
    v_exp_f32 v51, v51
    v_exp_f32 v52, v52
    v_mfma_f32_16x16x16_bf16 v[56:59], v[122:123], v[120:121], 0
    ds_read_b128 v[40:43], v12 offset:10240
    v_exp_f32 v53, v53
    v_exp_f32 v54, v54
    v_mfma_f32_16x16x16_bf16 v[60:63], v[124:125], v[120:121], 0
    ds_read_b128 v[44:47], v12 offset:11264
    v_exp_f32 v55, v55
    v_cvt_pk_bf16_f32 v116, v48, v49
    v_cvt_pk_bf16_f32 v117, v50, v51
    v_cvt_pk_bf16_f32 v118, v52, v53
    v_cvt_pk_bf16_f32 v119, v54, v55
    v_mov_b64 v[48:49], 0
    v_mov_b64 v[50:51], 0
    v_mfma_f32_16x16x32_bf16 v[72:75], v[64:67], v[116:119], v[72:75]
    ds_read_b128 v[76:79], v12 offset:14336
    v_mov_b64 v[52:53], 0
    v_mfma_f32_16x16x32_bf16 v[56:59], v[108:111], v[116:119], v[56:59]
    ds_read_b128 v[80:83], v12 offset:15360
    v_mov_b64 v[54:55], 0
    v_mfma_f32_16x16x32_bf16 v[60:63], v[112:115], v[116:119], v[60:63]
    ds_read_b128 v[84:87], v12 offset:0
    v_rcp_f32 v120, v72
    v_mov_b64 v[116:117], 0
    s_nop 0
    v_pk_mul_f32 v[56:57], v[56:57], v[120:121] op_sel_hi:[1,0]
    v_pk_mul_f32 v[58:59], v[58:59], v[120:121] op_sel_hi:[1,0]
    v_cvt_pk_bf16_f32 v56, v56, v57
    v_cvt_pk_bf16_f32 v57, v58, v59
    v_pk_mul_f32 v[60:61], v[60:61], v[120:121] op_sel_hi:[1,0]
    v_pk_mul_f32 v[62:63], v[62:63], v[120:121] op_sel_hi:[1,0]
    v_cvt_pk_bf16_f32 v58, v60, v61
    v_cvt_pk_bf16_f32 v59, v62, v63
    v_cndmask_b32 v60, v56, v58, s[48:49]
    v_cndmask_b32 v61, v57, v59, s[48:49]
    ds_write_b64 v7, v[60:61] offset:512
    s_waitcnt lgkmcnt(1)
    v_smfmac_f32_16x16x64_bf16 v[48:51], v[56:59], v[24:31], v2
    ds_read_b128 v[88:91], v12 offset:1024
    v_mov_b64 v[118:119], 0
    v_smfmac_f32_16x16x64_bf16 v[52:55], v[56:59], v[32:39], v2
    ds_read_b128 v[92:95], v12 offset:4096
    v_smfmac_f32_16x16x64_bf16 v[68:71], v[56:59], v[40:47], v2
    ds_read_b128 v[96:99], v12 offset:5120
    s_waitcnt lgkmcnt(3)
    s_barrier
    ds_read_b128 v[60:63], v9 offset:0
    ds_read_b128 v[64:67], v9 offset:1536
    ds_read_b128 v[72:75], v9 offset:1024
    v_smfmac_f32_16x16x64_bf16 v[116:119], v[56:59], v[76:83], v2
    s_cmp_eq_u32 s16, 62
    s_cbranch_scc1 L_c62_s1
L_c62r_s1:
    s_waitcnt lgkmcnt(2)
    v_smfmac_f32_16x16x64_bf16 v[48:51], v[60:63], v[84:91], v2
    ds_read_b128 v[100:103], v12 offset:8192
    s_waitcnt lgkmcnt(2)
    v_smfmac_f32_16x16x64_bf16 v[48:51], v[64:67], a[64:71], v2
    ds_read_b128 v[104:107], v12 offset:9216
    s_waitcnt lgkmcnt(2)
    v_smfmac_f32_16x16x64_bf16 v[48:51], v[72:75], a[0:7], v2
    ds_read_b128 v[108:111], v12 offset:12288
    ds_read_b128 v[112:115], v12 offset:13312
    v_smfmac_f32_16x16x64_bf16 v[52:55], v[60:63], v[92:99], v2
    ds_read_b128 v[24:27], v13 offset:38912
    ds_read_b128 v[28:31], v13 offset:39936
    v_smfmac_f32_16x16x64_bf16 v[52:55], v[64:67], a[192:199], v2
    v_cvt_pk_bf16_f32 v48, v48, v49
    v_cvt_pk_bf16_f32 v49, v50, v51
    v_and_or_b32 v48, v48, -2, s17
    v_smfmac_f32_16x16x64_bf16 v[52:55], v[72:75], a[128:135], v2
    buffer_store_dwordx2 v[48:49], v3, s[52:55], s18 offen offset:0 sc1
    s_waitcnt lgkmcnt(4)
    v_smfmac_f32_16x16x64_bf16 v[68:71], v[60:63], v[100:107], v2
    ds_read_b128 v[32:35], v13 offset:36864
    ds_read_b128 v[36:39], v13 offset:37888
    v_smfmac_f32_16x16x64_bf16 v[68:71], v[64:67], v[192:199], v2
    v_cvt_pk_bf16_f32 v52, v52, v53
    v_cvt_pk_bf16_f32 v53, v54, v55
    v_and_or_b32 v52, v52, -2, s17
    v_smfmac_f32_16x16x64_bf16 v[68:71], v[72:75], v[128:135], v2
    buffer_store_dwordx2 v[52:53], v3, s[52:55], s18 offen offset:2048 sc1
    s_waitcnt lgkmcnt(2)
    v_smfmac_f32_16x16x64_bf16 v[116:119], v[60:63], v[108:115], v2
    v_smfmac_f32_16x16x64_bf16 v[116:119], v[64:67], v[24:31], v2
    v_cvt_pk_bf16_f32 v68, v68, v69
    v_cvt_pk_bf16_f32 v69, v70, v71
    v_and_or_b32 v68, v68, -2, s17
    s_waitcnt lgkmcnt(0)
    v_smfmac_f32_16x16x64_bf16 v[116:119], v[72:75], v[32:39], v2
    buffer_store_dwordx2 v[68:69], v3, s[52:55], s19 offen offset:0 sc1
    s_nop 6
    v_cvt_pk_bf16_f32 v116, v116, v117
    v_cvt_pk_bf16_f32 v117, v118, v119
    v_and_or_b32 v116, v116, -2, s17
    buffer_store_dwordx2 v[116:117], v3, s[52:55], s19 offen offset:2048 sc1
    ds_read_b128 v[72:75], v14 offset:31232
    s_waitcnt vmcnt(8)
    v_mov_b64 v[108:109], v[16:17]
    v_mov_b64 v[110:111], v[18:19]
    v_mov_b64 v[112:113], v[20:21]
    v_mov_b64 v[114:115], v[22:23]
    v_mov_b64 v[48:49], 0
    v_mov_b64 v[50:51], 0
    v_mov_b64 v[52:53], 0
    v_mov_b64 v[54:55], 0
    v_mov_b64 v[56:57], 0
    v_mov_b64 v[58:59], 0
    v_mov_b64 v[60:61], 0
    v_mov_b64 v[62:63], 0
    v_mov_b64 v[68:69], 0
    v_mov_b64 v[70:71], 0
    v_mov_b64 v[64:65], 0
    v_mov_b64 v[66:67], 0
    v_xor_b32 v15, 0x6000, v15
    s_add_u32 s16, s16, 1
    s_add_u32 s20, s20, 524288
    s_add_u32 s21, s21, 524288
    s_mov_b32 s24, s28
    s_add_u32 s28, s28, 131072
    s_xor_b32 s31, s31, 0x6000
    s_mov_b32 m0, s31
    s_mov_b32 s13, 0
    s_mov_b32 s26, s25
    s_and_b32 s15, s16, 3
    s_lshl_b32 s15, s15, 13
    s_add_u32 s25, s23, s15
    s_add_u32 s92, s25, 4096
    s_cmp_eq_u32 s16, 63
    s_cselect_b32 s21, 0x40000000, s21
    s_cselect_b32 s20, 0x40000000, s20
    ds_read_b128 v[24:27], v13 offset:0
    ds_read_b128 v[28:31], v13 offset:1024
    buffer_load_dwordx4 v[16:19], v1, s[52:55], s22 offen sc1
    buffer_load_dwordx4 v[20:23], v1, s[52:55], s22 offen offset:1024 sc1
    ds_read_b128 v[32:35], v13 offset:2048
    ds_read_b128 v[36:39], v13 offset:3072
    ds_read_b128 v[40:43], v13 offset:4096
    ds_read_b128 v[44:47], v13 offset:5120
    ds_read_b128 v[76:79], v13 offset:6144
    ds_read_b128 v[80:83], v13 offset:7168
    ds_read_b128 v[84:87], v13 offset:32768
    ds_read_b128 v[88:91], v13 offset:33792
    ds_read_b128 v[92:95], v13 offset:34816
    ds_read_b128 v[96:99], v13 offset:35840
    s_nop 8
    buffer_load_dwordx4 v[100:103], v1, s[52:55], s22 offen sc1
    buffer_load_dwordx4 v[104:107], v1, s[52:55], s22 offen offset:1024 sc1
    s_waitcnt lgkmcnt(0)
L_h1_s1a:
    s_waitcnt vmcnt(3)
    v_mfma_f32_16x16x32_bf16 v[116:119], v[72:75], v[16:19], 0
    v_bitop3_b32 v127, v16, v18, s17 bitop3:0x7e
    s_waitcnt vmcnt(2)
    v_mfma_f32_16x16x32_bf16 v[116:119], v[72:75], v[20:23], v[116:119]
    v_bitop3_b32 v120, v20, v22, s17 bitop3:0x7e
    v_bitop3_b32 v127, v127, v120, 1 bitop3:0xa8
    v_cmp_ne_u32 vcc, 0, v127
    s_cbranch_vccnz L_h1_s1b
    v_add_f32_dpp v116, v116, v116 row_ror:4 row_mask:0xf bank_mask:0xf
    v_add_f32_dpp v117, v117, v117 row_ror:4 row_mask:0xf bank_mask:0xf
    s_nop 0
    v_add_f32_dpp v116, v116, v116 row_ror:8 row_mask:0xf bank_mask:0xf
    v_add_f32_dpp v117, v117, v117 row_ror:8 row_mask:0xf bank_mask:0xf
    v_cvt_pk_bf16_f32 v116, v116, v117
    v_min_u32 v116, -2, v116
    buffer_store_dword v116, v4, s[52:55], s25 offen sc1
L_h1_s1_ok:
    s_xor_b32 s17, s17, 1
    s_mov_b32 s13, 0
    ds_read_b128 v[72:75], v8 offset:320
    s_nop 15
    s_nop 15
    s_nop 4
    buffer_load_dwordx4 v[16:19], v1, s[52:55], s25 offen offset:1024 sc1
    s_nop 15
    s_nop 9
    buffer_load_dwordx4 v[20:23], v1, s[52:55], s25 offen offset:1024 sc1
    s_waitcnt lgkmcnt(0)
    s_branch L_h2a_s1
L_h1_s1f:
    buffer_load_dwordx4 v[100:103], v1, s[52:55], s22 offen sc1
    buffer_load_dwordx4 v[104:107], v1, s[52:55], s22 offen offset:1024 sc1
    s_add_u32 s13, s13, 1
    s_cmp_lt_u32 s13, 1048576
    s_cbranch_scc1 L_h1_s1a
    s_branch L_end
L_h1_s1b:
    buffer_load_dwordx4 v[16:19], v1, s[52:55], s22 offen sc1
    buffer_load_dwordx4 v[20:23], v1, s[52:55], s22 offen offset:1024 sc1
    s_waitcnt vmcnt(3)
    v_mfma_f32_16x16x32_bf16 v[116:119], v[72:75], v[100:103], 0
    v_bitop3_b32 v127, v100, v102, s17 bitop3:0x7e
    s_waitcnt vmcnt(2)
    v_mfma_f32_16x16x32_bf16 v[116:119], v[72:75], v[104:107], v[116:119]
    v_bitop3_b32 v120, v104, v106, s17 bitop3:0x7e
    v_bitop3_b32 v127, v127, v120, 1 bitop3:0xa8
    v_cmp_ne_u32 vcc, 0, v127
    s_cbranch_vccnz L_h1_s1f
    v_add_f32_dpp v116, v116, v116 row_ror:4 row_mask:0xf bank_mask:0xf
    v_add_f32_dpp v117, v117, v117 row_ror:4 row_mask:0xf bank_mask:0xf
    s_nop 0
    v_add_f32_dpp v116, v116, v116 row_ror:8 row_mask:0xf bank_mask:0xf
    v_add_f32_dpp v117, v117, v117 row_ror:8 row_mask:0xf bank_mask:0xf
    v_cvt_pk_bf16_f32 v116, v116, v117
    v_min_u32 v116, -2, v116
    buffer_store_dword v116, v4, s[52:55], s25 offen sc1
    s_branch L_h1_s1_ok
L_lf_s1:
    s_mov_b32 s13, 0
L_lf1_s1:
    buffer_load_dwordx4 v[104:107], v1, s[52:55], s92 offen offset:1024 sc1
    s_waitcnt vmcnt(0)
    v_max3_u32 v127, v104, v105, v106
    v_max_u32 v127, v127, v107
    v_cmp_eq_u32 vcc, -1, v127
    ds_write_b128 v14, v[104:107] offset:5120
    s_cbranch_vccz L_lr_s1
    s_add_u32 s13, s13, 1
    s_cmp_lt_u32 s13, 1048576
    s_cbranch_scc1 L_lf1_s1
    s_branch L_end
L_c62_s1:
    s_mov_b32 s24, s28
    ds_read_b128 v[108:111], v8 offset:320
    buffer_store_dword v122, v11, s[52:55], s24 offen sc1
    buffer_store_dword v124, v11, s[52:55], s24 offen offset:256 sc1
    s_waitcnt lgkmcnt(0)
    buffer_store_dwordx4 v[108:111], v10, s[52:55], s24 offen sc1
    s_branch L_c62r_s1
L_h2b_s2_fail:
    buffer_load_dwordx4 v[20:23], v1, s[52:55], s25 offen offset:2048 sc1
    s_add_u32 s13, s13, 1
    s_nop 4
    v_mov_b64 v[48:49], 0
    v_mov_b64 v[50:51], 0
    v_mov_b64 v[52:53], 0
    v_mov_b64 v[54:55], 0
    s_cmp_lt_u32 s13, 1048576
    s_cbranch_scc1 L_h2a_s2
    s_branch L_end
.p2align 6
    s_nop 0
    s_nop 0
    s_nop 0
L_h2b_s2:
    buffer_load_dwordx4 v[16:19], v1, s[52:55], s25 offen offset:2048 sc1
    s_nop 5
    v_mov_b64 v[48:49], 0
    v_mov_b64 v[50:51], 0
    v_mov_b64 v[52:53], 0
    v_mov_b64 v[54:55], 0
    s_waitcnt vmcnt(1)
L_h2b_s2_go:
    v_max3_u32 v127, v20, v21, v22
    v_max_u32 v127, v127, v23
    v_cmp_eq_u32 vcc, -1, v127
    v_smfmac_f32_16x16x64_bf16 v[48:51], v[20:23], v[24:31], v2
    ds_write_b128 v14, v[20:23] offset:2048
    v_smfmac_f32_16x16x64_bf16 v[52:55], v[20:23], v[32:39], v2
    s_cbranch_vccnz L_h2b_s2_fail
    v_smfmac_f32_16x16x64_bf16 v[56:59], v[20:23], v[40:47], v2
    buffer_load_dwordx4 v[104:107], v1, s[52:55], s92 offen offset:2048 sc1
    s_waitcnt lgkmcnt(0)
    s_barrier
    ds_read_b128 v[24:27], v14 offset:3072
    v_smfmac_f32_16x16x64_bf16 v[60:63], v[20:23], v[76:83], v2
    ds_read_b128 v[28:31], v14 offset:0
    v_smfmac_f32_16x16x64_bf16 v[64:67], v[20:23], v[84:91], v2
    ds_read_b128 v[32:35], v14 offset:1024
    v_smfmac_f32_16x16x64_bf16 v[68:71], v[20:23], v[92:99], v2
    buffer_store_dword v126, v0, s[52:55], s30 offen sc1
    s_branch L_cbody_s2
.p2align 6
    s_nop 0
    s_nop 0
    s_nop 0
L_h2a_s2:
    s_waitcnt vmcnt(1)
L_h2a_s2_go:
    v_max3_u32 v127, v16, v17, v18
    v_max_u32 v127, v127, v19
    v_cmp_eq_u32 vcc, -1, v127
    v_smfmac_f32_16x16x64_bf16 v[48:51], v[16:19], v[24:31], v2
    ds_write_b128 v14, v[16:19] offset:2048
    v_smfmac_f32_16x16x64_bf16 v[52:55], v[16:19], v[32:39], v2
    s_cbranch_vccnz L_h2b_s2
    v_smfmac_f32_16x16x64_bf16 v[56:59], v[16:19], v[40:47], v2
    buffer_load_dwordx4 v[104:107], v1, s[52:55], s92 offen offset:2048 sc1
    s_waitcnt lgkmcnt(0)
    s_barrier
    ds_read_b128 v[24:27], v14 offset:3072
    v_smfmac_f32_16x16x64_bf16 v[60:63], v[16:19], v[76:83], v2
    ds_read_b128 v[28:31], v14 offset:0
    v_smfmac_f32_16x16x64_bf16 v[64:67], v[16:19], v[84:91], v2
    ds_read_b128 v[32:35], v14 offset:1024
    v_smfmac_f32_16x16x64_bf16 v[68:71], v[16:19], v[92:99], v2
    buffer_store_dword v126, v0, s[52:55], s30 offen sc1
L_cbody_s2:
    s_waitcnt lgkmcnt(2)
    v_smfmac_f32_16x16x64_bf16 v[48:51], v[24:27], a[16:23], v2
    v_smfmac_f32_16x16x64_bf16 v[52:55], v[24:27], a[80:87], v2
    v_smfmac_f32_16x16x64_bf16 v[56:59], v[24:27], a[144:151], v2
    buffer_load_dwordx4 v1, s[52:55], s21 offen sc1 lds
    s_waitcnt lgkmcnt(0)
    v_smfmac_f32_16x16x64_bf16 v[60:63], v[24:27], a[208:215], v2
    v_smfmac_f32_16x16x64_bf16 v[48:51], v[28:31], a[24:31], v2
    buffer_load_dwordx4 v[16:19], v1, s[52:55], s20 offen sc1
    v_smfmac_f32_16x16x64_bf16 v[52:55], v[28:31], a[88:95], v2
    v_smfmac_f32_16x16x64_bf16 v[56:59], v[28:31], a[152:159], v2
    buffer_load_dwordx4 v1, s[52:55], s21 offen offset:1024 sc1 lds
    v_smfmac_f32_16x16x64_bf16 v[60:63], v[28:31], a[216:223], v2
    s_waitcnt vmcnt(4)
    v_max3_u32 v127, v104, v105, v106
    v_max_u32 v127, v127, v107
    v_cmp_eq_u32 vcc, -1, v127
    v_smfmac_f32_16x16x64_bf16 v[48:51], v[32:35], a[32:39], v2
    buffer_load_dwordx4 v[20:23], v1, s[52:55], s20 offen offset:1024 sc1
    ds_write_b128 v14, v[104:107] offset:6144
    v_smfmac_f32_16x16x64_bf16 v[52:55], v[32:35], a[96:103], v2
    s_cbranch_vccnz L_lf_s2
L_lr_s2:
    v_smfmac_f32_16x16x64_bf16 v[48:51], v[104:107], a[8:15], v2
    buffer_store_dwordx4 v[72:75], v10, s[52:55], s24 offen sc1
    v_smfmac_f32_16x16x64_bf16 v[52:55], v[104:107], a[72:79], v2
    v_smfmac_f32_16x16x64_bf16 v[56:59], v[104:107], a[136:143], v2
    s_waitcnt lgkmcnt(0)
    s_barrier
    ds_read_b128 v[36:39], v14 offset:7168
    v_smfmac_f32_16x16x64_bf16 v[60:63], v[104:107], a[200:207], v2
    ds_read_b128 v[40:43], v14 offset:4096
    v_smfmac_f32_16x16x64_bf16 v[64:67], v[104:107], v[136:143], v2
    ds_read_b128 v[44:47], v14 offset:5120
    v_smfmac_f32_16x16x64_bf16 v[68:71], v[104:107], v[200:207], v2
    v_smfmac_f32_16x16x64_bf16 v[56:59], v[32:35], a[160:167], v2
    v_smfmac_f32_16x16x64_bf16 v[60:63], v[32:35], a[224:231], v2
    s_waitcnt lgkmcnt(0)
    v_smfmac_f32_16x16x64_bf16 v[48:51], v[36:39], a[40:47], v2
    buffer_store_dword v122, v11, s[52:55], s24 offen sc1
    v_smfmac_f32_16x16x64_bf16 v[52:55], v[36:39], a[104:111], v2
    ds_read_b128 v[92:95], v15 offset:0
    v_smfmac_f32_16x16x64_bf16 v[48:51], v[40:43], a[48:55], v2
    ds_read_b128 v[96:99], v15 offset:1024
    v_smfmac_f32_16x16x64_bf16 v[52:55], v[40:43], a[112:119], v2
    ds_read_b128 v[100:103], v15 offset:2048
    v_smfmac_f32_16x16x64_bf16 v[48:51], v[44:47], a[56:63], v2
    buffer_store_dword v124, v11, s[52:55], s24 offen offset:256 sc1
    ds_read_b128 v[104:107], v15 offset:3072
    v_smfmac_f32_16x16x64_bf16 v[52:55], v[44:47], a[120:127], v2
    v_smfmac_f32_16x16x64_bf16 v[56:59], v[36:39], a[168:175], v2
    v_add_f32 v48, v48, v50
    v_smfmac_f32_16x16x64_bf16 v[60:63], v[36:39], a[232:239], v2
    v_add_f32 v49, v49, v51
    v_smfmac_f32_16x16x64_bf16 v[56:59], v[40:43], a[176:183], v2
    v_add_f32 v52, v52, v54
    v_smfmac_f32_16x16x64_bf16 v[60:63], v[40:43], a[240:247], v2
    v_add_f32 v53, v53, v55
    v_smfmac_f32_16x16x64_bf16 v[56:59], v[44:47], a[184:191], v2
    v_cvt_pk_bf16_f32 v118, v48, v52
    v_smfmac_f32_16x16x64_bf16 v[60:63], v[44:47], a[248:255], v2
    v_cvt_pk_bf16_f32 v119, v49, v53
    v_smfmac_f32_16x16x64_bf16 v[64:67], v[24:27], v[144:151], v2
    ds_write2_b32 v6, v118, v119 offset0:0 offset1:136
    v_add_f32 v56, v56, v58
    v_add_f32 v57, v57, v59
    v_smfmac_f32_16x16x64_bf16 v[68:71], v[24:27], v[208:215], v2
    v_add_f32 v60, v60, v62
    v_add_f32 v61, v61, v63
    v_cvt_pk_bf16_f32 v116, v56, v60
    v_cvt_pk_bf16_f32 v117, v57, v61
    v_smfmac_f32_16x16x64_bf16 v[64:67], v[28:31], v[152:159], v2
    ds_write2_b32 v6, v116, v117 offset0:64 offset1:200
    v_smfmac_f32_16x16x64_bf16 v[68:71], v[28:31], v[216:223], v2
    v_smfmac_f32_16x16x64_bf16 v[64:67], v[32:35], v[160:167], v2
    buffer_store_dword v5, v4, s[52:55], s26 offen sc1
    v_smfmac_f32_16x16x64_bf16 v[68:71], v[32:35], v[224:231], v2
    s_cmp_eq_u32 s16, 63
    v_smfmac_f32_16x16x64_bf16 v[64:67], v[36:39], v[168:175], v2
    s_waitcnt lgkmcnt(0)
    s_barrier
    ds_read_b128 v[76:79], v8 offset:0
    v_smfmac_f32_16x16x64_bf16 v[68:71], v[36:39], v[232:239], v2
    ds_read_b128 v[80:83], v8 offset:64
    v_smfmac_f32_16x16x64_bf16 v[64:67], v[40:43], v[176:183], v2
    ds_read_b128 v[84:87], v8 offset:128
    v_smfmac_f32_16x16x64_bf16 v[68:71], v[40:43], v[240:247], v2
    ds_read_b128 v[88:91], v8 offset:192
    v_smfmac_f32_16x16x64_bf16 v[64:67], v[44:47], v[184:191], v2
    ds_read_b128 v[24:27], v8 offset:256
    v_smfmac_f32_16x16x64_bf16 v[68:71], v[44:47], v[248:255], v2
    s_cbranch_scc1 L_clast
    ds_read_b128 v[28:31], v8 offset:320
    s_waitcnt lgkmcnt(4)
    v_mfma_f32_16x16x32_bf16 v[48:51], v[92:95], v[76:79], 0
    ds_read_b128 v[56:59], v8 offset:384
    v_mfma_f32_16x16x32_bf16 v[48:51], v[96:99], v[80:83], v[48:51]
    ds_read_b128 v[60:63], v8 offset:448
    s_waitcnt lgkmcnt(4)
    v_mfma_f32_16x16x32_bf16 v[48:51], v[100:103], v[84:87], v[48:51]
    ds_read_b128 v[92:95], v15 offset:4096
    v_add_f32 v64, v64, v66
    v_mfma_f32_16x16x32_bf16 v[48:51], v[104:107], v[88:91], v[48:51]
    ds_read_b128 v[96:99], v15 offset:5120
    s_waitcnt lgkmcnt(4)
    v_mfma_f32_16x16x32_bf16 v[72:75], v[24:27], v[76:79], 0
    ds_read_b128 v[100:103], v15 offset:6144
    v_add_f32 v65, v65, v67
    v_mfma_f32_16x16x32_bf16 v[72:75], v[28:31], v[80:83], v[72:75]
    ds_read_b128 v[104:107], v15 offset:7168
    s_waitcnt lgkmcnt(4)
    v_mfma_f32_16x16x32_bf16 v[72:75], v[56:59], v[84:87], v[72:75]
    v_add_f32 v68, v68, v70
    v_add_f32 v69, v69, v71
    v_mfma_f32_16x16x32_bf16 v[72:75], v[60:63], v[88:91], v[72:75]
    s_waitcnt lgkmcnt(2)
    v_cvt_pk_bf16_f32 v122, v64, v65
    v_mfma_f32_16x16x32_bf16 v[52:55], v[92:95], v[76:79], 0
    v_cvt_pk_bf16_f32 v124, v68, v69
    v_max3_f32 v118, v48, v49, v50
    v_mfma_f32_16x16x32_bf16 v[52:55], v[96:99], v[80:83], v[52:55]
    s_waitcnt lgkmcnt(0)
    v_mov_b32 v64, 0x3f803f80
    v_mfma_f32_16x16x32_bf16 v[52:55], v[100:103], v[84:87], v[52:55]
    ds_read_b128 v[24:27], v13 offset:36864
    v_max3_f32 v118, v118, v51, v72
    v_mfma_f32_16x16x32_bf16 v[52:55], v[104:107], v[88:91], v[52:55]
    ds_read_b128 v[28:31], v13 offset:37888
    ds_read_b128 v[32:35], v12 offset:0
    v_mov_b32 v65, v64
    v_max_f32 v118, v118, v73
    v_mov_b64 v[66:67], v[64:65]
    v_mov_b64 v[68:69], 0
    v_mov_b64 v[70:71], 0
    s_nop 0
    v_max3_f32 v118, v118, v52, v53
    v_max3_f32 v74, v118, v54, v55
    v_mov_b32 v75, v74
    s_nop 1
    v_permlane16_swap_b32 v74, v75
    v_max_f32 v74, v74, v75
    v_mov_b32 v75, v74
    s_nop 1
    v_permlane32_swap_b32 v74, v75
    v_max_f32 v74, v74, v75
    v_mul_f32 v74, s32, v74
    v_pk_fma_f32 v[48:49], v[48:49], s[32:33], v[74:75] op_sel_hi:[1,1,0] neg_lo:[0,0,1] neg_hi:[0,0,1]
    v_pk_fma_f32 v[50:51], v[50:51], s[32:33], v[74:75] op_sel_hi:[1,1,0] neg_lo:[0,0,1] neg_hi:[0,0,1]
    v_pk_fma_f32 v[52:53], v[52:53], s[32:33], v[74:75] op_sel_hi:[1,1,0] neg_lo:[0,0,1] neg_hi:[0,0,1]
    v_pk_fma_f32 v[54:55], v[54:55], s[32:33], v[74:75] op_sel_hi:[1,1,0] neg_lo:[0,0,1] neg_hi:[0,0,1]
    v_pk_fma_f32 v[72:73], v[72:73], s[32:33], v[74:75] op_sel_hi:[1,1,0] neg_lo:[0,0,1] neg_hi:[0,0,1]
    v_exp_f32 v72, v72
    v_exp_f32 v73, v73
    v_exp_f32 v48, v48
    v_cvt_pk_bf16_f32 v120, v72, v73
    v_exp_f32 v49, v49
    v_exp_f32 v50, v50
    v_mfma_f32_16x16x16_bf16 v[72:75], v[64:65], v[120:121], 0
    ds_read_b128 v[36:39], v12 offset:1024
    v_exp_f32 v51, v51
    v_exp_f32 v52, v52
    v_mfma_f32_16x16x16_bf16 v[56:59], v[122:123], v[120:121], 0
    ds_read_b128 v[40:43], v12 offset:2048
    v_exp_f32 v53, v53
    v_exp_f32 v54, v54
    v_mfma_f32_16x16x16_bf16 v[60:63], v[124:125], v[120:121], 0
    ds_read_b128 v[44:47], v12 offset:3072
    v_exp_f32 v55, v55
    v_cvt_pk_bf16_f32 v116, v48, v49
    v_cvt_pk_bf16_f32 v117, v50, v51
    v_cvt_pk_bf16_f32 v118, v52, v53
    v_cvt_pk_bf16_f32 v119, v54, v55
    v_mov_b64 v[48:49], 0
    v_mov_b64 v[50:51], 0
    v_mfma_f32_16x16x32_bf16 v[72:75], v[64:67], v[116:119], v[72:75]
    ds_read_b128 v[76:79], v12 offset:4096
    v_mov_b64 v[52:53], 0
    v_mfma_f32_16x16x32_bf16 v[56:59], v[108:111], v[116:119], v[56:59]
    ds_read_b128 v[80:83], v12 offset:5120
    v_mov_b64 v[54:55], 0
    v_mfma_f32_16x16x32_bf16 v[60:63], v[112:115], v[116:119], v[60:63]
    ds_read_b128 v[84:87], v12 offset:6144
    v_rcp_f32 v120, v72
    v_mov_b64 v[116:117], 0
    s_nop 0
    v_pk_mul_f32 v[56:57], v[56:57], v[120:121] op_sel_hi:[1,0]
    v_pk_mul_f32 v[58:59], v[58:59], v[120:121] op_sel_hi:[1,0]
    v_cvt_pk_bf16_f32 v56, v56, v57
    v_cvt_pk_bf16_f32 v57, v58, v59
    v_pk_mul_f32 v[60:61], v[60:61], v[120:121] op_sel_hi:[1,0]
    v_pk_mul_f32 v[62:63], v[62:63], v[120:121] op_sel_hi:[1,0]
    v_cvt_pk_bf16_f32 v58, v60, v61
    v_cvt_pk_bf16_f32 v59, v62, v63
    v_cndmask_b32 v60, v56, v58, s[48:49]
    v_cndmask_b32 v61, v57, v59, s[48:49]
    ds_write_b64 v7, v[60:61] offset:1024
    s_waitcnt lgkmcnt(1)
    v_smfmac_f32_16x16x64_bf16 v[48:51], v[56:59], a[0:7], v2
    ds_read_b128 v[88:91], v12 offset:7168
    v_mov_b64 v[118:119], 0
    v_smfmac_f32_16x16x64_bf16 v[52:55], v[56:59], a[128:135], v2
    ds_read_b128 v[92:95], v12 offset:8192
    v_smfmac_f32_16x16x64_bf16 v[68:71], v[56:59], v[128:135], v2
    ds_read_b128 v[96:99], v12 offset:9216
    s_waitcnt lgkmcnt(3)
    s_barrier
    ds_read_b128 v[60:63], v9 offset:1536
    ds_read_b128 v[64:67], v9 offset:0
    ds_read_b128 v[72:75], v9 offset:512
    v_smfmac_f32_16x16x64_bf16 v[116:119], v[56:59], v[24:31], v2
    s_cmp_eq_u32 s16, 62
    s_cbranch_scc1 L_c62_s2
L_c62r_s2:
    s_waitcnt lgkmcnt(2)
    v_smfmac_f32_16x16x64_bf16 v[48:51], v[60:63], a[64:71], v2
    ds_read_b128 v[100:103], v12 offset:10240
    s_waitcnt lgkmcnt(2)
    v_smfmac_f32_16x16x64_bf16 v[48:51], v[64:67], v[32:39], v2
    ds_read_b128 v[104:107], v12 offset:11264
    s_waitcnt lgkmcnt(2)
    v_smfmac_f32_16x16x64_bf16 v[48:51], v[72:75], v[40:47], v2
    ds_read_b128 v[108:111], v13 offset:38912
    ds_read_b128 v[112:115], v13 offset:39936
    v_smfmac_f32_16x16x64_bf16 v[52:55], v[60:63], a[192:199], v2
    ds_read_b128 v[24:27], v12 offset:12288
    ds_read_b128 v[28:31], v12 offset:13312
    v_smfmac_f32_16x16x64_bf16 v[52:55], v[64:67], v[76:83], v2
    v_cvt_pk_bf16_f32 v48, v48, v49
    v_cvt_pk_bf16_f32 v49, v50, v51
    v_and_or_b32 v48, v48, -2, s17
    v_smfmac_f32_16x16x64_bf16 v[52:55], v[72:75], v[84:91], v2
    buffer_store_dwordx2 v[48:49], v3, s[52:55], s18 offen offset:0 sc1
    s_waitcnt lgkmcnt(4)
    v_smfmac_f32_16x16x64_bf16 v[68:71], v[60:63], v[192:199], v2
    ds_read_b128 v[32:35], v12 offset:14336
    ds_read_b128 v[36:39], v12 offset:15360
    v_smfmac_f32_16x16x64_bf16 v[68:71], v[64:67], v[92:99], v2
    v_cvt_pk_bf16_f32 v52, v52, v53
    v_cvt_pk_bf16_f32 v53, v54, v55
    v_and_or_b32 v52, v52, -2, s17
    v_smfmac_f32_16x16x64_bf16 v[68:71], v[72:75], v[100:107], v2
    buffer_store_dwordx2 v[52:53], v3, s[52:55], s18 offen offset:2048 sc1
    s_waitcnt lgkmcnt(2)
    v_smfmac_f32_16x16x64_bf16 v[116:119], v[60:63], v[108:115], v2
    v_smfmac_f32_16x16x64_bf16 v[116:119], v[64:67], v[24:31], v2
    v_cvt_pk_bf16_f32 v68, v68, v69
    v_cvt_pk_bf16_f32 v69, v70, v71
    v_and_or_b32 v68, v68, -2, s17
    s_waitcnt lgkmcnt(0)
    v_smfmac_f32_16x16x64_bf16 v[116:119], v[72:75], v[32:39], v2
    buffer_store_dwordx2 v[68:69], v3, s[52:55], s19 offen offset:0 sc1
    s_nop 6
    v_cvt_pk_bf16_f32 v116, v116, v117
    v_cvt_pk_bf16_f32 v117, v118, v119
    v_and_or_b32 v116, v116, -2, s17
    buffer_store_dwordx2 v[116:117], v3, s[52:55], s19 offen offset:2048 sc1
    ds_read_b128 v[72:75], v14 offset:31232
    s_waitcnt vmcnt(8)
    v_mov_b64 v[108:109], v[16:17]
    v_mov_b64 v[110:111], v[18:19]
    v_mov_b64 v[112:113], v[20:21]
    v_mov_b64 v[114:115], v[22:23]
    v_mov_b64 v[48:49], 0
    v_mov_b64 v[50:51], 0
    v_mov_b64 v[52:53], 0
    v_mov_b64 v[54:55], 0
    v_mov_b64 v[56:57], 0
    v_mov_b64 v[58:59], 0
    v_mov_b64 v[60:61], 0
    v_mov_b64 v[62:63], 0
    v_mov_b64 v[68:69], 0
    v_mov_b64 v[70:71], 0
    v_mov_b64 v[64:65], 0
    v_mov_b64 v[66:67], 0
    v_xor_b32 v15, 0x6000, v15
    s_add_u32 s16, s16, 1
    s_add_u32 s20, s20, 524288
    s_add_u32 s21, s21, 524288
    s_mov_b32 s24, s28
    s_add_u32 s28, s28, 131072
    s_xor_b32 s31, s31, 0x6000
    s_mov_b32 m0, s31
    s_mov_b32 s13, 0
    s_mov_b32 s26, s25
    s_and_b32 s15, s16, 3
    s_lshl_b32 s15, s15, 13
    s_add_u32 s25, s23, s15
    s_add_u32 s92, s25, 4096
    s_cmp_eq_u32 s16, 63
    s_cselect_b32 s21, 0x40000000, s21
    s_cselect_b32 s20, 0x40000000, s20
    v_add_u32 v126, 1, v126
    ds_read_b128 v[24:27], v13 offset:0
    ds_read_b128 v[28:31], v13 offset:1024
    ds_read_b128 v[32:35], v13 offset:2048
    ds_read_b128 v[36:39], v13 offset:3072
    ds_read_b128 v[40:43], v13 offset:4096
    ds_read_b128 v[44:47], v13 offset:5120
    ds_read_b128 v[76:79], v13 offset:6144
    ds_read_b128 v[80:83], v13 offset:7168
    ds_read_b128 v[84:87], v13 offset:32768
    ds_read_b128 v[88:91], v13 offset:33792
    buffer_load_dwordx4 v[16:19], v1, s[52:55], s22 offen sc1
    buffer_load_dwordx4 v[20:23], v1, s[52:55], s22 offen offset:1024 sc1
    ds_read_b128 v[92:95], v13 offset:34816
    ds_read_b128 v[96:99], v13 offset:35840
    s_nop 15
    s_nop 8
    buffer_load_dwordx4 v[100:103], v1, s[52:55], s22 offen sc1
    buffer_load_dwordx4 v[104:107], v1, s[52:55], s22 offen offset:1024 sc1
    s_waitcnt lgkmcnt(0)
L_h1_s2a:
    s_waitcnt vmcnt(3)
    v_mfma_f32_16x16x32_bf16 v[116:119], v[72:75], v[16:19], 0
    v_bitop3_b32 v127, v16, v18, s17 bitop3:0x7e
    s_waitcnt vmcnt(2)
    v_mfma_f32_16x16x32_bf16 v[116:119], v[72:75], v[20:23], v[116:119]
    v_bitop3_b32 v120, v20, v22, s17 bitop3:0x7e
    v_bitop3_b32 v127, v127, v120, 1 bitop3:0xa8
    v_cmp_ne_u32 vcc, 0, v127
    s_cbranch_vccnz L_h1_s2b
    v_add_f32_dpp v116, v116, v116 row_ror:4 row_mask:0xf bank_mask:0xf
    v_add_f32_dpp v117, v117, v117 row_ror:4 row_mask:0xf bank_mask:0xf
    s_nop 0
    v_add_f32_dpp v116, v116, v116 row_ror:8 row_mask:0xf bank_mask:0xf
    v_add_f32_dpp v117, v117, v117 row_ror:8 row_mask:0xf bank_mask:0xf
    v_cvt_pk_bf16_f32 v116, v116, v117
    v_min_u32 v116, -2, v116
    buffer_store_dword v116, v4, s[52:55], s25 offen sc1
L_h1_s2_ok:
    s_xor_b32 s17, s17, 1
    s_mov_b32 s13, 0
    ds_read_b128 v[72:75], v8 offset:384
    s_nop 14
    buffer_load_dwordx4 v[16:19], v1, s[52:55], s25 offen offset:2048 sc1
    s_nop 15
    s_nop 15
    buffer_load_dwordx4 v[20:23], v1, s[52:55], s25 offen offset:2048 sc1
    s_waitcnt lgkmcnt(0)
    s_branch L_h2a_s2
L_h1_s2f:
    buffer_load_dwordx4 v[100:103], v1, s[52:55], s22 offen sc1
    buffer_load_dwordx4 v[104:107], v1, s[52:55], s22 offen offset:1024 sc1
    s_add_u32 s13, s13, 1
    s_cmp_lt_u32 s13, 1048576
    s_cbranch_scc1 L_h1_s2a
    s_branch L_end
L_h1_s2b:
    buffer_load_dwordx4 v[16:19], v1, s[52:55], s22 offen sc1
    buffer_load_dwordx4 v[20:23], v1, s[52:55], s22 offen offset:1024 sc1
    s_waitcnt vmcnt(3)
    v_mfma_f32_16x16x32_bf16 v[116:119], v[72:75], v[100:103], 0
    v_bitop3_b32 v127, v100, v102, s17 bitop3:0x7e
    s_waitcnt vmcnt(2)
    v_mfma_f32_16x16x32_bf16 v[116:119], v[72:75], v[104:107], v[116:119]
    v_bitop3_b32 v120, v104, v106, s17 bitop3:0x7e
    v_bitop3_b32 v127, v127, v120, 1 bitop3:0xa8
    v_cmp_ne_u32 vcc, 0, v127
    s_cbranch_vccnz L_h1_s2f
    v_add_f32_dpp v116, v116, v116 row_ror:4 row_mask:0xf bank_mask:0xf
    v_add_f32_dpp v117, v117, v117 row_ror:4 row_mask:0xf bank_mask:0xf
    s_nop 0
    v_add_f32_dpp v116, v116, v116 row_ror:8 row_mask:0xf bank_mask:0xf
    v_add_f32_dpp v117, v117, v117 row_ror:8 row_mask:0xf bank_mask:0xf
    v_cvt_pk_bf16_f32 v116, v116, v117
    v_min_u32 v116, -2, v116
    buffer_store_dword v116, v4, s[52:55], s25 offen sc1
    s_branch L_h1_s2_ok
L_lf_s2:
    s_mov_b32 s13, 0
L_lf1_s2:
    buffer_load_dwordx4 v[104:107], v1, s[52:55], s92 offen offset:2048 sc1
    s_waitcnt vmcnt(0)
    v_max3_u32 v127, v104, v105, v106
    v_max_u32 v127, v127, v107
    v_cmp_eq_u32 vcc, -1, v127
    ds_write_b128 v14, v[104:107] offset:6144
    s_cbranch_vccz L_lr_s2
    s_add_u32 s13, s13, 1
    s_cmp_lt_u32 s13, 1048576
    s_cbranch_scc1 L_lf1_s2
    s_branch L_end
L_c62_s2:
    s_mov_b32 s24, s28
    ds_read_b128 v[108:111], v8 offset:384
    buffer_store_dword v122, v11, s[52:55], s24 offen sc1
    buffer_store_dword v124, v11, s[52:55], s24 offen offset:256 sc1
    s_waitcnt lgkmcnt(0)
    buffer_store_dwordx4 v[108:111], v10, s[52:55], s24 offen sc1
    s_branch L_c62r_s2
L_h2b_s3_fail:
    buffer_load_dwordx4 v[20:23], v1, s[52:55], s25 offen offset:3072 sc1
    s_add_u32 s13, s13, 1
    s_nop 4
    v_mov_b64 v[48:49], 0
    v_mov_b64 v[50:51], 0
    v_mov_b64 v[52:53], 0
    v_mov_b64 v[54:55], 0
    s_cmp_lt_u32 s13, 1048576
    s_cbranch_scc1 L_h2a_s3
    s_branch L_end
.p2align 6
    s_nop 0
    s_nop 0
    s_nop 0
L_h2b_s3:
    buffer_load_dwordx4 v[16:19], v1, s[52:55], s25 offen offset:3072 sc1
    s_nop 5
    v_mov_b64 v[48:49], 0
    v_mov_b64 v[50:51], 0
    v_mov_b64 v[52:53], 0
    v_mov_b64 v[54:55], 0
    s_waitcnt vmcnt(1)
L_h2b_s3_go:
    v_max3_u32 v127, v20, v21, v22
    v_max_u32 v127, v127, v23
    v_cmp_eq_u32 vcc, -1, v127
    v_smfmac_f32_16x16x64_bf16 v[48:51], v[20:23], v[24:31], v2
    ds_write_b128 v14, v[20:23] offset:3072
    v_smfmac_f32_16x16x64_bf16 v[52:55], v[20:23], v[32:39], v2
    s_cbranch_vccnz L_h2b_s3_fail
    v_smfmac_f32_16x16x64_bf16 v[56:59], v[20:23], v[40:47], v2
    buffer_load_dwordx4 v[104:107], v1, s[52:55], s92 offen offset:3072 sc1
    s_waitcnt lgkmcnt(0)
    s_barrier
    ds_read_b128 v[24:27], v14 offset:2048
    v_smfmac_f32_16x16x64_bf16 v[60:63], v[20:23], v[76:83], v2
    ds_read_b128 v[28:31], v14 offset:1024
    v_smfmac_f32_16x16x64_bf16 v[64:67], v[20:23], v[84:91], v2
    ds_read_b128 v[32:35], v14 offset:0
    v_smfmac_f32_16x16x64_bf16 v[68:71], v[20:23], v[92:99], v2
    s_branch L_cbody_s3
.p2align 6
    s_nop 0
    s_nop 0
    s_nop 0
L_h2a_s3:
    s_waitcnt vmcnt(1)
L_h2a_s3_go:
    v_max3_u32 v127, v16, v17, v18
    v_max_u32 v127, v127, v19
    v_cmp_eq_u32 vcc, -1, v127
    v_smfmac_f32_16x16x64_bf16 v[48:51], v[16:19], v[24:31], v2
    ds_write_b128 v14, v[16:19] offset:3072
    v_smfmac_f32_16x16x64_bf16 v[52:55], v[16:19], v[32:39], v2
    s_cbranch_vccnz L_h2b_s3
    v_smfmac_f32_16x16x64_bf16 v[56:59], v[16:19], v[40:47], v2
    buffer_load_dwordx4 v[104:107], v1, s[52:55], s92 offen offset:3072 sc1
    s_waitcnt lgkmcnt(0)
    s_barrier
    ds_read_b128 v[24:27], v14 offset:2048
    v_smfmac_f32_16x16x64_bf16 v[60:63], v[16:19], v[76:83], v2
    ds_read_b128 v[28:31], v14 offset:1024
    v_smfmac_f32_16x16x64_bf16 v[64:67], v[16:19], v[84:91], v2
    ds_read_b128 v[32:35], v14 offset:0
    v_smfmac_f32_16x16x64_bf16 v[68:71], v[16:19], v[92:99], v2
L_cbody_s3:
    s_waitcnt lgkmcnt(2)
    v_smfmac_f32_16x16x64_bf16 v[48:51], v[24:27], a[16:23], v2
    v_smfmac_f32_16x16x64_bf16 v[52:55], v[24:27], a[80:87], v2
    v_smfmac_f32_16x16x64_bf16 v[56:59], v[24:27], a[144:151], v2
    s_waitcnt lgkmcnt(0)
    v_smfmac_f32_16x16x64_bf16 v[60:63], v[24:27], a[208:215], v2
    buffer_load_dwordx4 v1, s[52:55], s21 offen sc1 lds
    v_smfmac_f32_16x16x64_bf16 v[48:51], v[28:31], a[24:31], v2
    v_smfmac_f32_16x16x64_bf16 v[52:55], v[28:31], a[88:95], v2
    buffer_load_dwordx4 v[16:19], v1, s[52:55], s20 offen sc1
    v_smfmac_f32_16x16x64_bf16 v[56:59], v[28:31], a[152:159], v2
    v_smfmac_f32_16x16x64_bf16 v[60:63], v[28:31], a[216:223], v2
    buffer_load_dwordx4 v1, s[52:55], s21 offen offset:1024 sc1 lds
    s_waitcnt vmcnt(3)
    v_max3_u32 v127, v104, v105, v106
    v_max_u32 v127, v127, v107
    v_cmp_eq_u32 vcc, -1, v127
    v_smfmac_f32_16x16x64_bf16 v[48:51], v[32:35], a[32:39], v2
    buffer_load_dwordx4 v[20:23], v1, s[52:55], s20 offen offset:1024 sc1
    ds_write_b128 v14, v[104:107] offset:7168
    v_smfmac_f32_16x16x64_bf16 v[52:55], v[32:35], a[96:103], v2
    s_cbranch_vccnz L_lf_s3
L_lr_s3:
    v_smfmac_f32_16x16x64_bf16 v[48:51], v[104:107], a[8:15], v2
    v_smfmac_f32_16x16x64_bf16 v[52:55], v[104:107], a[72:79], v2
    v_smfmac_f32_16x16x64_bf16 v[56:59], v[104:107], a[136:143], v2
    s_waitcnt lgkmcnt(0)
    s_barrier
    ds_read_b128 v[36:39], v14 offset:6144
    v_smfmac_f32_16x16x64_bf16 v[60:63], v[104:107], a[200:207], v2
    ds_read_b128 v[40:43], v14 offset:5120
    v_smfmac_f32_16x16x64_bf16 v[64:67], v[104:107], v[136:143], v2
    ds_read_b128 v[44:47], v14 offset:4096
    v_smfmac_f32_16x16x64_bf16 v[68:71], v[104:107], v[200:207], v2
    buffer_store_dwordx4 v[72:75], v10, s[52:55], s24 offen sc1
    v_smfmac_f32_16x16x64_bf16 v[56:59], v[32:35], a[160:167], v2
    v_smfmac_f32_16x16x64_bf16 v[60:63], v[32:35], a[224:231], v2
    s_waitcnt lgkmcnt(0)
    v_smfmac_f32_16x16x64_bf16 v[48:51], v[36:39], a[40:47], v2
    v_smfmac_f32_16x16x64_bf16 v[52:55], v[36:39], a[104:111], v2
    buffer_store_dword v122, v11, s[52:55], s24 offen sc1
    ds_read_b128 v[92:95], v15 offset:0
    v_smfmac_f32_16x16x64_bf16 v[48:51], v[40:43], a[48:55], v2
    ds_read_b128 v[96:99], v15 offset:1024
    v_smfmac_f32_16x16x64_bf16 v[52:55], v[40:43], a[112:119], v2
    ds_read_b128 v[100:103], v15 offset:2048
    v_smfmac_f32_16x16x64_bf16 v[48:51], v[44:47], a[56:63], v2
    ds_read_b128 v[104:107], v15 offset:3072
    v_smfmac_f32_16x16x64_bf16 v[52:55], v[44:47], a[120:127], v2
    buffer_store_dword v124, v11, s[52:55], s24 offen offset:256 sc1
    v_smfmac_f32_16x16x64_bf16 v[56:59], v[36:39], a[168:175], v2
    v_add_f32 v48, v48, v50
    v_smfmac_f32_16x16x64_bf16 v[60:63], v[36:39], a[232:239], v2
    v_add_f32 v49, v49, v51
    v_smfmac_f32_16x16x64_bf16 v[56:59], v[40:43], a[176:183], v2
    v_add_f32 v52, v52, v54
    v_smfmac_f32_16x16x64_bf16 v[60:63], v[40:43], a[240:247], v2
    v_add_f32 v53, v53, v55
    v_smfmac_f32_16x16x64_bf16 v[56:59], v[44:47], a[184:191], v2
    v_cvt_pk_bf16_f32 v118, v48, v52
    v_smfmac_f32_16x16x64_bf16 v[60:63], v[44:47], a[248:255], v2
    v_cvt_pk_bf16_f32 v119, v49, v53
    v_smfmac_f32_16x16x64_bf16 v[64:67], v[24:27], v[144:151], v2
    ds_write2_b32 v6, v118, v119 offset0:0 offset1:136
    v_add_f32 v56, v56, v58
    v_add_f32 v57, v57, v59
    v_smfmac_f32_16x16x64_bf16 v[68:71], v[24:27], v[208:215], v2
    v_add_f32 v60, v60, v62
    v_add_f32 v61, v61, v63
    v_cvt_pk_bf16_f32 v116, v56, v60
    v_cvt_pk_bf16_f32 v117, v57, v61
    v_smfmac_f32_16x16x64_bf16 v[64:67], v[28:31], v[152:159], v2
    ds_write2_b32 v6, v116, v117 offset0:64 offset1:200
    v_smfmac_f32_16x16x64_bf16 v[68:71], v[28:31], v[216:223], v2
    buffer_store_dword v5, v4, s[52:55], s26 offen sc1
    v_smfmac_f32_16x16x64_bf16 v[64:67], v[32:35], v[160:167], v2
    v_smfmac_f32_16x16x64_bf16 v[68:71], v[32:35], v[224:231], v2
    s_cmp_eq_u32 s16, 63
    v_smfmac_f32_16x16x64_bf16 v[64:67], v[36:39], v[168:175], v2
    s_waitcnt lgkmcnt(0)
    s_barrier
    ds_read_b128 v[76:79], v8 offset:0
    v_smfmac_f32_16x16x64_bf16 v[68:71], v[36:39], v[232:239], v2
    ds_read_b128 v[80:83], v8 offset:64
    v_smfmac_f32_16x16x64_bf16 v[64:67], v[40:43], v[176:183], v2
    ds_read_b128 v[84:87], v8 offset:128
    v_smfmac_f32_16x16x64_bf16 v[68:71], v[40:43], v[240:247], v2
    ds_read_b128 v[88:91], v8 offset:192
    v_smfmac_f32_16x16x64_bf16 v[64:67], v[44:47], v[184:191], v2
    ds_read_b128 v[24:27], v8 offset:256
    v_smfmac_f32_16x16x64_bf16 v[68:71], v[44:47], v[248:255], v2
    s_cbranch_scc1 L_clast
    ds_read_b128 v[28:31], v8 offset:320
    s_waitcnt lgkmcnt(4)
    v_mfma_f32_16x16x32_bf16 v[48:51], v[92:95], v[76:79], 0
    ds_read_b128 v[56:59], v8 offset:384
    v_mfma_f32_16x16x32_bf16 v[48:51], v[96:99], v[80:83], v[48:51]
    ds_read_b128 v[60:63], v8 offset:448
    s_waitcnt lgkmcnt(4)
    v_mfma_f32_16x16x32_bf16 v[48:51], v[100:103], v[84:87], v[48:51]
    ds_read_b128 v[92:95], v15 offset:4096
    v_add_f32 v64, v64, v66
    v_mfma_f32_16x16x32_bf16 v[48:51], v[104:107], v[88:91], v[48:51]
    ds_read_b128 v[96:99], v15 offset:5120
    s_waitcnt lgkmcnt(4)
    v_mfma_f32_16x16x32_bf16 v[72:75], v[24:27], v[76:79], 0
    ds_read_b128 v[100:103], v15 offset:6144
    v_add_f32 v65, v65, v67
    v_mfma_f32_16x16x32_bf16 v[72:75], v[28:31], v[80:83], v[72:75]
    ds_read_b128 v[104:107], v15 offset:7168
    s_waitcnt lgkmcnt(4)
    v_mfma_f32_16x16x32_bf16 v[72:75], v[56:59], v[84:87], v[72:75]
    v_add_f32 v68, v68, v70
    v_add_f32 v69, v69, v71
    v_mfma_f32_16x16x32_bf16 v[72:75], v[60:63], v[88:91], v[72:75]
    s_waitcnt lgkmcnt(2)
    v_cvt_pk_bf16_f32 v122, v64, v65
    v_mfma_f32_16x16x32_bf16 v[52:55], v[92:95], v[76:79], 0
    v_cvt_pk_bf16_f32 v124, v68, v69
    v_max3_f32 v118, v48, v49, v50
    v_mfma_f32_16x16x32_bf16 v[52:55], v[96:99], v[80:83], v[52:55]
    s_waitcnt lgkmcnt(0)
    v_mov_b32 v64, 0x3f803f80
    v_mfma_f32_16x16x32_bf16 v[52:55], v[100:103], v[84:87], v[52:55]
    ds_read_b128 v[24:27], v13 offset:38912
    v_max3_f32 v118, v118, v51, v72
    v_mfma_f32_16x16x32_bf16 v[52:55], v[104:107], v[88:91], v[52:55]
    ds_read_b128 v[28:31], v13 offset:39936
    ds_read_b128 v[32:35], v12 offset:2048
    v_mov_b32 v65, v64
    v_max_f32 v118, v118, v73
    v_mov_b64 v[66:67], v[64:65]
    v_mov_b64 v[68:69], 0
    v_mov_b64 v[70:71], 0
    s_nop 0
    v_max3_f32 v118, v118, v52, v53
    v_max3_f32 v74, v118, v54, v55
    v_mov_b32 v75, v74
    s_nop 1
    v_permlane16_swap_b32 v74, v75
    v_max_f32 v74, v74, v75
    v_mov_b32 v75, v74
    s_nop 1
    v_permlane32_swap_b32 v74, v75
    v_max_f32 v74, v74, v75
    v_mul_f32 v74, s32, v74
    v_pk_fma_f32 v[48:49], v[48:49], s[32:33], v[74:75] op_sel_hi:[1,1,0] neg_lo:[0,0,1] neg_hi:[0,0,1]
    v_pk_fma_f32 v[50:51], v[50:51], s[32:33], v[74:75] op_sel_hi:[1,1,0] neg_lo:[0,0,1] neg_hi:[0,0,1]
    v_pk_fma_f32 v[52:53], v[52:53], s[32:33], v[74:75] op_sel_hi:[1,1,0] neg_lo:[0,0,1] neg_hi:[0,0,1]
    v_pk_fma_f32 v[54:55], v[54:55], s[32:33], v[74:75] op_sel_hi:[1,1,0] neg_lo:[0,0,1] neg_hi:[0,0,1]
    v_pk_fma_f32 v[72:73], v[72:73], s[32:33], v[74:75] op_sel_hi:[1,1,0] neg_lo:[0,0,1] neg_hi:[0,0,1]
    v_exp_f32 v72, v72
    v_exp_f32 v73, v73
    v_exp_f32 v48, v48
    v_cvt_pk_bf16_f32 v120, v72, v73
    v_exp_f32 v49, v49
    v_exp_f32 v50, v50
    v_mfma_f32_16x16x16_bf16 v[72:75], v[64:65], v[120:121], 0
    ds_read_b128 v[36:39], v12 offset:3072
    v_exp_f32 v51, v51
    v_exp_f32 v52, v52
    v_mfma_f32_16x16x16_bf16 v[56:59], v[122:123], v[120:121], 0
    ds_read_b128 v[40:43], v12 offset:0
    v_exp_f32 v53, v53
    v_exp_f32 v54, v54
    v_mfma_f32_16x16x16_bf16 v[60:63], v[124:125], v[120:121], 0
    ds_read_b128 v[44:47], v12 offset:1024
    v_exp_f32 v55, v55
    v_cvt_pk_bf16_f32 v116, v48, v49
    v_cvt_pk_bf16_f32 v117, v50, v51
    v_cvt_pk_bf16_f32 v118, v52, v53
    v_cvt_pk_bf16_f32 v119, v54, v55
    v_mov_b64 v[48:49], 0
    v_mov_b64 v[50:51], 0
    v_mfma_f32_16x16x32_bf16 v[72:75], v[64:67], v[116:119], v[72:75]
    ds_read_b128 v[76:79], v12 offset:6144
    v_mov_b64 v[52:53], 0
    v_mfma_f32_16x16x32_bf16 v[56:59], v[108:111], v[116:119], v[56:59]
    ds_read_b128 v[80:83], v12 offset:7168
    v_mov_b64 v[54:55], 0
    v_mfma_f32_16x16x32_bf16 v[60:63], v[112:115], v[116:119], v[60:63]
    ds_read_b128 v[84:87], v12 offset:4096
    v_rcp_f32 v120, v72
    v_mov_b64 v[116:117], 0
    s_nop 0
    v_pk_mul_f32 v[56:57], v[56:57], v[120:121] op_sel_hi:[1,0]
    v_pk_mul_f32 v[58:59], v[58:59], v[120:121] op_sel_hi:[1,0]
    v_cvt_pk_bf16_f32 v56, v56, v57
    v_cvt_pk_bf16_f32 v57, v58, v59
    v_pk_mul_f32 v[60:61], v[60:61], v[120:121] op_sel_hi:[1,0]
    v_pk_mul_f32 v[62:63], v[62:63], v[120:121] op_sel_hi:[1,0]
    v_cvt_pk_bf16_f32 v58, v60, v61
    v_cvt_pk_bf16_f32 v59, v62, v63
    v_cndmask_b32 v60, v56, v58, s[48:49]
    v_cndmask_b32 v61, v57, v59, s[48:49]
    ds_write_b64 v7, v[60:61] offset:1536
    s_waitcnt lgkmcnt(1)
    v_smfmac_f32_16x16x64_bf16 v[48:51], v[56:59], a[64:71], v2
    ds_read_b128 v[88:91], v12 offset:5120
    v_mov_b64 v[118:119], 0
    v_smfmac_f32_16x16x64_bf16 v[52:55], v[56:59], a[192:199], v2
    ds_read_b128 v[92:95], v12 offset:10240
    v_smfmac_f32_16x16x64_bf16 v[68:71], v[56:59], v[192:199], v2
    ds_read_b128 v[96:99], v12 offset:11264
    s_waitcnt lgkmcnt(3)
    s_barrier
    ds_read_b128 v[60:63], v9 offset:1024
    ds_read_b128 v[64:67], v9 offset:512
    ds_read_b128 v[72:75], v9 offset:0
    v_smfmac_f32_16x16x64_bf16 v[116:119], v[56:59], v[24:31], v2
    s_cmp_eq_u32 s16, 62
    s_cbranch_scc1 L_c62_s3
L_c62r_s3:
    s_waitcnt lgkmcnt(2)
    v_smfmac_f32_16x16x64_bf16 v[48:51], v[60:63], a[0:7], v2
    ds_read_b128 v[100:103], v12 offset:8192
    s_waitcnt lgkmcnt(2)
    v_smfmac_f32_16x16x64_bf16 v[48:51], v[64:67], v[32:39], v2
    ds_read_b128 v[104:107], v12 offset:9216
    s_waitcnt lgkmcnt(2)
    v_smfmac_f32_16x16x64_bf16 v[48:51], v[72:75], v[40:47], v2
    ds_read_b128 v[108:111], v13 offset:36864
    ds_read_b128 v[112:115], v13 offset:37888
    v_smfmac_f32_16x16x64_bf16 v[52:55], v[60:63], a[128:135], v2
    ds_read_b128 v[24:27], v12 offset:14336
    ds_read_b128 v[28:31], v12 offset:15360
    v_smfmac_f32_16x16x64_bf16 v[52:55], v[64:67], v[76:83], v2
    v_cvt_pk_bf16_f32 v48, v48, v49
    v_cvt_pk_bf16_f32 v49, v50, v51
    v_and_or_b32 v48, v48, -2, s17
    v_smfmac_f32_16x16x64_bf16 v[52:55], v[72:75], v[84:91], v2
    buffer_store_dwordx2 v[48:49], v3, s[52:55], s18 offen offset:0 sc1
    s_waitcnt lgkmcnt(4)
    v_smfmac_f32_16x16x64_bf16 v[68:71], v[60:63], v[128:135], v2
    ds_read_b128 v[32:35], v12 offset:12288
    ds_read_b128 v[36:39], v12 offset:13312
    v_smfmac_f32_16x16x64_bf16 v[68:71], v[64:67], v[92:99], v2
    v_cvt_pk_bf16_f32 v52, v52, v53
    v_cvt_pk_bf16_f32 v53, v54, v55
    v_and_or_b32 v52, v52, -2, s17
    v_smfmac_f32_16x16x64_bf16 v[68:71], v[72:75], v[100:107], v2
    buffer_store_dwordx2 v[52:53], v3, s[52:55], s18 offen offset:2048 sc1
    s_waitcnt lgkmcnt(2)
    v_smfmac_f32_16x16x64_bf16 v[116:119], v[60:63], v[108:115], v2
    v_smfmac_f32_16x16x64_bf16 v[116:119], v[64:67], v[24:31], v2
    v_cvt_pk_bf16_f32 v68, v68, v69
    v_cvt_pk_bf16_f32 v69, v70, v71
    v_and_or_b32 v68, v68, -2, s17
    s_waitcnt lgkmcnt(0)
    v_smfmac_f32_16x16x64_bf16 v[116:119], v[72:75], v[32:39], v2
    buffer_store_dwordx2 v[68:69], v3, s[52:55], s19 offen offset:0 sc1
    s_nop 6
    v_cvt_pk_bf16_f32 v116, v116, v117
    v_cvt_pk_bf16_f32 v117, v118, v119
    v_and_or_b32 v116, v116, -2, s17
    buffer_store_dwordx2 v[116:117], v3, s[52:55], s19 offen offset:2048 sc1
    ds_read_b128 v[72:75], v14 offset:31232
    s_waitcnt vmcnt(8)
    v_mov_b64 v[108:109], v[16:17]
    v_mov_b64 v[110:111], v[18:19]
    v_mov_b64 v[112:113], v[20:21]
    v_mov_b64 v[114:115], v[22:23]
    v_mov_b64 v[48:49], 0
    v_mov_b64 v[50:51], 0
    v_mov_b64 v[52:53], 0
    v_mov_b64 v[54:55], 0
    v_mov_b64 v[56:57], 0
    v_mov_b64 v[58:59], 0
    v_mov_b64 v[60:61], 0
    v_mov_b64 v[62:63], 0
    v_mov_b64 v[68:69], 0
    v_mov_b64 v[70:71], 0
    v_mov_b64 v[64:65], 0
    v_mov_b64 v[66:67], 0
    v_xor_b32 v15, 0x6000, v15
    s_add_u32 s16, s16, 1
    s_add_u32 s20, s20, 524288
    s_add_u32 s21, s21, 524288
    s_mov_b32 s24, s28
    s_add_u32 s28, s28, 131072
    s_xor_b32 s31, s31, 0x6000
    s_mov_b32 m0, s31
    s_mov_b32 s13, 0
    s_mov_b32 s26, s25
    s_and_b32 s15, s16, 3
    s_lshl_b32 s15, s15, 13
    s_add_u32 s25, s23, s15
    s_add_u32 s92, s25, 4096
    s_cmp_eq_u32 s16, 63
    s_cselect_b32 s21, 0x40000000, s21
    s_cselect_b32 s20, 0x40000000, s20
    ds_read_b128 v[24:27], v13 offset:0
    ds_read_b128 v[28:31], v13 offset:1024
    ds_read_b128 v[32:35], v13 offset:2048
    ds_read_b128 v[36:39], v13 offset:3072
    ds_read_b128 v[40:43], v13 offset:4096
    ds_read_b128 v[44:47], v13 offset:5120
    ds_read_b128 v[76:79], v13 offset:6144
    ds_read_b128 v[80:83], v13 offset:7168
    ds_read_b128 v[84:87], v13 offset:32768
    ds_read_b128 v[88:91], v13 offset:33792
    ds_read_b128 v[92:95], v13 offset:34816
    buffer_load_dwordx4 v[16:19], v1, s[52:55], s22 offen sc1
    buffer_load_dwordx4 v[20:23], v1, s[52:55], s22 offen offset:1024 sc1
    ds_read_b128 v[96:99], v13 offset:35840
    s_nop 15
    s_nop 13
    buffer_load_dwordx4 v[100:103], v1, s[52:55], s22 offen sc1
    buffer_load_dwordx4 v[104:107], v1, s[52:55], s22 offen offset:1024 sc1
    s_waitcnt lgkmcnt(0)
L_h1_s3a:
    s_waitcnt vmcnt(3)
    v_mfma_f32_16x16x32_bf16 v[116:119], v[72:75], v[16:19], 0
    v_bitop3_b32 v127, v16, v18, s17 bitop3:0x7e
    s_waitcnt vmcnt(2)
    v_mfma_f32_16x16x32_bf16 v[116:119], v[72:75], v[20:23], v[116:119]
    v_bitop3_b32 v120, v20, v22, s17 bitop3:0x7e
    v_bitop3_b32 v127, v127, v120, 1 bitop3:0xa8
    v_cmp_ne_u32 vcc, 0, v127
    s_cbranch_vccnz L_h1_s3b
    v_add_f32_dpp v116, v116, v116 row_ror:4 row_mask:0xf bank_mask:0xf
    v_add_f32_dpp v117, v117, v117 row_ror:4 row_mask:0xf bank_mask:0xf
    s_nop 0
    v_add_f32_dpp v116, v116, v116 row_ror:8 row_mask:0xf bank_mask:0xf
    v_add_f32_dpp v117, v117, v117 row_ror:8 row_mask:0xf bank_mask:0xf
    v_cvt_pk_bf16_f32 v116, v116, v117
    v_min_u32 v116, -2, v116
    buffer_store_dword v116, v4, s[52:55], s25 offen sc1
L_h1_s3_ok:
    s_xor_b32 s17, s17, 1
    s_mov_b32 s13, 0
    ds_read_b128 v[72:75], v8 offset:448
    s_nop 15
    s_nop 2
    buffer_load_dwordx4 v[16:19], v1, s[52:55], s25 offen offset:3072 sc1
    s_nop 15
    s_nop 12
    buffer_load_dwordx4 v[20:23], v1, s[52:55], s25 offen offset:3072 sc1
    s_waitcnt lgkmcnt(0)
    s_branch L_h2a_s3
L_h1_s3f:
    buffer_load_dwordx4 v[100:103], v1, s[52:55], s22 offen sc1
    buffer_load_dwordx4 v[104:107], v1, s[52:55], s22 offen offset:1024 sc1
    s_add_u32 s13, s13, 1
    s_cmp_lt_u32 s13, 1048576
    s_cbranch_scc1 L_h1_s3a
    s_branch L_end
L_h1_s3b:
    buffer_load_dwordx4 v[16:19], v1, s[52:55], s22 offen sc1
    buffer_load_dwordx4 v[20:23], v1, s[52:55], s22 offen offset:1024 sc1
    s_waitcnt vmcnt(3)
    v_mfma_f32_16x16x32_bf16 v[116:119], v[72:75], v[100:103], 0
    v_bitop3_b32 v127, v100, v102, s17 bitop3:0x7e
    s_waitcnt vmcnt(2)
    v_mfma_f32_16x16x32_bf16 v[116:119], v[72:75], v[104:107], v[116:119]
    v_bitop3_b32 v120, v104, v106, s17 bitop3:0x7e
    v_bitop3_b32 v127, v127, v120, 1 bitop3:0xa8
    v_cmp_ne_u32 vcc, 0, v127
    s_cbranch_vccnz L_h1_s3f
    v_add_f32_dpp v116, v116, v116 row_ror:4 row_mask:0xf bank_mask:0xf
    v_add_f32_dpp v117, v117, v117 row_ror:4 row_mask:0xf bank_mask:0xf
    s_nop 0
    v_add_f32_dpp v116, v116, v116 row_ror:8 row_mask:0xf bank_mask:0xf
    v_add_f32_dpp v117, v117, v117 row_ror:8 row_mask:0xf bank_mask:0xf
    v_cvt_pk_bf16_f32 v116, v116, v117
    v_min_u32 v116, -2, v116
    buffer_store_dword v116, v4, s[52:55], s25 offen sc1
    s_branch L_h1_s3_ok
L_lf_s3:
    s_mov_b32 s13, 0
L_lf1_s3:
    buffer_load_dwordx4 v[104:107], v1, s[52:55], s92 offen offset:3072 sc1
    s_waitcnt vmcnt(0)
    v_max3_u32 v127, v104, v105, v106
    v_max_u32 v127, v127, v107
    v_cmp_eq_u32 vcc, -1, v127
    ds_write_b128 v14, v[104:107] offset:7168
    s_cbranch_vccz L_lr_s3
    s_add_u32 s13, s13, 1
    s_cmp_lt_u32 s13, 1048576
    s_cbranch_scc1 L_lf1_s3
    s_branch L_end
L_c62_s3:
    s_mov_b32 s24, s28
    ds_read_b128 v[108:111], v8 offset:448
    buffer_store_dword v122, v11, s[52:55], s24 offen sc1
    buffer_store_dword v124, v11, s[52:55], s24 offen offset:256 sc1
    s_waitcnt lgkmcnt(0)
    buffer_store_dwordx4 v[108:111], v10, s[52:55], s24 offen sc1
    s_branch L_c62r_s3
L_clast:
    s_lshl_b32 s14, s3, 6
    v_add_u32 v118, s14, v8
    ds_read_b128 v[72:75], v118 offset:256
    s_cmp_eq_u32 s3, 0
    s_cselect_b32 s51, s30, 0x40000000
    s_mov_b32 s24, s28
    v_mov_b32 v116, 64
    s_nop 2
    v_pk_add_f32 v[64:65], v[64:65], v[66:67]
    v_pk_add_f32 v[68:69], v[68:69], v[70:71]
    v_cvt_pk_bf16_f32 v122, v64, v65
    v_cvt_pk_bf16_f32 v124, v68, v69
    buffer_store_dword v122, v11, s[52:55], s24 offen sc1
    buffer_store_dword v124, v11, s[52:55], s24 offen offset:256 sc1
    s_waitcnt lgkmcnt(0)
    buffer_store_dwordx4 v[72:75], v10, s[52:55], s24 offen sc1
    s_waitcnt vmcnt(0)
    s_barrier
    s_mov_b64 exec, 1
    buffer_store_dword v116, off, s[52:55], s51 sc1
    s_mov_b64 exec, -1
    s_endpgm
L_work:
    s_and_b32 s14, s4, 1
    s_lshl_b32 s14, s14, 4
    s_lshr_b32 s9, s5, 1
    s_add_u32 s9, s9, s14
    s_and_b32 s10, s5, 1
    s_lshl_b32 s84, s3, 10
    v_lshrrev_b32 v3, 4, v0
    v_lshlrev_b32 v4, 2, v3
    v_and_b32 v5, 15, v0
    v_xor_b32 v4, v4, v5
    v_lshlrev_b32 v4, 4, v4
    s_lshl_b32 s14, s3, 2
    v_add_u32 v3, s14, v3
    v_lshlrev_b32 v3, 13, v3
    s_lshl_b32 s14, s9, 8
    v_add3_u32 v2, v3, v4, s14
    s_lshl_b32 s14, s3, 6
    v_add_u32 v8, s14, v0
    v_lshlrev_b32 v8, 13, v8
    s_lshl_b32 s14, s9, 8
    s_lshl_b32 s15, s10, 7
    s_add_u32 s14, s14, s15
    v_add_u32 v8, s14, v8
    s_mov_b32 s51, 2097152
    v_mov_b32 v116, -1
    v_mov_b32 v117, -1
    v_mov_b32 v118, -1
    v_mov_b32 v119, -1
    s_lshl_b32 s14, s3, 10
    s_cmp_eq_u32 s7, 0
    s_cselect_b32 s14, s14, 0x40000000
    v_add_u32 v120, s14, v1
    s_lshl_b32 s14, s2, 12
    buffer_store_dwordx4 v[116:119], v120, s[52:55], s14 offen sc1
    s_add_u32 m0, s84, 0
    s_mov_b32 s50, 0
    buffer_load_dwordx4 v2, s[64:67], s50 offen  lds
    s_add_u32 m0, m0, 4096
    s_add_u32 s50, s50, 131072
    buffer_load_dwordx4 v2, s[64:67], s50 offen  lds
    s_add_u32 m0, m0, 4096
    s_add_u32 s50, s50, 131072
    buffer_load_dwordx4 v2, s[64:67], s50 offen  lds
    s_add_u32 m0, m0, 4096
    s_add_u32 s50, s50, 131072
    buffer_load_dwordx4 v2, s[64:67], s50 offen  lds
    s_add_u32 m0, m0, 4096
    s_add_u32 s50, s50, 131072
    buffer_load_dwordx4 v2, s[64:67], s50 offen  lds
    s_add_u32 m0, m0, 4096
    s_add_u32 s50, s50, 131072
    buffer_load_dwordx4 v2, s[64:67], s50 offen  lds
    s_add_u32 m0, m0, 4096
    s_add_u32 s50, s50, 131072
    buffer_load_dwordx4 v2, s[64:67], s50 offen  lds
    s_add_u32 m0, m0, 4096
    s_add_u32 s50, s50, 131072
    buffer_load_dwordx4 v2, s[64:67], s50 offen  lds
    s_add_u32 m0, m0, 4096
    s_add_u32 s50, s50, 131072
    buffer_load_dwordx4 v2, s[64:67], s50 offen  lds
    s_add_u32 m0, m0, 4096
    s_add_u32 s50, s50, 131072
    buffer_load_dwordx4 v2, s[64:67], s50 offen  lds
    s_add_u32 m0, m0, 4096
    s_add_u32 s50, s50, 131072
    buffer_load_dwordx4 v2, s[64:67], s50 offen  lds
    s_add_u32 m0, m0, 4096
    s_add_u32 s50, s50, 131072
    buffer_load_dwordx4 v2, s[64:67], s50 offen  lds
    s_add_u32 m0, m0, 4096
    s_add_u32 s50, s50, 131072
    buffer_load_dwordx4 v2, s[64:67], s50 offen  lds
    s_add_u32 m0, m0, 4096
    s_add_u32 s50, s50, 131072
    buffer_load_dwordx4 v2, s[64:67], s50 offen  lds
    s_add_u32 m0, m0, 4096
    s_add_u32 s50, s50, 131072
    buffer_load_dwordx4 v2, s[64:67], s50 offen  lds
    s_add_u32 m0, m0, 4096
    s_add_u32 s50, s50, 131072
    buffer_load_dwordx4 v2, s[64:67], s50 offen  lds
    s_add_u32 m0, s84, 65536
    s_mov_b32 s50, 2097152
    buffer_load_dwordx4 v2, s[64:67], s50 offen  lds
    s_add_u32 m0, m0, 4096
    s_add_u32 s50, s50, 131072
    buffer_load_dwordx4 v2, s[64:67], s50 offen  lds
    s_add_u32 m0, m0, 4096
    s_add_u32 s50, s50, 131072
    buffer_load_dwordx4 v2, s[64:67], s50 offen  lds
    s_add_u32 m0, m0, 4096
    s_add_u32 s50, s50, 131072
    buffer_load_dwordx4 v2, s[64:67], s50 offen  lds
    s_add_u32 m0, m0, 4096
    s_add_u32 s50, s50, 131072
    buffer_load_dwordx4 v2, s[64:67], s50 offen  lds
    s_add_u32 m0, m0, 4096
    s_add_u32 s50, s50, 131072
    buffer_load_dwordx4 v2, s[64:67], s50 offen  lds
    s_add_u32 m0, m0, 4096
    s_add_u32 s50, s50, 131072
    buffer_load_dwordx4 v2, s[64:67], s50 offen  lds
    s_add_u32 m0, m0, 4096
    s_add_u32 s50, s50, 131072
    buffer_load_dwordx4 v2, s[64:67], s50 offen  lds
    s_add_u32 m0, m0, 4096
    s_add_u32 s50, s50, 131072
    buffer_load_dwordx4 v2, s[64:67], s50 offen  lds
    s_add_u32 m0, m0, 4096
    s_add_u32 s50, s50, 131072
    buffer_load_dwordx4 v2, s[64:67], s50 offen  lds
    s_add_u32 m0, m0, 4096
    s_add_u32 s50, s50, 131072
    buffer_load_dwordx4 v2, s[64:67], s50 offen  lds
    s_add_u32 m0, m0, 4096
    s_add_u32 s50, s50, 131072
    buffer_load_dwordx4 v2, s[64:67], s50 offen  lds
    s_add_u32 m0, m0, 4096
    s_add_u32 s50, s50, 131072
    buffer_load_dwordx4 v2, s[64:67], s50 offen  lds
    s_add_u32 m0, m0, 4096
    s_add_u32 s50, s50, 131072
    buffer_load_dwordx4 v2, s[64:67], s50 offen  lds
    s_add_u32 m0, m0, 4096
    s_add_u32 s50, s50, 131072
    buffer_load_dwordx4 v2, s[64:67], s50 offen  lds
    s_add_u32 m0, m0, 4096
    s_add_u32 s50, s50, 131072
    buffer_load_dwordx4 v2, s[64:67], s50 offen  lds
    v_lshrrev_b32 v3, 5, v0
    v_bfe_u32 v4, v0, 2, 2
    v_lshl_add_u32 v3, v3, 3, v4
    v_lshlrev_b32 v3, 8, v3
    v_xor_b32 v4, s3, v4
    v_bfe_u32 v5, v0, 4, 1
    v_lshlrev_b32 v5, 1, v5
    v_lshl_add_u32 v4, v4, 2, v5
    v_lshl_add_u32 v3, v4, 4, v3
    v_and_b32 v4, 1, v0
    v_bfe_u32 v5, v0, 1, 1
    v_lshl_add_u32 v6, v4, 4, v3
    v_lshl_add_u32 v6, v5, 3, v6
    v_lshl_add_u32 v7, v5, 4, v3
    v_lshl_add_u32 v7, v4, 3, v7
    s_waitcnt vmcnt(16)
    s_barrier
    s_lshl_b32 s14, s12, 3
    s_or_b32 s15, s3, s7
    s_cmp_eq_u32 s15, 0
    s_cselect_b32 s14, s14, 0x40000000
    s_lshr_b32 s15, s2, 3
    s_lshl_b32 s15, 1, s15
    v_mov_b32 v126, s15
    v_mov_b32 v127, 0x100
    v_mov_b32 v14, s14
    v_cmp_eq_u32 vcc, 0, v0
    v_mov_b32 v15, 0x40000000
    s_nop 0
    v_cndmask_b32 v14, v15, v14, vcc
    buffer_atomic_add_x2 v[126:127], v14, s[56:59], 0 offen offset:128 sc0 sc1
    ds_read_b64_tr_b16 a[128:129], v6 offset:0
    ds_read_b64_tr_b16 a[130:131], v6 offset:1024
    ds_read_b64_tr_b16 a[132:133], v6 offset:4096
    ds_read_b64_tr_b16 a[134:135], v6 offset:5120
    ds_read_b64_tr_b16 a[136:137], v6 offset:8192
    ds_read_b64_tr_b16 a[138:139], v6 offset:9216
    ds_read_b64_tr_b16 a[140:141], v6 offset:12288
    ds_read_b64_tr_b16 a[142:143], v6 offset:13312
    ds_read_b64_tr_b16 a[144:145], v6 offset:16384
    ds_read_b64_tr_b16 a[146:147], v6 offset:17408
    ds_read_b64_tr_b16 a[148:149], v6 offset:20480
    ds_read_b64_tr_b16 a[150:151], v6 offset:21504
    ds_read_b64_tr_b16 a[152:153], v6 offset:24576
    ds_read_b64_tr_b16 a[154:155], v6 offset:25600
    ds_read_b64_tr_b16 a[156:157], v6 offset:28672
    ds_read_b64_tr_b16 a[158:159], v6 offset:29696
    ds_read_b64_tr_b16 a[160:161], v6 offset:32768
    ds_read_b64_tr_b16 a[162:163], v6 offset:33792
    ds_read_b64_tr_b16 a[164:165], v6 offset:36864
    ds_read_b64_tr_b16 a[166:167], v6 offset:37888
    ds_read_b64_tr_b16 a[168:169], v6 offset:40960
    ds_read_b64_tr_b16 a[170:171], v6 offset:41984
    ds_read_b64_tr_b16 a[172:173], v6 offset:45056
    ds_read_b64_tr_b16 a[174:175], v6 offset:46080
    ds_read_b64_tr_b16 a[176:177], v6 offset:49152
    ds_read_b64_tr_b16 a[178:179], v6 offset:50176
    ds_read_b64_tr_b16 a[180:181], v6 offset:53248
    ds_read_b64_tr_b16 a[182:183], v6 offset:54272
    ds_read_b64_tr_b16 a[184:185], v6 offset:57344
    ds_read_b64_tr_b16 a[186:187], v6 offset:58368
    ds_read_b64_tr_b16 a[188:189], v6 offset:61440
    ds_read_b64_tr_b16 a[190:191], v6 offset:62464
    v_xor_b32 v6, 0x10000, v6
    v_xor_b32 v7, 0x10000, v7
    s_waitcnt lgkmcnt(0)
    s_barrier
    s_add_u32 m0, s84, 0
    s_mov_b32 s50, 0
    buffer_load_dwordx4 v2, s[68:71], s50 offen  lds
    s_add_u32 m0, m0, 4096
    s_add_u32 s50, s50, 131072
    buffer_load_dwordx4 v2, s[68:71], s50 offen  lds
    s_add_u32 m0, m0, 4096
    s_add_u32 s50, s50, 131072
    buffer_load_dwordx4 v2, s[68:71], s50 offen  lds
    s_add_u32 m0, m0, 4096
    s_add_u32 s50, s50, 131072
    buffer_load_dwordx4 v2, s[68:71], s50 offen  lds
    s_add_u32 m0, m0, 4096
    s_add_u32 s50, s50, 131072
    buffer_load_dwordx4 v2, s[68:71], s50 offen  lds
    s_add_u32 m0, m0, 4096
    s_add_u32 s50, s50, 131072
    buffer_load_dwordx4 v2, s[68:71], s50 offen  lds
    s_add_u32 m0, m0, 4096
    s_add_u32 s50, s50, 131072
    buffer_load_dwordx4 v2, s[68:71], s50 offen  lds
    s_add_u32 m0, m0, 4096
    s_add_u32 s50, s50, 131072
    buffer_load_dwordx4 v2, s[68:71], s50 offen  lds
    s_add_u32 m0, m0, 4096
    s_add_u32 s50, s50, 131072
    buffer_load_dwordx4 v2, s[68:71], s50 offen  lds
    s_add_u32 m0, m0, 4096
    s_add_u32 s50, s50, 131072
    buffer_load_dwordx4 v2, s[68:71], s50 offen  lds
    s_add_u32 m0, m0, 4096
    s_add_u32 s50, s50, 131072
    buffer_load_dwordx4 v2, s[68:71], s50 offen  lds
    s_add_u32 m0, m0, 4096
    s_add_u32 s50, s50, 131072
    buffer_load_dwordx4 v2, s[68:71], s50 offen  lds
    s_add_u32 m0, m0, 4096
    s_add_u32 s50, s50, 131072
    buffer_load_dwordx4 v2, s[68:71], s50 offen  lds
    s_add_u32 m0, m0, 4096
    s_add_u32 s50, s50, 131072
    buffer_load_dwordx4 v2, s[68:71], s50 offen  lds
    s_add_u32 m0, m0, 4096
    s_add_u32 s50, s50, 131072
    buffer_load_dwordx4 v2, s[68:71], s50 offen  lds
    s_add_u32 m0, m0, 4096
    s_add_u32 s50, s50, 131072
    buffer_load_dwordx4 v2, s[68:71], s50 offen  lds
    s_waitcnt vmcnt(17)
    s_barrier
    ds_read_b64_tr_b16 a[192:193], v6 offset:0
    ds_read_b64_tr_b16 a[194:195], v6 offset:1024
    ds_read_b64_tr_b16 a[196:197], v6 offset:4096
    ds_read_b64_tr_b16 a[198:199], v6 offset:5120
    ds_read_b64_tr_b16 a[200:201], v6 offset:8192
    ds_read_b64_tr_b16 a[202:203], v6 offset:9216
    ds_read_b64_tr_b16 a[204:205], v6 offset:12288
    ds_read_b64_tr_b16 a[206:207], v6 offset:13312
    ds_read_b64_tr_b16 a[208:209], v6 offset:16384
    ds_read_b64_tr_b16 a[210:211], v6 offset:17408
    ds_read_b64_tr_b16 a[212:213], v6 offset:20480
    ds_read_b64_tr_b16 a[214:215], v6 offset:21504
    ds_read_b64_tr_b16 a[216:217], v6 offset:24576
    ds_read_b64_tr_b16 a[218:219], v6 offset:25600
    ds_read_b64_tr_b16 a[220:221], v6 offset:28672
    ds_read_b64_tr_b16 a[222:223], v6 offset:29696
    ds_read_b64_tr_b16 a[224:225], v6 offset:32768
    ds_read_b64_tr_b16 a[226:227], v6 offset:33792
    ds_read_b64_tr_b16 a[228:229], v6 offset:36864
    ds_read_b64_tr_b16 a[230:231], v6 offset:37888
    ds_read_b64_tr_b16 a[232:233], v6 offset:40960
    ds_read_b64_tr_b16 a[234:235], v6 offset:41984
    ds_read_b64_tr_b16 a[236:237], v6 offset:45056
    ds_read_b64_tr_b16 a[238:239], v6 offset:46080
    ds_read_b64_tr_b16 a[240:241], v6 offset:49152
    ds_read_b64_tr_b16 a[242:243], v6 offset:50176
    ds_read_b64_tr_b16 a[244:245], v6 offset:53248
    ds_read_b64_tr_b16 a[246:247], v6 offset:54272
    ds_read_b64_tr_b16 a[248:249], v6 offset:57344
    ds_read_b64_tr_b16 a[250:251], v6 offset:58368
    ds_read_b64_tr_b16 a[252:253], v6 offset:61440
    ds_read_b64_tr_b16 a[254:255], v6 offset:62464
    v_xor_b32 v6, 0x10000, v6
    v_xor_b32 v7, 0x10000, v7
    s_waitcnt lgkmcnt(0)
    s_barrier
    s_add_u32 m0, s84, 65536
    s_mov_b32 s50, 2097152
    buffer_load_dwordx4 v2, s[68:71], s50 offen  lds
    s_add_u32 m0, m0, 4096
    s_add_u32 s50, s50, 131072
    buffer_load_dwordx4 v2, s[68:71], s50 offen  lds
    s_add_u32 m0, m0, 4096
    s_add_u32 s50, s50, 131072
    buffer_load_dwordx4 v2, s[68:71], s50 offen  lds
    s_add_u32 m0, m0, 4096
    s_add_u32 s50, s50, 131072
    buffer_load_dwordx4 v2, s[68:71], s50 offen  lds
    s_add_u32 m0, m0, 4096
    s_add_u32 s50, s50, 131072
    buffer_load_dwordx4 v2, s[68:71], s50 offen  lds
    s_add_u32 m0, m0, 4096
    s_add_u32 s50, s50, 131072
    buffer_load_dwordx4 v2, s[68:71], s50 offen  lds
    s_add_u32 m0, m0, 4096
    s_add_u32 s50, s50, 131072
    buffer_load_dwordx4 v2, s[68:71], s50 offen  lds
    s_add_u32 m0, m0, 4096
    s_add_u32 s50, s50, 131072
    buffer_load_dwordx4 v2, s[68:71], s50 offen  lds
    s_add_u32 m0, m0, 4096
    s_add_u32 s50, s50, 131072
    buffer_load_dwordx4 v2, s[68:71], s50 offen  lds
    s_add_u32 m0, m0, 4096
    s_add_u32 s50, s50, 131072
    buffer_load_dwordx4 v2, s[68:71], s50 offen  lds
    s_add_u32 m0, m0, 4096
    s_add_u32 s50, s50, 131072
    buffer_load_dwordx4 v2, s[68:71], s50 offen  lds
    s_add_u32 m0, m0, 4096
    s_add_u32 s50, s50, 131072
    buffer_load_dwordx4 v2, s[68:71], s50 offen  lds
    s_add_u32 m0, m0, 4096
    s_add_u32 s50, s50, 131072
    buffer_load_dwordx4 v2, s[68:71], s50 offen  lds
    s_add_u32 m0, m0, 4096
    s_add_u32 s50, s50, 131072
    buffer_load_dwordx4 v2, s[68:71], s50 offen  lds
    s_add_u32 m0, m0, 4096
    s_add_u32 s50, s50, 131072
    buffer_load_dwordx4 v2, s[68:71], s50 offen  lds
    s_add_u32 m0, m0, 4096
    s_add_u32 s50, s50, 131072
    buffer_load_dwordx4 v2, s[68:71], s50 offen  lds
    s_waitcnt vmcnt(16)
    s_barrier
    ds_read_b64_tr_b16 v[128:129], v7 offset:0
    ds_read_b64_tr_b16 v[130:131], v7 offset:1024
    ds_read_b64_tr_b16 v[132:133], v7 offset:4096
    ds_read_b64_tr_b16 v[134:135], v7 offset:5120
    ds_read_b64_tr_b16 v[136:137], v7 offset:8192
    ds_read_b64_tr_b16 v[138:139], v7 offset:9216
    ds_read_b64_tr_b16 v[140:141], v7 offset:12288
    ds_read_b64_tr_b16 v[142:143], v7 offset:13312
    ds_read_b64_tr_b16 v[144:145], v7 offset:16384
    ds_read_b64_tr_b16 v[146:147], v7 offset:17408
    ds_read_b64_tr_b16 v[148:149], v7 offset:20480
    ds_read_b64_tr_b16 v[150:151], v7 offset:21504
    ds_read_b64_tr_b16 v[152:153], v7 offset:24576
    ds_read_b64_tr_b16 v[154:155], v7 offset:25600
    ds_read_b64_tr_b16 v[156:157], v7 offset:28672
    ds_read_b64_tr_b16 v[158:159], v7 offset:29696
    ds_read_b64_tr_b16 v[160:161], v7 offset:32768
    ds_read_b64_tr_b16 v[162:163], v7 offset:33792
    ds_read_b64_tr_b16 v[164:165], v7 offset:36864
    ds_read_b64_tr_b16 v[166:167], v7 offset:37888
    ds_read_b64_tr_b16 v[168:169], v7 offset:40960
    ds_read_b64_tr_b16 v[170:171], v7 offset:41984
    ds_read_b64_tr_b16 v[172:173], v7 offset:45056
    ds_read_b64_tr_b16 v[174:175], v7 offset:46080
    ds_read_b64_tr_b16 v[176:177], v7 offset:49152
    ds_read_b64_tr_b16 v[178:179], v7 offset:50176
    ds_read_b64_tr_b16 v[180:181], v7 offset:53248
    ds_read_b64_tr_b16 v[182:183], v7 offset:54272
    ds_read_b64_tr_b16 v[184:185], v7 offset:57344
    ds_read_b64_tr_b16 v[186:187], v7 offset:58368
    ds_read_b64_tr_b16 v[188:189], v7 offset:61440
    ds_read_b64_tr_b16 v[190:191], v7 offset:62464
    v_xor_b32 v6, 0x10000, v6
    v_xor_b32 v7, 0x10000, v7
    s_waitcnt lgkmcnt(0)
    s_barrier
    s_add_u32 m0, s84, 0
    s_mov_b32 s50, 0
    buffer_load_dwordx4 v2, s[60:63], s50 offen  lds
    s_add_u32 m0, m0, 4096
    s_add_u32 s50, s50, 131072
    buffer_load_dwordx4 v2, s[60:63], s50 offen  lds
    s_add_u32 m0, m0, 4096
    s_add_u32 s50, s50, 131072
    buffer_load_dwordx4 v2, s[60:63], s50 offen  lds
    s_add_u32 m0, m0, 4096
    s_add_u32 s50, s50, 131072
    buffer_load_dwordx4 v2, s[60:63], s50 offen  lds
    s_add_u32 m0, m0, 4096
    s_add_u32 s50, s50, 131072
    buffer_load_dwordx4 v2, s[60:63], s50 offen  lds
    s_add_u32 m0, m0, 4096
    s_add_u32 s50, s50, 131072
    buffer_load_dwordx4 v2, s[60:63], s50 offen  lds
    s_add_u32 m0, m0, 4096
    s_add_u32 s50, s50, 131072
    buffer_load_dwordx4 v2, s[60:63], s50 offen  lds
    s_add_u32 m0, m0, 4096
    s_add_u32 s50, s50, 131072
    buffer_load_dwordx4 v2, s[60:63], s50 offen  lds
    s_add_u32 m0, m0, 4096
    s_add_u32 s50, s50, 131072
    buffer_load_dwordx4 v2, s[60:63], s50 offen  lds
    s_add_u32 m0, m0, 4096
    s_add_u32 s50, s50, 131072
    buffer_load_dwordx4 v2, s[60:63], s50 offen  lds
    s_add_u32 m0, m0, 4096
    s_add_u32 s50, s50, 131072
    buffer_load_dwordx4 v2, s[60:63], s50 offen  lds
    s_add_u32 m0, m0, 4096
    s_add_u32 s50, s50, 131072
    buffer_load_dwordx4 v2, s[60:63], s50 offen  lds
    s_add_u32 m0, m0, 4096
    s_add_u32 s50, s50, 131072
    buffer_load_dwordx4 v2, s[60:63], s50 offen  lds
    s_add_u32 m0, m0, 4096
    s_add_u32 s50, s50, 131072
    buffer_load_dwordx4 v2, s[60:63], s50 offen  lds
    s_add_u32 m0, m0, 4096
    s_add_u32 s50, s50, 131072
    buffer_load_dwordx4 v2, s[60:63], s50 offen  lds
    s_add_u32 m0, m0, 4096
    s_add_u32 s50, s50, 131072
    buffer_load_dwordx4 v2, s[60:63], s50 offen  lds
    s_waitcnt vmcnt(16)
    s_barrier
    ds_read_b64_tr_b16 v[192:193], v7 offset:0
    ds_read_b64_tr_b16 v[194:195], v7 offset:1024
    ds_read_b64_tr_b16 v[196:197], v7 offset:4096
    ds_read_b64_tr_b16 v[198:199], v7 offset:5120
    ds_read_b64_tr_b16 v[200:201], v7 offset:8192
    ds_read_b64_tr_b16 v[202:203], v7 offset:9216
    ds_read_b64_tr_b16 v[204:205], v7 offset:12288
    ds_read_b64_tr_b16 v[206:207], v7 offset:13312
    ds_read_b64_tr_b16 v[208:209], v7 offset:16384
    ds_read_b64_tr_b16 v[210:211], v7 offset:17408
    ds_read_b64_tr_b16 v[212:213], v7 offset:20480
    ds_read_b64_tr_b16 v[214:215], v7 offset:21504
    ds_read_b64_tr_b16 v[216:217], v7 offset:24576
    ds_read_b64_tr_b16 v[218:219], v7 offset:25600
    ds_read_b64_tr_b16 v[220:221], v7 offset:28672
    ds_read_b64_tr_b16 v[222:223], v7 offset:29696
    ds_read_b64_tr_b16 v[224:225], v7 offset:32768
    ds_read_b64_tr_b16 v[226:227], v7 offset:33792
    ds_read_b64_tr_b16 v[228:229], v7 offset:36864
    ds_read_b64_tr_b16 v[230:231], v7 offset:37888
    ds_read_b64_tr_b16 v[232:233], v7 offset:40960
    ds_read_b64_tr_b16 v[234:235], v7 offset:41984
    ds_read_b64_tr_b16 v[236:237], v7 offset:45056
    ds_read_b64_tr_b16 v[238:239], v7 offset:46080
    ds_read_b64_tr_b16 v[240:241], v7 offset:49152
    ds_read_b64_tr_b16 v[242:243], v7 offset:50176
    ds_read_b64_tr_b16 v[244:245], v7 offset:53248
    ds_read_b64_tr_b16 v[246:247], v7 offset:54272
    ds_read_b64_tr_b16 v[248:249], v7 offset:57344
    ds_read_b64_tr_b16 v[250:251], v7 offset:58368
    ds_read_b64_tr_b16 v[252:253], v7 offset:61440
    ds_read_b64_tr_b16 v[254:255], v7 offset:62464
    v_xor_b32 v6, 0x10000, v6
    v_xor_b32 v7, 0x10000, v7
    s_waitcnt lgkmcnt(0)
    s_barrier
    s_add_u32 m0, s84, 65536
    s_mov_b32 s50, 2097152
    buffer_load_dwordx4 v2, s[60:63], s50 offen  lds
    s_add_u32 m0, m0, 4096
    s_add_u32 s50, s50, 131072
    buffer_load_dwordx4 v2, s[60:63], s50 offen  lds
    s_add_u32 m0, m0, 4096
    s_add_u32 s50, s50, 131072
    buffer_load_dwordx4 v2, s[60:63], s50 offen  lds
    s_add_u32 m0, m0, 4096
    s_add_u32 s50, s50, 131072
    buffer_load_dwordx4 v2, s[60:63], s50 offen  lds
    s_add_u32 m0, m0, 4096
    s_add_u32 s50, s50, 131072
    buffer_load_dwordx4 v2, s[60:63], s50 offen  lds
    s_add_u32 m0, m0, 4096
    s_add_u32 s50, s50, 131072
    buffer_load_dwordx4 v2, s[60:63], s50 offen  lds
    s_add_u32 m0, m0, 4096
    s_add_u32 s50, s50, 131072
    buffer_load_dwordx4 v2, s[60:63], s50 offen  lds
    s_add_u32 m0, m0, 4096
    s_add_u32 s50, s50, 131072
    buffer_load_dwordx4 v2, s[60:63], s50 offen  lds
    s_add_u32 m0, m0, 4096
    s_add_u32 s50, s50, 131072
    buffer_load_dwordx4 v2, s[60:63], s50 offen  lds
    s_add_u32 m0, m0, 4096
    s_add_u32 s50, s50, 131072
    buffer_load_dwordx4 v2, s[60:63], s50 offen  lds
    s_add_u32 m0, m0, 4096
    s_add_u32 s50, s50, 131072
    buffer_load_dwordx4 v2, s[60:63], s50 offen  lds
    s_add_u32 m0, m0, 4096
    s_add_u32 s50, s50, 131072
    buffer_load_dwordx4 v2, s[60:63], s50 offen  lds
    s_add_u32 m0, m0, 4096
    s_add_u32 s50, s50, 131072
    buffer_load_dwordx4 v2, s[60:63], s50 offen  lds
    s_add_u32 m0, m0, 4096
    s_add_u32 s50, s50, 131072
    buffer_load_dwordx4 v2, s[60:63], s50 offen  lds
    s_add_u32 m0, m0, 4096
    s_add_u32 s50, s50, 131072
    buffer_load_dwordx4 v2, s[60:63], s50 offen  lds
    s_add_u32 m0, m0, 4096
    s_add_u32 s50, s50, 131072
    buffer_load_dwordx4 v2, s[60:63], s50 offen  lds
    s_waitcnt vmcnt(16)
    s_barrier
    ds_read_b64_tr_b16 a[0:1], v6 offset:0
    ds_read_b64_tr_b16 a[2:3], v6 offset:1024
    ds_read_b64_tr_b16 a[4:5], v6 offset:4096
    ds_read_b64_tr_b16 a[6:7], v6 offset:5120
    ds_read_b64_tr_b16 a[8:9], v6 offset:8192
    ds_read_b64_tr_b16 a[10:11], v6 offset:9216
    ds_read_b64_tr_b16 a[12:13], v6 offset:12288
    ds_read_b64_tr_b16 a[14:15], v6 offset:13312
    ds_read_b64_tr_b16 a[16:17], v6 offset:16384
    ds_read_b64_tr_b16 a[18:19], v6 offset:17408
    ds_read_b64_tr_b16 a[20:21], v6 offset:20480
    ds_read_b64_tr_b16 a[22:23], v6 offset:21504
    ds_read_b64_tr_b16 a[24:25], v6 offset:24576
    ds_read_b64_tr_b16 a[26:27], v6 offset:25600
    ds_read_b64_tr_b16 a[28:29], v6 offset:28672
    ds_read_b64_tr_b16 a[30:31], v6 offset:29696
    ds_read_b64_tr_b16 a[32:33], v6 offset:32768
    ds_read_b64_tr_b16 a[34:35], v6 offset:33792
    ds_read_b64_tr_b16 a[36:37], v6 offset:36864
    ds_read_b64_tr_b16 a[38:39], v6 offset:37888
    ds_read_b64_tr_b16 a[40:41], v6 offset:40960
    ds_read_b64_tr_b16 a[42:43], v6 offset:41984
    ds_read_b64_tr_b16 a[44:45], v6 offset:45056
    ds_read_b64_tr_b16 a[46:47], v6 offset:46080
    ds_read_b64_tr_b16 a[48:49], v6 offset:49152
    ds_read_b64_tr_b16 a[50:51], v6 offset:50176
    ds_read_b64_tr_b16 a[52:53], v6 offset:53248
    ds_read_b64_tr_b16 a[54:55], v6 offset:54272
    ds_read_b64_tr_b16 a[56:57], v6 offset:57344
    ds_read_b64_tr_b16 a[58:59], v6 offset:58368
    ds_read_b64_tr_b16 a[60:61], v6 offset:61440
    ds_read_b64_tr_b16 a[62:63], v6 offset:62464
    v_xor_b32 v6, 0x10000, v6
    v_xor_b32 v7, 0x10000, v7
    s_waitcnt lgkmcnt(0)
    s_barrier
    v_and_b32 v22, 7, v0
    v_lshlrev_b32 v22, 3, v22
    buffer_load_dwordx2 v[20:21], v22, s[56:59], 0 offen offset:128 sc1
    s_cmp_eq_u32 s8, 1
    s_cselect_b64 s[76:77], s[30:31], s[16:17]
    s_mov_b32 s78, 0x200000
    s_mov_b32 s79, 0x20000
    s_lshl_b32 s94, s10, 15
    s_lshl_b32 s14, s3, 13
    s_add_u32 s94, s94, s14
    s_mul_i32 s95, s3, 8320
    s_mov_b32 m0, s95
    s_mov_b32 s50, s94
    buffer_load_dwordx4 v1, s[76:79], s50 offen lds
    s_add_u32 m0, m0, 1040
    s_add_u32 s50, s50, 1024
    buffer_load_dwordx4 v1, s[76:79], s50 offen lds
    s_add_u32 m0, m0, 1040
    s_add_u32 s50, s50, 1024
    buffer_load_dwordx4 v1, s[76:79], s50 offen lds
    s_add_u32 m0, m0, 1040
    s_add_u32 s50, s50, 1024
    buffer_load_dwordx4 v1, s[76:79], s50 offen lds
    s_add_u32 m0, m0, 1040
    s_add_u32 s50, s50, 1024
    buffer_load_dwordx4 v1, s[76:79], s50 offen lds
    s_add_u32 m0, m0, 1040
    s_add_u32 s50, s50, 1024
    buffer_load_dwordx4 v1, s[76:79], s50 offen lds
    s_add_u32 m0, m0, 1040
    s_add_u32 s50, s50, 1024
    buffer_load_dwordx4 v1, s[76:79], s50 offen lds
    s_add_u32 m0, m0, 1040
    s_add_u32 s50, s50, 1024
    buffer_load_dwordx4 v1, s[76:79], s50 offen lds
    s_waitcnt vmcnt(8)
    s_barrier
    ds_read_b64_tr_b16 a[64:65], v6 offset:0
    ds_read_b64_tr_b16 a[66:67], v6 offset:1024
    ds_read_b64_tr_b16 a[68:69], v6 offset:4096
    ds_read_b64_tr_b16 a[70:71], v6 offset:5120
    ds_read_b64_tr_b16 a[72:73], v6 offset:8192
    ds_read_b64_tr_b16 a[74:75], v6 offset:9216
    ds_read_b64_tr_b16 a[76:77], v6 offset:12288
    ds_read_b64_tr_b16 a[78:79], v6 offset:13312
    ds_read_b64_tr_b16 a[80:81], v6 offset:16384
    ds_read_b64_tr_b16 a[82:83], v6 offset:17408
    ds_read_b64_tr_b16 a[84:85], v6 offset:20480
    ds_read_b64_tr_b16 a[86:87], v6 offset:21504
    ds_read_b64_tr_b16 a[88:89], v6 offset:24576
    ds_read_b64_tr_b16 a[90:91], v6 offset:25600
    ds_read_b64_tr_b16 a[92:93], v6 offset:28672
    ds_read_b64_tr_b16 a[94:95], v6 offset:29696
    ds_read_b64_tr_b16 a[96:97], v6 offset:32768
    ds_read_b64_tr_b16 a[98:99], v6 offset:33792
    ds_read_b64_tr_b16 a[100:101], v6 offset:36864
    ds_read_b64_tr_b16 a[102:103], v6 offset:37888
    ds_read_b64_tr_b16 a[104:105], v6 offset:40960
    ds_read_b64_tr_b16 a[106:107], v6 offset:41984
    ds_read_b64_tr_b16 a[108:109], v6 offset:45056
    ds_read_b64_tr_b16 a[110:111], v6 offset:46080
    ds_read_b64_tr_b16 a[112:113], v6 offset:49152
    ds_read_b64_tr_b16 a[114:115], v6 offset:50176
    ds_read_b64_tr_b16 a[116:117], v6 offset:53248
    ds_read_b64_tr_b16 a[118:119], v6 offset:54272
    ds_read_b64_tr_b16 a[120:121], v6 offset:57344
    ds_read_b64_tr_b16 a[122:123], v6 offset:58368
    ds_read_b64_tr_b16 a[124:125], v6 offset:61440
    ds_read_b64_tr_b16 a[126:127], v6 offset:62464
    v_xor_b32 v6, 0x10000, v6
    v_xor_b32 v7, 0x10000, v7
    s_waitcnt lgkmcnt(0)
    s_barrier
    v_cmp_eq_u32 vcc, -1, v20
    v_mov_b32 v23, 0x2000
    v_cmp_eq_u32 s[14:15], v23, v21
    s_nop 0
    s_and_b64 vcc, vcc, s[14:15]
    s_cmp_eq_u64 vcc, -1
    s_cselect_b32 s7, 1, s7
    s_cmp_eq_u32 s7, 1
    s_cbranch_scc1 L_vdone_5
    s_mov_b32 s13, 0
    v_and_b32 v22, 7, v0
    v_lshlrev_b32 v22, 3, v22
L_vloop_6:
    buffer_load_dwordx2 v[20:21], v22, s[56:59], 0 offen offset:128 sc1
    s_waitcnt vmcnt(0)
    v_cmp_eq_u32 vcc, -1, v20
    v_mov_b32 v23, 0x2000
    v_cmp_eq_u32 s[14:15], v23, v21
    s_nop 0
    s_and_b64 vcc, vcc, s[14:15]
    s_cmp_eq_u64 vcc, -1
    s_cbranch_scc1 L_vdone_5
    v_lshrrev_b32 v21, 8, v21
    s_mov_b32 s50, 0
    v_readlane_b32 s51, v21, 0
    s_nop 0
    s_add_u32 s50, s50, s51
    v_readlane_b32 s51, v21, 1
    s_nop 0
    s_add_u32 s50, s50, s51
    v_readlane_b32 s51, v21, 2
    s_nop 0
    s_add_u32 s50, s50, s51
    v_readlane_b32 s51, v21, 3
    s_nop 0
    s_add_u32 s50, s50, s51
    v_readlane_b32 s51, v21, 4
    s_nop 0
    s_add_u32 s50, s50, s51
    v_readlane_b32 s51, v21, 5
    s_nop 0
    s_add_u32 s50, s50, s51
    v_readlane_b32 s51, v21, 6
    s_nop 0
    s_add_u32 s50, s50, s51
    v_readlane_b32 s51, v21, 7
    s_nop 0
    s_add_u32 s50, s50, s51
    s_cmp_ge_u32 s50, 256
    s_cbranch_scc1 L_vfb_7
    s_add_u32 s13, s13, 1
    s_cmp_lt_u32 s13, 1048576
    s_cbranch_scc1 L_vloop_6
    s_branch L_end
L_vfb_7:
    v_mov_b32 v24, 163328
    v_lshrrev_b32 v25, 8, v127
    s_cmp_eq_u32 s3, 0
    s_cselect_b64 exec, 1, 0
    ds_write_b32 v24, v25
    s_mov_b64 exec, -1
    s_waitcnt lgkmcnt(0)
    s_barrier
    ds_read_b32 v25, v24
    v_cmp_eq_u32 vcc, 32, v21
    s_waitcnt lgkmcnt(0)
    v_readfirstlane_b32 s14, v25
    s_barrier
    s_lshr_b32 s15, s2, 5
    s_and_b32 s50, s2, 31
    s_and_b32 s14, s14, 31
    s_cmp_eq_u64 vcc, -1
    s_cselect_b32 s4, s12, s15
    s_cselect_b32 s5, s14, s50
    s_cselect_b32 s6, 0, 1
    s_mov_b32 s7, 1
    s_branch L_reload
L_vdone_5:
    v_and_b32 v20, 31, v0
    v_lshrrev_b32 v21, 5, v0
    v_mul_u32_u24 v22, 1040, v20
    v_lshl_add_u32 v2, v21, 4, v22
    v_lshrrev_b32 v22, 4, v20
    v_and_b32 v23, 7, v20
    v_lshl_add_u32 v23, v22, 3, v23
    v_lshl_add_u32 v23, v21, 5, v23
    v_lshlrev_b32 v23, 4, v23
    v_bfe_u32 v24, v20, 3, 1
    v_lshl_add_u32 v23, v24, 12, v23
    s_lshl_b32 s14, s3, 10
    v_add_u32 v4, s14, v23
    v_and_b32 v23, 15, v20
    v_lshl_add_u32 v23, v21, 4, v23
    v_lshlrev_b32 v23, 4, v23
    v_and_b32 v24, 7, v20
    v_lshl_add_u32 v24, v21, 3, v24
    v_lshlrev_b32 v24, 4, v24
    v_lshrrev_b32 v25, 3, v20
    v_lshl_add_u32 v24, v25, 16, v24
    s_lshl_b32 s14, s3, 9
    v_add_u32 v6, s14, v24
    v_lshl_add_u32 v24, v22, 10, v23
    s_lshl_b32 s14, s3, 11
    s_add_u32 s14, s14, 8192
    v_add_u32 v5, s14, v24
    v_and_b32 v23, 7, v0
    v_lshlrev_b32 v23, 8, v23
    v_lshl_add_u32 v23, v21, 5, v23
    s_lshl_b32 s14, s3, 6
    v_add_u32 v7, s14, v23
    v_lshlrev_b32 v23, 4, v20
    v_lshl_add_u32 v23, v21, 3, v23
    s_lshl_b32 s14, s3, 9
    s_add_u32 s14, s14, 2048
    v_add_u32 v8, s14, v23
    s_mul_i32 s14, s3, 2048
    s_add_u32 s14, s14, 66560
    v_add_u32 v9, s14, v1
    v_mul_u32_u24 v23, 176, v20
    v_lshl_add_u32 v23, v21, 4, v23
    s_mul_i32 s14, s3, 5632
    s_add_u32 s14, s14, 110080
    v_add_u32 v11, s14, v23
    v_mul_u32_u24 v23, 80, v20
    v_lshl_add_u32 v23, v21, 5, v23
    v_add_u32 v16, 107520, v23
    v_lshrrev_b32 v22, 3, v0
    s_lshl_b32 s14, s3, 3
    v_add_u32 v22, s14, v22
    v_and_b32 v23, 7, v0
    v_mul_u32_u24 v24, 176, v22
    v_add_u32 v24, 110080, v24
    v_lshl_add_u32 v12, v23, 4, v24
    v_lshl_add_u32 v13, v23, 2, v24
    v_mul_u32_u24 v24, 80, v22
    v_add_u32 v24, 107520, v24
    v_lshl_add_u32 v15, v23, 1, v24
    v_and_b32 v25, 1, v23
    v_lshl_add_u32 v24, v25, 5, v24
    v_lshrrev_b32 v25, 1, v23
    v_lshl_add_u32 v14, v25, 3, v24
    v_lshlrev_b32 v23, 2, v23
    v_cmp_le_u32 s[28:29], v23, v22
    v_add_u32 v23, 1, v23
    v_cmp_le_u32 s[30:31], v23, v22
    v_add_u32 v23, 1, v23
    v_cmp_le_u32 s[32:33], v23, v22
    v_add_u32 v23, 1, v23
    v_cmp_le_u32 s[34:35], v23, v22
    v_add_u32 v23, 1, v23
    v_or_b32 v23, s3, v0
    v_cmp_eq_u32 vcc, 0, v23
    v_mov_b32 v19, 0x40000000
    s_nop 0
    v_cndmask_b32 v19, v19, 0, vcc
    v_mov_b32 v126, 0
    v_mov_b32 v127, 0
    s_mov_b32 s16, 0
    s_mov_b32 s17, 0
    s_mov_b32 s18, 0
    s_lshl_b32 s14, s8, 6
    s_add_u32 s14, s14, s10
    s_mul_i32 s15, s8, 2048
    s_mul_i32 s50, s9, 1
    s_add_u32 s15, s15, s50
    s_mul_i32 s50, s10, 32
    s_add_u32 s15, s15, s50
    s_lshl_b32 s20, s15, 14
    s_add_u32 s20, s20, 2097152
    s_lshl_b32 s21, s15, 12
    s_add_u32 s21, s21, 105644032
    s_lshl_b32 s22, s14, 18
    s_lshl_b32 s15, s9, 11
    s_add_u32 s22, s22, s15
    s_add_u32 s22, s22, 73400320
    s_lshl_b32 s14, s8, 5
    s_add_u32 s14, s14, s9
    s_lshl_b32 s14, s14, 7
    s_add_u32 s24, s14, 925696
    s_lshl_b32 s15, s10, 2
    s_add_u32 s23, s14, s15
    s_add_u32 s23, s23, 917504
    s_lshl_b32 s14, s8, 1
    s_add_u32 s14, s14, s10
    s_lshl_b32 s14, s14, 9
    s_lshr_b32 s15, s9, 3
    s_lshl_b32 s15, s15, 7
    s_add_u32 s14, s14, s15
    s_and_b32 s15, s9, 7
    s_lshl_b32 s15, s15, 2
    s_add_u32 s25, s14, s15
    s_add_u32 s25, s25, 933888
    s_mov_b32 s26, 0x3e0293ee
    s_mov_b32 s38, 0xd028965f
    s_sub_u32 s37, s10, 9
    s_waitcnt vmcnt(0)
    s_barrier
    s_sub_u32 s22, s22, 2621440
L_wloop:
    v_add_u32 v3, s17, v2
    v_add_u32 v10, s18, v9
    s_sub_u32 s14, s20, 5242880
    s_cmp_ge_u32 s16, 5
    s_cselect_b32 s40, s22, 0x40000000
    s_cselect_b32 s39, s14, 0x40000000
    s_cmp_eq_u32 s16, 8
    s_cbranch_scc1 L_wpoison
L_wpoison_r:
    s_cmp_ge_u32 s16, 32
    s_cbranch_scc1 L_wtail
    ds_read_b128 v[68:71], v3 offset:0
    ds_read_b128 v[72:75], v3 offset:32
    s_waitcnt lgkmcnt(1)
    v_mfma_f32_32x32x16_bf16 v[20:35], a[0:3], v[68:71], 0
    buffer_load_dword v17, off, s[52:55], s24 sc1
    v_mfma_f32_32x32x16_bf16 v[36:51], a[128:131], v[68:71], 0
    v_mfma_f32_32x32x16_bf16 v[52:67], v[68:71], v[128:131], 0
    ds_read_b128 v[68:71], v3 offset:64
    s_waitcnt lgkmcnt(1)
    v_mfma_f32_32x32x16_bf16 v[20:35], a[4:7], v[72:75], v[20:35]
    buffer_load_dwordx4 v[100:103], v4, s[52:55], s39 offen sc1
    v_mfma_f32_32x32x16_bf16 v[36:51], a[132:135], v[72:75], v[36:51]
    v_mfma_f32_32x32x16_bf16 v[52:67], v[72:75], v[132:135], v[52:67]
    ds_read_b128 v[72:75], v3 offset:96
    s_waitcnt lgkmcnt(1)
    v_mfma_f32_32x32x16_bf16 v[20:35], a[8:11], v[68:71], v[20:35]
    buffer_load_dwordx4 v[104:107], v4, s[52:55], s39 offen offset:256 sc1
    v_mfma_f32_32x32x16_bf16 v[36:51], a[136:139], v[68:71], v[36:51]
    v_mfma_f32_32x32x16_bf16 v[52:67], v[68:71], v[136:139], v[52:67]
    ds_read_b128 v[68:71], v3 offset:128
    s_waitcnt lgkmcnt(1)
    v_mfma_f32_32x32x16_bf16 v[20:35], a[12:15], v[72:75], v[20:35]
    buffer_load_dwordx4 v[116:119], v5, s[52:55], s39 offen sc1
    v_mfma_f32_32x32x16_bf16 v[36:51], a[140:143], v[72:75], v[36:51]
    v_mfma_f32_32x32x16_bf16 v[52:67], v[72:75], v[140:143], v[52:67]
    ds_read_b128 v[72:75], v3 offset:160
    s_waitcnt lgkmcnt(1)
    v_mfma_f32_32x32x16_bf16 v[20:35], a[16:19], v[68:71], v[20:35]
    buffer_load_dwordx4 v[120:123], v5, s[52:55], s39 offen offset:512 sc1
    v_mfma_f32_32x32x16_bf16 v[36:51], a[144:147], v[68:71], v[36:51]
    v_mfma_f32_32x32x16_bf16 v[52:67], v[68:71], v[144:147], v[52:67]
    ds_read_b128 v[68:71], v3 offset:192
    s_waitcnt lgkmcnt(1)
    v_mfma_f32_32x32x16_bf16 v[20:35], a[20:23], v[72:75], v[20:35]
    ds_read_b128 v[92:95], v10 offset:0
    ds_read_b128 v[96:99], v10 offset:1024
    v_mfma_f32_32x32x16_bf16 v[36:51], a[148:151], v[72:75], v[36:51]
    v_mfma_f32_32x32x16_bf16 v[52:67], v[72:75], v[148:151], v[52:67]
    ds_read_b128 v[72:75], v3 offset:224
    s_waitcnt lgkmcnt(3)
    v_mfma_f32_32x32x16_bf16 v[20:35], a[24:27], v[68:71], v[20:35]
    s_cmp_lt_u32 s16, 31
    s_cselect_b32 s14, 65536, 0
    s_add_u32 s94, s94, s14
    v_mfma_f32_32x32x16_bf16 v[36:51], a[152:155], v[68:71], v[36:51]
    s_sub_u32 s95, s95, s17
    s_xor_b32 s17, s17, 33280
    s_add_u32 s95, s95, s17
    v_mfma_f32_32x32x16_bf16 v[52:67], v[68:71], v[152:155], v[52:67]
    ds_read_b128 v[68:71], v3 offset:256
    s_waitcnt lgkmcnt(1)
    v_mfma_f32_32x32x16_bf16 v[20:35], a[28:31], v[72:75], v[20:35]
    s_mov_b32 m0, s95
    s_mov_b32 s50, s94
    v_mfma_f32_32x32x16_bf16 v[36:51], a[156:159], v[72:75], v[36:51]
    v_mfma_f32_32x32x16_bf16 v[52:67], v[72:75], v[156:159], v[52:67]
    ds_read_b128 v[72:75], v3 offset:288
    s_waitcnt lgkmcnt(1)
    v_mfma_f32_32x32x16_bf16 v[20:35], a[32:35], v[68:71], v[20:35]
    s_waitcnt vmcnt(5)
    s_barrier
    v_mfma_f32_32x32x16_bf16 v[36:51], a[160:163], v[68:71], v[36:51]
    s_min_u32 s14, s16, 32
    v_mov_b32 v18, s14
    buffer_store_dword v18, v19, s[52:55], s23 offen sc1
    v_mfma_f32_32x32x16_bf16 v[52:67], v[68:71], v[160:163], v[52:67]
    ds_read_b128 v[68:71], v3 offset:320
    s_waitcnt lgkmcnt(1)
    v_mfma_f32_32x32x16_bf16 v[20:35], a[36:39], v[72:75], v[20:35]
    s_sub_u32 s14, s16, 5
    v_mov_b32 v76, s14
    buffer_store_dword v76, v19, s[52:55], s25 offen sc1
    v_mfma_f32_32x32x16_bf16 v[36:51], a[164:167], v[72:75], v[36:51]
    s_waitcnt vmcnt(6)
    v_readfirstlane_b32 s14, v17
    s_nop 0
    s_max_i32 s14, s14, 0
    s_cmp_ge_i32 s14, s37
    s_cbranch_scc1 L_wm_8_ok
    s_mov_b32 s13, 0
L_wm_8:
    buffer_load_dword v17, off, s[52:55], s24 sc1
    s_waitcnt vmcnt(0)
    v_readfirstlane_b32 s14, v17
    s_nop 0
    s_cmp_ge_i32 s14, s37
    s_cbranch_scc1 L_wm_8_ok
    s_add_u32 s13, s13, 1
    s_cmp_lt_u32 s13, 1048576
    s_cbranch_scc1 L_wm_8
    s_branch L_end
L_wm_8_ok:
    v_mfma_f32_32x32x16_bf16 v[52:67], v[72:75], v[164:167], v[52:67]
    ds_read_b128 v[72:75], v3 offset:352
    s_waitcnt lgkmcnt(1)
    v_mfma_f32_32x32x16_bf16 v[20:35], a[40:43], v[68:71], v[20:35]
    buffer_load_dwordx4 v[108:111], v7, s[52:55], s21 offen sc1
    v_mfma_f32_32x32x16_bf16 v[36:51], a[168:171], v[68:71], v[36:51]
    buffer_load_dwordx4 v[112:115], v7, s[52:55], s21 offen offset:16 sc1
    v_mfma_f32_32x32x16_bf16 v[52:67], v[68:71], v[168:171], v[52:67]
    ds_read_b128 v[68:71], v3 offset:384
    s_waitcnt lgkmcnt(1)
    v_mfma_f32_32x32x16_bf16 v[20:35], a[44:47], v[72:75], v[20:35]
    buffer_load_dwordx2 v[124:125], v8, s[52:55], s21 offen sc1
    v_mfma_f32_32x32x16_bf16 v[36:51], a[172:175], v[72:75], v[36:51]
    buffer_load_dwordx4 v1, s[76:79], s50 offen lds
    s_add_u32 m0, m0, 1040
    s_add_u32 s50, s50, 1024
    v_mfma_f32_32x32x16_bf16 v[52:67], v[72:75], v[172:175], v[52:67]
    ds_read_b128 v[72:75], v3 offset:416
    s_waitcnt lgkmcnt(1)
    v_mfma_f32_32x32x16_bf16 v[20:35], a[48:51], v[68:71], v[20:35]
    buffer_load_dwordx4 v1, s[76:79], s50 offen lds
    s_add_u32 m0, m0, 1040
    s_add_u32 s50, s50, 1024
    v_mfma_f32_32x32x16_bf16 v[36:51], a[176:179], v[68:71], v[36:51]
    buffer_load_dwordx4 v1, s[76:79], s50 offen lds
    s_add_u32 m0, m0, 1040
    s_add_u32 s50, s50, 1024
    v_mfma_f32_32x32x16_bf16 v[52:67], v[68:71], v[176:179], v[52:67]
    ds_read_b128 v[68:71], v3 offset:448
    s_waitcnt lgkmcnt(1)
    v_mfma_f32_32x32x16_bf16 v[20:35], a[52:55], v[72:75], v[20:35]
    buffer_load_dwordx4 v1, s[76:79], s50 offen lds
    s_add_u32 m0, m0, 1040
    s_add_u32 s50, s50, 1024
    v_mfma_f32_32x32x16_bf16 v[36:51], a[180:183], v[72:75], v[36:51]
    buffer_load_dwordx4 v1, s[76:79], s50 offen lds
    s_add_u32 m0, m0, 1040
    s_add_u32 s50, s50, 1024
    v_mfma_f32_32x32x16_bf16 v[52:67], v[72:75], v[180:183], v[52:67]
    ds_read_b128 v[72:75], v3 offset:480
    s_waitcnt lgkmcnt(1)
    v_mfma_f32_32x32x16_bf16 v[20:35], a[56:59], v[68:71], v[20:35]
    buffer_load_dwordx4 v1, s[76:79], s50 offen lds
    s_add_u32 m0, m0, 1040
    s_add_u32 s50, s50, 1024
    v_mfma_f32_32x32x16_bf16 v[36:51], a[184:187], v[68:71], v[36:51]
    buffer_load_dwordx4 v1, s[76:79], s50 offen lds
    s_add_u32 m0, m0, 1040
    s_add_u32 s50, s50, 1024
    v_mfma_f32_32x32x16_bf16 v[52:67], v[68:71], v[184:187], v[52:67]
    ds_read_b128 v[68:71], v3 offset:512
    s_waitcnt lgkmcnt(1)
    v_mfma_f32_32x32x16_bf16 v[20:35], a[60:63], v[72:75], v[20:35]
    buffer_load_dwordx4 v1, s[76:79], s50 offen lds
    v_mfma_f32_32x32x16_bf16 v[36:51], a[188:191], v[72:75], v[36:51]
    v_mfma_f32_32x32x16_bf16 v[52:67], v[72:75], v[188:191], v[52:67]
    ds_read_b128 v[72:75], v3 offset:544
    s_waitcnt lgkmcnt(1)
    v_mfma_f32_32x32x16_bf16 v[20:35], a[64:67], v[68:71], v[20:35]
    s_waitcnt vmcnt(15)
    s_waitcnt lgkmcnt(11)
    v_mfma_f32_32x32x16_bf16 v[76:91], v[100:103], v[92:95], 0
    v_mfma_f32_32x32x16_bf16 v[76:91], v[104:107], v[96:99], v[76:91]
    v_mfma_f32_32x32x16_bf16 v[36:51], a[192:195], v[68:71], v[36:51]
    v_mfma_f32_32x32x16_bf16 v[52:67], v[68:71], v[192:195], v[52:67]
    ds_read_b128 v[68:71], v3 offset:576
    s_waitcnt lgkmcnt(1)
    v_mfma_f32_32x32x16_bf16 v[20:35], a[68:71], v[72:75], v[20:35]
    ds_write_b128 v11, v[76:79] offset:0
    ds_write_b128 v11, v[80:83] offset:32
    v_mfma_f32_32x32x16_bf16 v[36:51], a[196:199], v[72:75], v[36:51]
    ds_write_b128 v11, v[84:87] offset:64
    ds_write_b128 v11, v[88:91] offset:96
    v_mfma_f32_32x32x16_bf16 v[52:67], v[72:75], v[196:199], v[52:67]
    ds_read_b128 v[72:75], v3 offset:608
    s_waitcnt lgkmcnt(5)
    v_mfma_f32_32x32x16_bf16 v[20:35], a[72:75], v[68:71], v[20:35]
    v_mfma_f32_32x32x16_bf16 v[36:51], a[200:203], v[68:71], v[36:51]
    s_waitcnt vmcnt(9)
    v_mfma_f32_32x32x16_bf16 v[76:91], v[108:111], v[92:95], 0
    v_mfma_f32_32x32x16_bf16 v[76:91], v[112:115], v[96:99], v[76:91]
    v_mfma_f32_32x32x16_bf16 v[52:67], v[68:71], v[200:203], v[52:67]
    ds_read_b128 v[68:71], v3 offset:640
    s_waitcnt lgkmcnt(1)
    v_mfma_f32_32x32x16_bf16 v[20:35], a[76:79], v[72:75], v[20:35]
    v_mfma_f32_32x32x16_bf16 v[36:51], a[204:207], v[72:75], v[36:51]
    ds_write_b128 v11, v[76:79] offset:128
    v_mfma_f32_32x32x16_bf16 v[52:67], v[72:75], v[204:207], v[52:67]
    ds_read_b128 v[72:75], v3 offset:672
    s_waitcnt lgkmcnt(2)
    v_mfma_f32_32x32x16_bf16 v[20:35], a[80:83], v[68:71], v[20:35]
    v_mfma_f32_32x32x16_bf16 v[36:51], a[208:211], v[68:71], v[36:51]
    s_waitcnt lgkmcnt(1)
    s_barrier
    ds_read_b128 v[92:95], v12 offset:0
    ds_read_b128 v[96:99], v12 offset:5632
    v_mfma_f32_32x32x16_bf16 v[52:67], v[68:71], v[208:211], v[52:67]
    ds_read_b128 v[68:71], v3 offset:704
    s_waitcnt lgkmcnt(3)
    v_mfma_f32_32x32x16_bf16 v[20:35], a[84:87], v[72:75], v[20:35]
    ds_read_b128 v[100:103], v12 offset:11264
    ds_read_b128 v[104:107], v12 offset:16896
    ds_read_b32 v108, v13 offset:128
    v_mfma_f32_32x32x16_bf16 v[36:51], a[212:215], v[72:75], v[36:51]
    ds_read_b32 v109, v13 offset:5760
    ds_read_b32 v110, v13 offset:11392
    ds_read_b32 v111, v13 offset:17024
    v_mfma_f32_32x32x16_bf16 v[52:67], v[72:75], v[212:215], v[52:67]
    ds_read_b128 v[72:75], v3 offset:736
    s_waitcnt lgkmcnt(7)
    v_mfma_f32_32x32x16_bf16 v[20:35], a[88:91], v[68:71], v[20:35]
    v_mov_b32 v112, s38
    s_waitcnt lgkmcnt(8)
    v_add_f32 v92, v92, v96
    v_add_f32 v93, v93, v97
    v_add_f32 v94, v94, v98
    v_add_f32 v95, v95, v99
    v_mfma_f32_32x32x16_bf16 v[36:51], a[216:219], v[68:71], v[36:51]
    s_waitcnt lgkmcnt(5)
    v_add_f32 v100, v100, v104
    v_add_f32 v101, v101, v105
    v_add_f32 v102, v102, v106
    v_add_f32 v103, v103, v107
    v_add_f32 v92, v92, v100
    v_mfma_f32_32x32x16_bf16 v[52:67], v[68:71], v[216:219], v[52:67]
    ds_read_b128 v[68:71], v3 offset:768
    v_add_f32 v93, v93, v101
    v_add_f32 v94, v94, v102
    v_add_f32 v95, v95, v103
    v_cndmask_b32 v92, v112, v92, s[28:29]
    s_waitcnt lgkmcnt(1)
    v_mfma_f32_32x32x16_bf16 v[20:35], a[92:95], v[72:75], v[20:35]
    v_cndmask_b32 v93, v112, v93, s[30:31]
    v_cndmask_b32 v94, v112, v94, s[32:33]
    v_cndmask_b32 v95, v112, v95, s[34:35]
    s_waitcnt lgkmcnt(2)
    v_add_f32 v108, v108, v109
    v_add_f32 v110, v110, v111
    v_mfma_f32_32x32x16_bf16 v[36:51], a[220:223], v[72:75], v[36:51]
    v_max3_f32 v97, v92, v93, v94
    v_add_f32 v96, v108, v110
    v_max3_f32 v97, v97, v95, v96
    s_nop 1
    v_max_f32_dpp v97, v97, v97 quad_perm:[1,0,3,2] row_mask:0xf bank_mask:0xf
    v_mfma_f32_32x32x16_bf16 v[52:67], v[72:75], v[220:223], v[52:67]
    ds_read_b128 v[72:75], v3 offset:800
    v_max_f32_dpp v97, v97, v97 quad_perm:[2,3,0,1] row_mask:0xf bank_mask:0xf
    s_nop 1
    v_max_f32_dpp v97, v97, v97 row_half_mirror row_mask:0xf bank_mask:0xf
    s_waitcnt lgkmcnt(1)
    v_mfma_f32_32x32x16_bf16 v[20:35], a[96:99], v[68:71], v[20:35]
    v_mul_f32 v97, s26, v97
    v_fma_f32 v92, v92, s26, -v97
    v_fma_f32 v93, v93, s26, -v97
    v_fma_f32 v94, v94, s26, -v97
    v_fma_f32 v95, v95, s26, -v97
    v_fma_f32 v96, v96, s26, -v97
    v_mfma_f32_32x32x16_bf16 v[36:51], a[224:227], v[68:71], v[36:51]
    v_exp_f32 v92, v92
    v_exp_f32 v93, v93
    v_exp_f32 v94, v94
    v_mfma_f32_32x32x16_bf16 v[52:67], v[68:71], v[224:227], v[52:67]
    ds_read_b128 v[68:71], v3 offset:832
    v_exp_f32 v95, v95
    v_exp_f32 v96, v96
    s_waitcnt lgkmcnt(1)
    v_mfma_f32_32x32x16_bf16 v[20:35], a[100:103], v[72:75], v[20:35]
    v_add_f32 v98, v92, v93
    v_add_f32 v99, v94, v95
    v_add_f32 v98, v98, v96
    v_add_f32 v98, v98, v99
    s_nop 1
    v_add_f32_dpp v98, v98, v98 quad_perm:[1,0,3,2] row_mask:0xf bank_mask:0xf
    v_mfma_f32_32x32x16_bf16 v[36:51], a[228:231], v[72:75], v[36:51]
    s_nop 0
    v_add_f32_dpp v98, v98, v98 quad_perm:[2,3,0,1] row_mask:0xf bank_mask:0xf
    s_nop 1
    v_add_f32_dpp v98, v98, v98 row_half_mirror row_mask:0xf bank_mask:0xf
    v_rcp_f32 v98, v98
    v_mfma_f32_32x32x16_bf16 v[52:67], v[72:75], v[228:231], v[52:67]
    ds_read_b128 v[72:75], v3 offset:864
    v_lshrrev_b32 v104, 5, v0
    v_mul_f32 v92, v92, v98
    v_mul_f32 v93, v93, v98
    v_mul_f32 v94, v94, v98
    s_waitcnt lgkmcnt(1)
    v_mfma_f32_32x32x16_bf16 v[20:35], a[104:107], v[68:71], v[20:35]
    v_mul_f32 v95, v95, v98
    v_mul_f32 v96, v96, v98
    v_cvt_pk_bf16_f32 v92, v92, v93
    v_cvt_pk_bf16_f32 v93, v94, v95
    v_cvt_pk_bf16_f32 v96, v96, v96
    v_mfma_f32_32x32x16_bf16 v[36:51], a[232:235], v[68:71], v[36:51]
    ds_write_b64 v14, v[92:93]
    ds_write_b16 v15, v96 offset:64
    v_mul_u32_u24 v104, 24, v104
    v_sub_u32 v104, v16, v104
    v_mfma_f32_32x32x16_bf16 v[52:67], v[68:71], v[232:235], v[52:67]
    ds_read_b128 v[68:71], v3 offset:896
    v_mov_b32 v102, 0
    v_mov_b32 v103, 0
    s_waitcnt lgkmcnt(3)
    v_mfma_f32_32x32x16_bf16 v[20:35], a[108:111], v[72:75], v[20:35]
    s_waitcnt vmcnt(0)
    s_waitcnt lgkmcnt(1)
    s_barrier
    ds_read_b128 v[92:95], v16
    ds_read_b128 v[96:99], v16 offset:16
    ds_read_b64 v[100:101], v104 offset:64
    v_mfma_f32_32x32x16_bf16 v[36:51], a[236:239], v[72:75], v[36:51]
    v_mfma_f32_32x32x16_bf16 v[52:67], v[72:75], v[236:239], v[52:67]
    ds_read_b128 v[72:75], v3 offset:928
    s_waitcnt lgkmcnt(4)
    v_mfma_f32_32x32x16_bf16 v[20:35], a[112:115], v[68:71], v[20:35]
    s_waitcnt lgkmcnt(1)
    v_mfma_f32_32x32x16_bf16 v[76:91], v[116:119], v[92:95], 0
    v_mfma_f32_32x32x16_bf16 v[76:91], v[120:123], v[96:99], v[76:91]
    v_mfma_f32_32x32x16_bf16 v[76:91], v[124:127], v[100:103], v[76:91]
    v_mfma_f32_32x32x16_bf16 v[36:51], a[240:243], v[68:71], v[36:51]
    v_mfma_f32_32x32x16_bf16 v[52:67], v[68:71], v[240:243], v[52:67]
    ds_read_b128 v[68:71], v3 offset:960
    s_waitcnt lgkmcnt(1)
    v_mfma_f32_32x32x16_bf16 v[20:35], a[116:119], v[72:75], v[20:35]
    v_cvt_pk_bf16_f32 v108, v76, v77
    v_cvt_pk_bf16_f32 v109, v78, v79
    v_cvt_pk_bf16_f32 v110, v80, v81
    v_cvt_pk_bf16_f32 v111, v82, v83
    v_mfma_f32_32x32x16_bf16 v[36:51], a[244:247], v[72:75], v[36:51]
    v_cvt_pk_bf16_f32 v112, v84, v85
    v_cvt_pk_bf16_f32 v113, v86, v87
    v_cvt_pk_bf16_f32 v114, v88, v89
    v_cvt_pk_bf16_f32 v115, v90, v91
    v_mfma_f32_32x32x16_bf16 v[52:67], v[72:75], v[244:247], v[52:67]
    ds_read_b128 v[72:75], v3 offset:992
    s_waitcnt lgkmcnt(1)
    v_mfma_f32_32x32x16_bf16 v[20:35], a[120:123], v[68:71], v[20:35]
    buffer_store_dwordx4 v[108:111], v6, s[52:55], s40 offen sc1
    v_mfma_f32_32x32x16_bf16 v[36:51], a[248:251], v[68:71], v[36:51]
    buffer_store_dwordx4 v[112:115], v6, s[52:55], s40 offen offset:256 sc1
    v_mfma_f32_32x32x16_bf16 v[52:67], v[68:71], v[248:251], v[52:67]
    s_waitcnt lgkmcnt(0)
    v_mfma_f32_32x32x16_bf16 v[36:51], a[252:255], v[72:75], v[36:51]
    v_mfma_f32_32x32x16_bf16 v[52:67], v[72:75], v[252:255], v[52:67]
    v_mfma_f32_32x32x16_bf16 v[20:35], a[124:127], v[72:75], v[20:35]
    v_cvt_pk_bf16_f32 v36, v36, v44
    v_cvt_pk_bf16_f32 v37, v37, v45
    v_cvt_pk_bf16_f32 v38, v38, v46
    v_cvt_pk_bf16_f32 v39, v39, v47
    v_cvt_pk_bf16_f32 v40, v40, v48
    v_cvt_pk_bf16_f32 v41, v41, v49
    v_cvt_pk_bf16_f32 v42, v42, v50
    v_cvt_pk_bf16_f32 v43, v43, v51
    buffer_store_dwordx4 v[36:39], v4, s[52:55], s20 offen sc1
    buffer_store_dwordx4 v[40:43], v4, s[52:55], s20 offen offset:256 sc1
    v_cvt_pk_bf16_f32 v52, v52, v53
    v_cvt_pk_bf16_f32 v53, v54, v55
    v_cvt_pk_bf16_f32 v54, v56, v57
    v_cvt_pk_bf16_f32 v55, v58, v59
    v_cvt_pk_bf16_f32 v56, v60, v61
    v_cvt_pk_bf16_f32 v57, v62, v63
    v_cvt_pk_bf16_f32 v58, v64, v65
    v_cvt_pk_bf16_f32 v59, v66, v67
    buffer_store_dwordx4 v[52:55], v5, s[52:55], s20 offen sc1
    buffer_store_dwordx4 v[56:59], v5, s[52:55], s20 offen offset:512 sc1
    v_cvt_pk_bf16_f32 v76, v20, v28
    v_cvt_pk_bf16_f32 v77, v21, v29
    v_cvt_pk_bf16_f32 v78, v22, v30
    v_cvt_pk_bf16_f32 v79, v23, v31
    v_cvt_pk_bf16_f32 v80, v24, v32
    v_cvt_pk_bf16_f32 v81, v25, v33
    v_cvt_pk_bf16_f32 v82, v26, v34
    v_cvt_pk_bf16_f32 v83, v27, v35
    ds_write_b128 v10, v[76:79] offset:0
    ds_write_b128 v10, v[80:83] offset:1024
    s_branch L_wnext
L_wpoison:
    v_mov_b32 v100, -1
    v_mov_b32 v101, -1
    v_mov_b32 v102, -1
    v_mov_b32 v103, -1
    s_lshl_b32 s14, s3, 10
    s_add_u32 s14, s14, s21
    s_add_u32 s14, s14, 6291456
    buffer_store_dwordx4 v[100:103], v1, s[52:55], s14 offen sc1
    s_add_u32 s14, s14, 262144
    buffer_store_dwordx4 v[100:103], v1, s[52:55], s14 offen sc1
    s_add_u32 s14, s14, 262144
    buffer_store_dwordx4 v[100:103], v1, s[52:55], s14 offen sc1
    s_add_u32 s14, s14, 262144
    buffer_store_dwordx4 v[100:103], v1, s[52:55], s14 offen sc1
    s_add_u32 s14, s14, 262144
    buffer_store_dwordx4 v[100:103], v1, s[52:55], s14 offen sc1
    s_add_u32 s14, s14, 262144
    s_add_u32 s14, s22, 14155776
    buffer_store_dwordx4 v[100:103], v6, s[52:55], s14 offen sc1
    buffer_store_dwordx4 v[100:103], v6, s[52:55], s14 offen offset:256 sc1
    s_add_u32 s14, s22, 14680064
    buffer_store_dwordx4 v[100:103], v6, s[52:55], s14 offen sc1
    buffer_store_dwordx4 v[100:103], v6, s[52:55], s14 offen offset:256 sc1
    s_branch L_wpoison_r
L_wtail:
    buffer_load_dword v17, off, s[52:55], s24 sc1
    buffer_load_dwordx4 v[100:103], v4, s[52:55], s39 offen sc1
    buffer_load_dwordx4 v[104:107], v4, s[52:55], s39 offen offset:256 sc1
    buffer_load_dwordx4 v[116:119], v5, s[52:55], s39 offen sc1
    buffer_load_dwordx4 v[120:123], v5, s[52:55], s39 offen offset:512 sc1
    ds_read_b128 v[92:95], v10 offset:0
    ds_read_b128 v[96:99], v10 offset:1024
    s_waitcnt vmcnt(5)
    s_barrier
    s_min_u32 s14, s16, 32
    v_mov_b32 v18, s14
    buffer_store_dword v18, v19, s[52:55], s23 offen sc1
    s_sub_u32 s14, s16, 5
    v_mov_b32 v76, s14
    buffer_store_dword v76, v19, s[52:55], s25 offen sc1
    s_waitcnt vmcnt(4)
    s_waitcnt lgkmcnt(0)
    v_mfma_f32_32x32x16_bf16 v[76:91], v[100:103], v[92:95], 0
    v_mfma_f32_32x32x16_bf16 v[76:91], v[104:107], v[96:99], v[76:91]
    s_nop 11
    ds_write_b128 v11, v[76:79] offset:0
    ds_write_b128 v11, v[80:83] offset:32
    ds_write_b128 v11, v[84:87] offset:64
    ds_write_b128 v11, v[88:91] offset:96
    s_mov_b32 s13, 0
L_wlast_l:
    buffer_load_dword v17, off, s[52:55], s24 sc1
    buffer_load_dwordx4 v[108:111], v7, s[52:55], s21 offen sc1
    buffer_load_dwordx4 v[112:115], v7, s[52:55], s21 offen offset:16 sc1
    buffer_load_dwordx2 v[124:125], v8, s[52:55], s21 offen sc1
    s_waitcnt vmcnt(0)
    v_max3_u32 v18, v108, v109, v110
    v_max3_u32 v18, v18, v111, v112
    v_max3_u32 v18, v18, v113, v114
    v_max3_u32 v18, v18, v115, v124
    v_max_u32 v18, v18, v125
    v_cmp_eq_u32 vcc, -1, v18
    s_cbranch_vccz L_wkm
    v_readfirstlane_b32 s14, v17
    s_nop 0
    s_cmp_ge_i32 s14, s37
    s_cbranch_scc0 L_wlast_r
    buffer_load_dwordx4 v[108:111], v7, s[52:55], s21 offen sc1
    buffer_load_dwordx4 v[112:115], v7, s[52:55], s21 offen offset:16 sc1
    buffer_load_dwordx2 v[124:125], v8, s[52:55], s21 offen sc1
    s_branch L_wkm
L_wlast_r:
    s_add_u32 s13, s13, 1
    s_cmp_lt_u32 s13, 1048576
    s_cbranch_scc1 L_wlast_l
    s_branch L_end
L_wkm:
    s_waitcnt vmcnt(1)
    v_mfma_f32_32x32x16_bf16 v[76:91], v[108:111], v[92:95], 0
    v_mfma_f32_32x32x16_bf16 v[76:91], v[112:115], v[96:99], v[76:91]
    s_nop 11
    ds_write_b128 v11, v[76:79] offset:128
    s_waitcnt lgkmcnt(0)
    s_barrier
    ds_read_b128 v[92:95], v12 offset:0
    ds_read_b128 v[96:99], v12 offset:5632
    ds_read_b128 v[100:103], v12 offset:11264
    ds_read_b128 v[104:107], v12 offset:16896
    ds_read_b32 v108, v13 offset:128
    ds_read_b32 v109, v13 offset:5760
    ds_read_b32 v110, v13 offset:11392
    ds_read_b32 v111, v13 offset:17024
    v_mov_b32 v112, s38
    s_waitcnt lgkmcnt(6)
    v_add_f32 v92, v92, v96
    v_add_f32 v93, v93, v97
    v_add_f32 v94, v94, v98
    v_add_f32 v95, v95, v99
    s_waitcnt lgkmcnt(4)
    v_add_f32 v100, v100, v104
    v_add_f32 v101, v101, v105
    v_add_f32 v102, v102, v106
    v_add_f32 v103, v103, v107
    v_add_f32 v92, v92, v100
    v_add_f32 v93, v93, v101
    v_add_f32 v94, v94, v102
    v_add_f32 v95, v95, v103
    v_cndmask_b32 v92, v112, v92, s[28:29]
    v_cndmask_b32 v93, v112, v93, s[30:31]
    v_cndmask_b32 v94, v112, v94, s[32:33]
    v_cndmask_b32 v95, v112, v95, s[34:35]
    s_waitcnt lgkmcnt(0)
    v_add_f32 v108, v108, v109
    v_add_f32 v110, v110, v111
    v_max3_f32 v97, v92, v93, v94
    v_add_f32 v96, v108, v110
    v_max3_f32 v97, v97, v95, v96
    s_nop 1
    v_max_f32_dpp v97, v97, v97 quad_perm:[1,0,3,2] row_mask:0xf bank_mask:0xf
    s_nop 1
    v_max_f32_dpp v97, v97, v97 quad_perm:[2,3,0,1] row_mask:0xf bank_mask:0xf
    s_nop 1
    v_max_f32_dpp v97, v97, v97 row_half_mirror row_mask:0xf bank_mask:0xf
    v_mul_f32 v97, s26, v97
    v_fma_f32 v92, v92, s26, -v97
    v_fma_f32 v93, v93, s26, -v97
    v_fma_f32 v94, v94, s26, -v97
    v_fma_f32 v95, v95, s26, -v97
    v_fma_f32 v96, v96, s26, -v97
    v_exp_f32 v92, v92
    v_exp_f32 v93, v93
    v_exp_f32 v94, v94
    v_exp_f32 v95, v95
    v_exp_f32 v96, v96
    v_add_f32 v98, v92, v93
    v_add_f32 v99, v94, v95
    v_add_f32 v98, v98, v96
    v_add_f32 v98, v98, v99
    s_nop 1
    v_add_f32_dpp v98, v98, v98 quad_perm:[1,0,3,2] row_mask:0xf bank_mask:0xf
    s_nop 1
    v_add_f32_dpp v98, v98, v98 quad_perm:[2,3,0,1] row_mask:0xf bank_mask:0xf
    s_nop 1
    v_add_f32_dpp v98, v98, v98 row_half_mirror row_mask:0xf bank_mask:0xf
    v_rcp_f32 v98, v98
    v_lshrrev_b32 v104, 5, v0
    v_mul_f32 v92, v92, v98
    v_mul_f32 v93, v93, v98
    v_mul_f32 v94, v94, v98
    v_mul_f32 v95, v95, v98
    v_mul_f32 v96, v96, v98
    v_cvt_pk_bf16_f32 v92, v92, v93
    v_cvt_pk_bf16_f32 v93, v94, v95
    v_cvt_pk_bf16_f32 v96, v96, v96
    ds_write_b64 v14, v[92:93]
    ds_write_b16 v15, v96 offset:64
    v_mul_u32_u24 v104, 24, v104
    v_sub_u32 v104, v16, v104
    v_mov_b32 v102, 0
    v_mov_b32 v103, 0
    s_waitcnt vmcnt(0)
    s_waitcnt lgkmcnt(0)
    s_barrier
    ds_read_b128 v[92:95], v16
    ds_read_b128 v[96:99], v16 offset:16
    ds_read_b64 v[100:101], v104 offset:64
    s_waitcnt lgkmcnt(2)
    v_mfma_f32_32x32x16_bf16 v[76:91], v[116:119], v[92:95], 0
    s_waitcnt lgkmcnt(1)
    v_mfma_f32_32x32x16_bf16 v[76:91], v[120:123], v[96:99], v[76:91]
    s_waitcnt lgkmcnt(0)
    v_mfma_f32_32x32x16_bf16 v[76:91], v[124:127], v[100:103], v[76:91]
    s_nop 11
    v_cvt_pk_bf16_f32 v108, v76, v77
    v_cvt_pk_bf16_f32 v109, v78, v79
    v_cvt_pk_bf16_f32 v110, v80, v81
    v_cvt_pk_bf16_f32 v111, v82, v83
    v_cvt_pk_bf16_f32 v112, v84, v85
    v_cvt_pk_bf16_f32 v113, v86, v87
    v_cvt_pk_bf16_f32 v114, v88, v89
    v_cvt_pk_bf16_f32 v115, v90, v91
    buffer_store_dwordx4 v[108:111], v6, s[52:55], s40 offen sc1
    buffer_store_dwordx4 v[112:115], v6, s[52:55], s40 offen offset:256 sc1
L_wnext:
    s_add_u32 s16, s16, 1
    s_add_u32 s20, s20, 1048576
    s_add_u32 s21, s21, 262144
    s_add_u32 s22, s22, 524288
    s_add_u32 s37, s37, 2
    s_add_u32 s18, s18, 8192
    s_cmp_eq_u32 s18, 40960
    s_cselect_b32 s18, 0, s18
    s_cmp_lt_u32 s16, 37
    s_cbranch_scc1 L_wloop
    s_waitcnt vmcnt(0)
    s_barrier
    s_sub_u32 s14, s16, 5
    v_mov_b32 v76, s14
    buffer_store_dword v76, v19, s[52:55], s25 offen sc1
    s_endpgm
L_outp:
    s_lshr_b32 s10, s5, 3
    s_and_b32 s11, s5, 7
    s_lshl_b32 s84, s3, 15
    v_mov_b32 v116, -1
    v_mov_b32 v117, -1
    v_mov_b32 v118, -1
    v_mov_b32 v119, -1
    s_lshl_b32 s14, s3, 10
    s_cmp_eq_u32 s7, 0
    s_cselect_b32 s14, s14, 0x40000000
    v_add_u32 v120, s14, v1
    s_lshl_b32 s14, s2, 12
    buffer_store_dwordx4 v[116:119], v120, s[52:55], s14 offen sc1
    s_waitcnt vmcnt(0)
    s_barrier
    s_lshl_b32 s14, s12, 3
    s_or_b32 s15, s3, s7
    s_cmp_eq_u32 s15, 0
    s_cselect_b32 s14, s14, 0x40000000
    s_lshr_b32 s15, s2, 3
    s_lshl_b32 s15, 1, s15
    v_mov_b32 v126, s15
    v_mov_b32 v127, 0x100
    v_mov_b32 v14, s14
    v_cmp_eq_u32 vcc, 0, v0
    v_mov_b32 v15, 0x40000000
    s_nop 0
    v_cndmask_b32 v14, v15, v14, vcc
    buffer_atomic_add_x2 v[126:127], v14, s[56:59], 0 offen offset:128 sc0 sc1
    s_cmp_eq_u32 s7, 1
    s_cbranch_scc1 L_vdone_9
    s_mov_b32 s13, 0
    v_and_b32 v18, 7, v0
    v_lshlrev_b32 v18, 3, v18
L_vloop_10:
    buffer_load_dwordx2 v[16:17], v18, s[56:59], 0 offen offset:128 sc1
    s_waitcnt vmcnt(0)
    v_cmp_eq_u32 vcc, -1, v16
    v_mov_b32 v19, 0x2000
    v_cmp_eq_u32 s[14:15], v19, v17
    s_nop 0
    s_and_b64 vcc, vcc, s[14:15]
    s_cmp_eq_u64 vcc, -1
    s_cbranch_scc1 L_vdone_9
    v_lshrrev_b32 v17, 8, v17
    s_mov_b32 s50, 0
    v_readlane_b32 s51, v17, 0
    s_nop 0
    s_add_u32 s50, s50, s51
    v_readlane_b32 s51, v17, 1
    s_nop 0
    s_add_u32 s50, s50, s51
    v_readlane_b32 s51, v17, 2
    s_nop 0
    s_add_u32 s50, s50, s51
    v_readlane_b32 s51, v17, 3
    s_nop 0
    s_add_u32 s50, s50, s51
    v_readlane_b32 s51, v17, 4
    s_nop 0
    s_add_u32 s50, s50, s51
    v_readlane_b32 s51, v17, 5
    s_nop 0
    s_add_u32 s50, s50, s51
    v_readlane_b32 s51, v17, 6
    s_nop 0
    s_add_u32 s50, s50, s51
    v_readlane_b32 s51, v17, 7
    s_nop 0
    s_add_u32 s50, s50, s51
    s_cmp_ge_u32 s50, 256
    s_cbranch_scc1 L_vfb_11
    s_add_u32 s13, s13, 1
    s_cmp_lt_u32 s13, 1048576
    s_cbranch_scc1 L_vloop_10
    s_branch L_end
L_vfb_11:
    v_mov_b32 v20, 163328
    v_lshrrev_b32 v21, 8, v127
    s_cmp_eq_u32 s3, 0
    s_cselect_b64 exec, 1, 0
    ds_write_b32 v20, v21
    s_mov_b64 exec, -1
    s_waitcnt lgkmcnt(0)
    s_barrier
    ds_read_b32 v21, v20
    v_cmp_eq_u32 vcc, 32, v17
    s_waitcnt lgkmcnt(0)
    v_readfirstlane_b32 s14, v21
    s_barrier
    s_lshr_b32 s15, s2, 5
    s_and_b32 s50, s2, 31
    s_and_b32 s14, s14, 31
    s_cmp_eq_u64 vcc, -1
    s_cselect_b32 s4, s12, s15
    s_cselect_b32 s5, s14, s50
    s_cselect_b32 s6, 0, 1
    s_mov_b32 s7, 1
    s_branch L_reload
L_vdone_9:
    s_lshl_b32 s14, s5, 2
    s_add_u32 s14, s14, s3
    s_lshl_b32 s14, s14, 13
    v_lshl_add_u32 v8, v0, 7, s14
    s_mov_b32 s14, 0
    buffer_load_dword v9, v8, s[72:75], s14 offen
    s_mov_b32 s14, 1048576
    buffer_load_dword v9, v8, s[72:75], s14 offen
    s_mov_b32 s14, 2097152
    buffer_load_dword v9, v8, s[72:75], s14 offen
    s_mov_b32 s14, 3145728
    buffer_load_dword v9, v8, s[72:75], s14 offen
    v_lshrrev_b32 v3, 3, v0
    v_and_b32 v4, 7, v0
    v_lshlrev_b32 v3, 10, v3
    v_lshl_add_u32 v3, v4, 4, v3
    s_lshl_b32 s14, s11, 7
    s_lshl_b32 s15, s3, 20
    s_add_u32 s14, s14, s15
    v_add_u32 v2, s14, v3
    s_waitcnt vmcnt(0)
    s_add_u32 m0, s84, 0
    s_mov_b32 s50, 0
    buffer_load_dwordx4 v2, s[72:75], s50 offen lds
    s_add_u32 m0, m0, 1024
    s_add_u32 s50, s50, 8192
    buffer_load_dwordx4 v2, s[72:75], s50 offen lds
    s_add_u32 m0, m0, 1024
    s_add_u32 s50, s50, 8192
    buffer_load_dwordx4 v2, s[72:75], s50 offen lds
    s_add_u32 m0, m0, 1024
    s_add_u32 s50, s50, 8192
    buffer_load_dwordx4 v2, s[72:75], s50 offen lds
    s_add_u32 m0, m0, 1024
    s_add_u32 s50, s50, 8192
    buffer_load_dwordx4 v2, s[72:75], s50 offen lds
    s_add_u32 m0, m0, 1024
    s_add_u32 s50, s50, 8192
    buffer_load_dwordx4 v2, s[72:75], s50 offen lds
    s_add_u32 m0, m0, 1024
    s_add_u32 s50, s50, 8192
    buffer_load_dwordx4 v2, s[72:75], s50 offen lds
    s_add_u32 m0, m0, 1024
    s_add_u32 s50, s50, 8192
    buffer_load_dwordx4 v2, s[72:75], s50 offen lds
    s_add_u32 m0, m0, 1024
    s_add_u32 s50, s50, 8192
    buffer_load_dwordx4 v2, s[72:75], s50 offen lds
    s_add_u32 m0, m0, 1024
    s_add_u32 s50, s50, 8192
    buffer_load_dwordx4 v2, s[72:75], s50 offen lds
    s_add_u32 m0, m0, 1024
    s_add_u32 s50, s50, 8192
    buffer_load_dwordx4 v2, s[72:75], s50 offen lds
    s_add_u32 m0, m0, 1024
    s_add_u32 s50, s50, 8192
    buffer_load_dwordx4 v2, s[72:75], s50 offen lds
    s_add_u32 m0, m0, 1024
    s_add_u32 s50, s50, 8192
    buffer_load_dwordx4 v2, s[72:75], s50 offen lds
    s_add_u32 m0, m0, 1024
    s_add_u32 s50, s50, 8192
    buffer_load_dwordx4 v2, s[72:75], s50 offen lds
    s_add_u32 m0, m0, 1024
    s_add_u32 s50, s50, 8192
    buffer_load_dwordx4 v2, s[72:75], s50 offen lds
    s_add_u32 m0, m0, 1024
    s_add_u32 s50, s50, 8192
    buffer_load_dwordx4 v2, s[72:75], s50 offen lds
    s_add_u32 m0, s84, 16384
    s_mov_b32 s50, 131072
    buffer_load_dwordx4 v2, s[72:75], s50 offen lds
    s_add_u32 m0, m0, 1024
    s_add_u32 s50, s50, 8192
    buffer_load_dwordx4 v2, s[72:75], s50 offen lds
    s_add_u32 m0, m0, 1024
    s_add_u32 s50, s50, 8192
    buffer_load_dwordx4 v2, s[72:75], s50 offen lds
    s_add_u32 m0, m0, 1024
    s_add_u32 s50, s50, 8192
    buffer_load_dwordx4 v2, s[72:75], s50 offen lds
    s_add_u32 m0, m0, 1024
    s_add_u32 s50, s50, 8192
    buffer_load_dwordx4 v2, s[72:75], s50 offen lds
    s_add_u32 m0, m0, 1024
    s_add_u32 s50, s50, 8192
    buffer_load_dwordx4 v2, s[72:75], s50 offen lds
    s_add_u32 m0, m0, 1024
    s_add_u32 s50, s50, 8192
    buffer_load_dwordx4 v2, s[72:75], s50 offen lds
    s_add_u32 m0, m0, 1024
    s_add_u32 s50, s50, 8192
    buffer_load_dwordx4 v2, s[72:75], s50 offen lds
    s_add_u32 m0, m0, 1024
    s_add_u32 s50, s50, 8192
    buffer_load_dwordx4 v2, s[72:75], s50 offen lds
    s_add_u32 m0, m0, 1024
    s_add_u32 s50, s50, 8192
    buffer_load_dwordx4 v2, s[72:75], s50 offen lds
    s_add_u32 m0, m0, 1024
    s_add_u32 s50, s50, 8192
    buffer_load_dwordx4 v2, s[72:75], s50 offen lds
    s_add_u32 m0, m0, 1024
    s_add_u32 s50, s50, 8192
    buffer_load_dwordx4 v2, s[72:75], s50 offen lds
    s_add_u32 m0, m0, 1024
    s_add_u32 s50, s50, 8192
    buffer_load_dwordx4 v2, s[72:75], s50 offen lds
    s_add_u32 m0, m0, 1024
    s_add_u32 s50, s50, 8192
    buffer_load_dwordx4 v2, s[72:75], s50 offen lds
    s_add_u32 m0, m0, 1024
    s_add_u32 s50, s50, 8192
    buffer_load_dwordx4 v2, s[72:75], s50 offen lds
    s_add_u32 m0, m0, 1024
    s_add_u32 s50, s50, 8192
    buffer_load_dwordx4 v2, s[72:75], s50 offen lds
    v_lshrrev_b32 v3, 3, v0
    v_bfe_u32 v5, v0, 2, 1
    v_lshl_add_u32 v3, v3, 2, v5
    v_lshlrev_b32 v3, 7, v3
    v_and_b32 v4, 3, v0
    v_lshl_add_u32 v3, v4, 3, v3
    v_add_u32 v6, s84, v3
    v_add_u32 v12, s84, v1
    s_waitcnt vmcnt(16)
    ds_read_b64_tr_b16 a[0:1], v6 offset:0
    ds_read_b64_tr_b16 a[2:3], v6 offset:256
    ds_read_b64_tr_b16 a[4:5], v6 offset:4096
    ds_read_b64_tr_b16 a[6:7], v6 offset:4352
    ds_read_b64_tr_b16 a[8:9], v6 offset:32
    ds_read_b64_tr_b16 a[10:11], v6 offset:288
    ds_read_b64_tr_b16 a[12:13], v6 offset:4128
    ds_read_b64_tr_b16 a[14:15], v6 offset:4384
    ds_read_b64_tr_b16 v[128:129], v6 offset:64
    ds_read_b64_tr_b16 v[130:131], v6 offset:320
    ds_read_b64_tr_b16 v[132:133], v6 offset:4160
    ds_read_b64_tr_b16 v[134:135], v6 offset:4416
    ds_read_b64_tr_b16 v[16:17], v6 offset:96
    ds_read_b64_tr_b16 v[18:19], v6 offset:352
    ds_read_b64_tr_b16 v[20:21], v6 offset:4192
    ds_read_b64_tr_b16 v[22:23], v6 offset:4448
    ds_read_b64_tr_b16 a[16:17], v6 offset:8192
    ds_read_b64_tr_b16 a[18:19], v6 offset:8448
    ds_read_b64_tr_b16 a[20:21], v6 offset:12288
    ds_read_b64_tr_b16 a[22:23], v6 offset:12544
    ds_read_b64_tr_b16 a[24:25], v6 offset:8224
    ds_read_b64_tr_b16 a[26:27], v6 offset:8480
    ds_read_b64_tr_b16 a[28:29], v6 offset:12320
    ds_read_b64_tr_b16 a[30:31], v6 offset:12576
    ds_read_b64_tr_b16 v[136:137], v6 offset:8256
    ds_read_b64_tr_b16 v[138:139], v6 offset:8512
    ds_read_b64_tr_b16 v[140:141], v6 offset:12352
    ds_read_b64_tr_b16 v[142:143], v6 offset:12608
    ds_read_b64_tr_b16 v[24:25], v6 offset:8288
    ds_read_b64_tr_b16 v[26:27], v6 offset:8544
    ds_read_b64_tr_b16 v[28:29], v6 offset:12384
    ds_read_b64_tr_b16 v[30:31], v6 offset:12640
    s_waitcnt lgkmcnt(0)
    s_add_u32 m0, s84, 0
    s_mov_b32 s50, 262144
    buffer_load_dwordx4 v2, s[72:75], s50 offen lds
    s_add_u32 m0, m0, 1024
    s_add_u32 s50, s50, 8192
    buffer_load_dwordx4 v2, s[72:75], s50 offen lds
    s_add_u32 m0, m0, 1024
    s_add_u32 s50, s50, 8192
    buffer_load_dwordx4 v2, s[72:75], s50 offen lds
    s_add_u32 m0, m0, 1024
    s_add_u32 s50, s50, 8192
    buffer_load_dwordx4 v2, s[72:75], s50 offen lds
    s_add_u32 m0, m0, 1024
    s_add_u32 s50, s50, 8192
    buffer_load_dwordx4 v2, s[72:75], s50 offen lds
    s_add_u32 m0, m0, 1024
    s_add_u32 s50, s50, 8192
    buffer_load_dwordx4 v2, s[72:75], s50 offen lds
    s_add_u32 m0, m0, 1024
    s_add_u32 s50, s50, 8192
    buffer_load_dwordx4 v2, s[72:75], s50 offen lds
    s_add_u32 m0, m0, 1024
    s_add_u32 s50, s50, 8192
    buffer_load_dwordx4 v2, s[72:75], s50 offen lds
    s_add_u32 m0, m0, 1024
    s_add_u32 s50, s50, 8192
    buffer_load_dwordx4 v2, s[72:75], s50 offen lds
    s_add_u32 m0, m0, 1024
    s_add_u32 s50, s50, 8192
    buffer_load_dwordx4 v2, s[72:75], s50 offen lds
    s_add_u32 m0, m0, 1024
    s_add_u32 s50, s50, 8192
    buffer_load_dwordx4 v2, s[72:75], s50 offen lds
    s_add_u32 m0, m0, 1024
    s_add_u32 s50, s50, 8192
    buffer_load_dwordx4 v2, s[72:75], s50 offen lds
    s_add_u32 m0, m0, 1024
    s_add_u32 s50, s50, 8192
    buffer_load_dwordx4 v2, s[72:75], s50 offen lds
    s_add_u32 m0, m0, 1024
    s_add_u32 s50, s50, 8192
    buffer_load_dwordx4 v2, s[72:75], s50 offen lds
    s_add_u32 m0, m0, 1024
    s_add_u32 s50, s50, 8192
    buffer_load_dwordx4 v2, s[72:75], s50 offen lds
    s_add_u32 m0, m0, 1024
    s_add_u32 s50, s50, 8192
    buffer_load_dwordx4 v2, s[72:75], s50 offen lds
    s_waitcnt vmcnt(16)
    ds_read_b64_tr_b16 a[32:33], v6 offset:16384
    ds_read_b64_tr_b16 a[34:35], v6 offset:16640
    ds_read_b64_tr_b16 a[36:37], v6 offset:20480
    ds_read_b64_tr_b16 a[38:39], v6 offset:20736
    ds_read_b64_tr_b16 a[40:41], v6 offset:16416
    ds_read_b64_tr_b16 a[42:43], v6 offset:16672
    ds_read_b64_tr_b16 a[44:45], v6 offset:20512
    ds_read_b64_tr_b16 a[46:47], v6 offset:20768
    ds_read_b64_tr_b16 v[144:145], v6 offset:16448
    ds_read_b64_tr_b16 v[146:147], v6 offset:16704
    ds_read_b64_tr_b16 v[148:149], v6 offset:20544
    ds_read_b64_tr_b16 v[150:151], v6 offset:20800
    ds_read_b64_tr_b16 v[32:33], v6 offset:16480
    ds_read_b64_tr_b16 v[34:35], v6 offset:16736
    ds_read_b64_tr_b16 v[36:37], v6 offset:20576
    ds_read_b64_tr_b16 v[38:39], v6 offset:20832
    ds_read_b64_tr_b16 a[48:49], v6 offset:24576
    ds_read_b64_tr_b16 a[50:51], v6 offset:24832
    ds_read_b64_tr_b16 a[52:53], v6 offset:28672
    ds_read_b64_tr_b16 a[54:55], v6 offset:28928
    ds_read_b64_tr_b16 a[56:57], v6 offset:24608
    ds_read_b64_tr_b16 a[58:59], v6 offset:24864
    ds_read_b64_tr_b16 a[60:61], v6 offset:28704
    ds_read_b64_tr_b16 a[62:63], v6 offset:28960
    ds_read_b64_tr_b16 v[152:153], v6 offset:24640
    ds_read_b64_tr_b16 v[154:155], v6 offset:24896
    ds_read_b64_tr_b16 v[156:157], v6 offset:28736
    ds_read_b64_tr_b16 v[158:159], v6 offset:28992
    ds_read_b64_tr_b16 v[40:41], v6 offset:24672
    ds_read_b64_tr_b16 v[42:43], v6 offset:24928
    ds_read_b64_tr_b16 v[44:45], v6 offset:28768
    ds_read_b64_tr_b16 v[46:47], v6 offset:29024
    s_waitcnt lgkmcnt(0)
    s_add_u32 m0, s84, 16384
    s_mov_b32 s50, 393216
    buffer_load_dwordx4 v2, s[72:75], s50 offen lds
    s_add_u32 m0, m0, 1024
    s_add_u32 s50, s50, 8192
    buffer_load_dwordx4 v2, s[72:75], s50 offen lds
    s_add_u32 m0, m0, 1024
    s_add_u32 s50, s50, 8192
    buffer_load_dwordx4 v2, s[72:75], s50 offen lds
    s_add_u32 m0, m0, 1024
    s_add_u32 s50, s50, 8192
    buffer_load_dwordx4 v2, s[72:75], s50 offen lds
    s_add_u32 m0, m0, 1024
    s_add_u32 s50, s50, 8192
    buffer_load_dwordx4 v2, s[72:75], s50 offen lds
    s_add_u32 m0, m0, 1024
    s_add_u32 s50, s50, 8192
    buffer_load_dwordx4 v2, s[72:75], s50 offen lds
    s_add_u32 m0, m0, 1024
    s_add_u32 s50, s50, 8192
    buffer_load_dwordx4 v2, s[72:75], s50 offen lds
    s_add_u32 m0, m0, 1024
    s_add_u32 s50, s50, 8192
    buffer_load_dwordx4 v2, s[72:75], s50 offen lds
    s_add_u32 m0, m0, 1024
    s_add_u32 s50, s50, 8192
    buffer_load_dwordx4 v2, s[72:75], s50 offen lds
    s_add_u32 m0, m0, 1024
    s_add_u32 s50, s50, 8192
    buffer_load_dwordx4 v2, s[72:75], s50 offen lds
    s_add_u32 m0, m0, 1024
    s_add_u32 s50, s50, 8192
    buffer_load_dwordx4 v2, s[72:75], s50 offen lds
    s_add_u32 m0, m0, 1024
    s_add_u32 s50, s50, 8192
    buffer_load_dwordx4 v2, s[72:75], s50 offen lds
    s_add_u32 m0, m0, 1024
    s_add_u32 s50, s50, 8192
    buffer_load_dwordx4 v2, s[72:75], s50 offen lds
    s_add_u32 m0, m0, 1024
    s_add_u32 s50, s50, 8192
    buffer_load_dwordx4 v2, s[72:75], s50 offen lds
    s_add_u32 m0, m0, 1024
    s_add_u32 s50, s50, 8192
    buffer_load_dwordx4 v2, s[72:75], s50 offen lds
    s_add_u32 m0, m0, 1024
    s_add_u32 s50, s50, 8192
    buffer_load_dwordx4 v2, s[72:75], s50 offen lds
    s_waitcnt vmcnt(16)
    ds_read_b64_tr_b16 a[64:65], v6 offset:0
    ds_read_b64_tr_b16 a[66:67], v6 offset:256
    ds_read_b64_tr_b16 a[68:69], v6 offset:4096
    ds_read_b64_tr_b16 a[70:71], v6 offset:4352
    ds_read_b64_tr_b16 a[72:73], v6 offset:32
    ds_read_b64_tr_b16 a[74:75], v6 offset:288
    ds_read_b64_tr_b16 a[76:77], v6 offset:4128
    ds_read_b64_tr_b16 a[78:79], v6 offset:4384
    ds_read_b64_tr_b16 v[160:161], v6 offset:64
    ds_read_b64_tr_b16 v[162:163], v6 offset:320
    ds_read_b64_tr_b16 v[164:165], v6 offset:4160
    ds_read_b64_tr_b16 v[166:167], v6 offset:4416
    ds_read_b64_tr_b16 v[48:49], v6 offset:96
    ds_read_b64_tr_b16 v[50:51], v6 offset:352
    ds_read_b64_tr_b16 v[52:53], v6 offset:4192
    ds_read_b64_tr_b16 v[54:55], v6 offset:4448
    ds_read_b64_tr_b16 a[80:81], v6 offset:8192
    ds_read_b64_tr_b16 a[82:83], v6 offset:8448
    ds_read_b64_tr_b16 a[84:85], v6 offset:12288
    ds_read_b64_tr_b16 a[86:87], v6 offset:12544
    ds_read_b64_tr_b16 a[88:89], v6 offset:8224
    ds_read_b64_tr_b16 a[90:91], v6 offset:8480
    ds_read_b64_tr_b16 a[92:93], v6 offset:12320
    ds_read_b64_tr_b16 a[94:95], v6 offset:12576
    ds_read_b64_tr_b16 v[168:169], v6 offset:8256
    ds_read_b64_tr_b16 v[170:171], v6 offset:8512
    ds_read_b64_tr_b16 v[172:173], v6 offset:12352
    ds_read_b64_tr_b16 v[174:175], v6 offset:12608
    ds_read_b64_tr_b16 v[56:57], v6 offset:8288
    ds_read_b64_tr_b16 v[58:59], v6 offset:8544
    ds_read_b64_tr_b16 v[60:61], v6 offset:12384
    ds_read_b64_tr_b16 v[62:63], v6 offset:12640
    s_waitcnt lgkmcnt(0)
    s_add_u32 m0, s84, 0
    s_mov_b32 s50, 524288
    buffer_load_dwordx4 v2, s[72:75], s50 offen lds
    s_add_u32 m0, m0, 1024
    s_add_u32 s50, s50, 8192
    buffer_load_dwordx4 v2, s[72:75], s50 offen lds
    s_add_u32 m0, m0, 1024
    s_add_u32 s50, s50, 8192
    buffer_load_dwordx4 v2, s[72:75], s50 offen lds
    s_add_u32 m0, m0, 1024
    s_add_u32 s50, s50, 8192
    buffer_load_dwordx4 v2, s[72:75], s50 offen lds
    s_add_u32 m0, m0, 1024
    s_add_u32 s50, s50, 8192
    buffer_load_dwordx4 v2, s[72:75], s50 offen lds
    s_add_u32 m0, m0, 1024
    s_add_u32 s50, s50, 8192
    buffer_load_dwordx4 v2, s[72:75], s50 offen lds
    s_add_u32 m0, m0, 1024
    s_add_u32 s50, s50, 8192
    buffer_load_dwordx4 v2, s[72:75], s50 offen lds
    s_add_u32 m0, m0, 1024
    s_add_u32 s50, s50, 8192
    buffer_load_dwordx4 v2, s[72:75], s50 offen lds
    s_add_u32 m0, m0, 1024
    s_add_u32 s50, s50, 8192
    buffer_load_dwordx4 v2, s[72:75], s50 offen lds
    s_add_u32 m0, m0, 1024
    s_add_u32 s50, s50, 8192
    buffer_load_dwordx4 v2, s[72:75], s50 offen lds
    s_add_u32 m0, m0, 1024
    s_add_u32 s50, s50, 8192
    buffer_load_dwordx4 v2, s[72:75], s50 offen lds
    s_add_u32 m0, m0, 1024
    s_add_u32 s50, s50, 8192
    buffer_load_dwordx4 v2, s[72:75], s50 offen lds
    s_add_u32 m0, m0, 1024
    s_add_u32 s50, s50, 8192
    buffer_load_dwordx4 v2, s[72:75], s50 offen lds
    s_add_u32 m0, m0, 1024
    s_add_u32 s50, s50, 8192
    buffer_load_dwordx4 v2, s[72:75], s50 offen lds
    s_add_u32 m0, m0, 1024
    s_add_u32 s50, s50, 8192
    buffer_load_dwordx4 v2, s[72:75], s50 offen lds
    s_add_u32 m0, m0, 1024
    s_add_u32 s50, s50, 8192
    buffer_load_dwordx4 v2, s[72:75], s50 offen lds
    s_waitcnt vmcnt(16)
    ds_read_b64_tr_b16 a[96:97], v6 offset:16384
    ds_read_b64_tr_b16 a[98:99], v6 offset:16640
    ds_read_b64_tr_b16 a[100:101], v6 offset:20480
    ds_read_b64_tr_b16 a[102:103], v6 offset:20736
    ds_read_b64_tr_b16 a[104:105], v6 offset:16416
    ds_read_b64_tr_b16 a[106:107], v6 offset:16672
    ds_read_b64_tr_b16 a[108:109], v6 offset:20512
    ds_read_b64_tr_b16 a[110:111], v6 offset:20768
    ds_read_b64_tr_b16 v[176:177], v6 offset:16448
    ds_read_b64_tr_b16 v[178:179], v6 offset:16704
    ds_read_b64_tr_b16 v[180:181], v6 offset:20544
    ds_read_b64_tr_b16 v[182:183], v6 offset:20800
    ds_read_b64_tr_b16 v[64:65], v6 offset:16480
    ds_read_b64_tr_b16 v[66:67], v6 offset:16736
    ds_read_b64_tr_b16 v[68:69], v6 offset:20576
    ds_read_b64_tr_b16 v[70:71], v6 offset:20832
    ds_read_b64_tr_b16 a[112:113], v6 offset:24576
    ds_read_b64_tr_b16 a[114:115], v6 offset:24832
    ds_read_b64_tr_b16 a[116:117], v6 offset:28672
    ds_read_b64_tr_b16 a[118:119], v6 offset:28928
    ds_read_b64_tr_b16 a[120:121], v6 offset:24608
    ds_read_b64_tr_b16 a[122:123], v6 offset:24864
    ds_read_b64_tr_b16 a[124:125], v6 offset:28704
    ds_read_b64_tr_b16 a[126:127], v6 offset:28960
    ds_read_b64_tr_b16 v[184:185], v6 offset:24640
    ds_read_b64_tr_b16 v[186:187], v6 offset:24896
    ds_read_b64_tr_b16 v[188:189], v6 offset:28736
    ds_read_b64_tr_b16 v[190:191], v6 offset:28992
    ds_read_b64_tr_b16 v[72:73], v6 offset:24672
    ds_read_b64_tr_b16 v[74:75], v6 offset:24928
    ds_read_b64_tr_b16 v[76:77], v6 offset:28768
    ds_read_b64_tr_b16 v[78:79], v6 offset:29024
    s_waitcnt lgkmcnt(0)
    s_add_u32 m0, s84, 16384
    s_mov_b32 s50, 655360
    buffer_load_dwordx4 v2, s[72:75], s50 offen lds
    s_add_u32 m0, m0, 1024
    s_add_u32 s50, s50, 8192
    buffer_load_dwordx4 v2, s[72:75], s50 offen lds
    s_add_u32 m0, m0, 1024
    s_add_u32 s50, s50, 8192
    buffer_load_dwordx4 v2, s[72:75], s50 offen lds
    s_add_u32 m0, m0, 1024
    s_add_u32 s50, s50, 8192
    buffer_load_dwordx4 v2, s[72:75], s50 offen lds
    s_add_u32 m0, m0, 1024
    s_add_u32 s50, s50, 8192
    buffer_load_dwordx4 v2, s[72:75], s50 offen lds
    s_add_u32 m0, m0, 1024
    s_add_u32 s50, s50, 8192
    buffer_load_dwordx4 v2, s[72:75], s50 offen lds
    s_add_u32 m0, m0, 1024
    s_add_u32 s50, s50, 8192
    buffer_load_dwordx4 v2, s[72:75], s50 offen lds
    s_add_u32 m0, m0, 1024
    s_add_u32 s50, s50, 8192
    buffer_load_dwordx4 v2, s[72:75], s50 offen lds
    s_add_u32 m0, m0, 1024
    s_add_u32 s50, s50, 8192
    buffer_load_dwordx4 v2, s[72:75], s50 offen lds
    s_add_u32 m0, m0, 1024
    s_add_u32 s50, s50, 8192
    buffer_load_dwordx4 v2, s[72:75], s50 offen lds
    s_add_u32 m0, m0, 1024
    s_add_u32 s50, s50, 8192
    buffer_load_dwordx4 v2, s[72:75], s50 offen lds
    s_add_u32 m0, m0, 1024
    s_add_u32 s50, s50, 8192
    buffer_load_dwordx4 v2, s[72:75], s50 offen lds
    s_add_u32 m0, m0, 1024
    s_add_u32 s50, s50, 8192
    buffer_load_dwordx4 v2, s[72:75], s50 offen lds
    s_add_u32 m0, m0, 1024
    s_add_u32 s50, s50, 8192
    buffer_load_dwordx4 v2, s[72:75], s50 offen lds
    s_add_u32 m0, m0, 1024
    s_add_u32 s50, s50, 8192
    buffer_load_dwordx4 v2, s[72:75], s50 offen lds
    s_add_u32 m0, m0, 1024
    s_add_u32 s50, s50, 8192
    buffer_load_dwordx4 v2, s[72:75], s50 offen lds
    s_waitcnt vmcnt(16)
    ds_read_b64_tr_b16 a[128:129], v6 offset:0
    ds_read_b64_tr_b16 a[130:131], v6 offset:256
    ds_read_b64_tr_b16 a[132:133], v6 offset:4096
    ds_read_b64_tr_b16 a[134:135], v6 offset:4352
    ds_read_b64_tr_b16 a[136:137], v6 offset:32
    ds_read_b64_tr_b16 a[138:139], v6 offset:288
    ds_read_b64_tr_b16 a[140:141], v6 offset:4128
    ds_read_b64_tr_b16 a[142:143], v6 offset:4384
    ds_read_b64_tr_b16 v[192:193], v6 offset:64
    ds_read_b64_tr_b16 v[194:195], v6 offset:320
    ds_read_b64_tr_b16 v[196:197], v6 offset:4160
    ds_read_b64_tr_b16 v[198:199], v6 offset:4416
    ds_read_b64_tr_b16 v[80:81], v6 offset:96
    ds_read_b64_tr_b16 v[82:83], v6 offset:352
    ds_read_b64_tr_b16 v[84:85], v6 offset:4192
    ds_read_b64_tr_b16 v[86:87], v6 offset:4448
    ds_read_b64_tr_b16 a[144:145], v6 offset:8192
    ds_read_b64_tr_b16 a[146:147], v6 offset:8448
    ds_read_b64_tr_b16 a[148:149], v6 offset:12288
    ds_read_b64_tr_b16 a[150:151], v6 offset:12544
    ds_read_b64_tr_b16 a[152:153], v6 offset:8224
    ds_read_b64_tr_b16 a[154:155], v6 offset:8480
    ds_read_b64_tr_b16 a[156:157], v6 offset:12320
    ds_read_b64_tr_b16 a[158:159], v6 offset:12576
    ds_read_b64_tr_b16 v[200:201], v6 offset:8256
    ds_read_b64_tr_b16 v[202:203], v6 offset:8512
    ds_read_b64_tr_b16 v[204:205], v6 offset:12352
    ds_read_b64_tr_b16 v[206:207], v6 offset:12608
    ds_read_b64_tr_b16 v[88:89], v6 offset:8288
    ds_read_b64_tr_b16 v[90:91], v6 offset:8544
    ds_read_b64_tr_b16 v[92:93], v6 offset:12384
    ds_read_b64_tr_b16 v[94:95], v6 offset:12640
    s_waitcnt lgkmcnt(0)
    s_add_u32 m0, s84, 0
    s_mov_b32 s50, 786432
    buffer_load_dwordx4 v2, s[72:75], s50 offen lds
    s_add_u32 m0, m0, 1024
    s_add_u32 s50, s50, 8192
    buffer_load_dwordx4 v2, s[72:75], s50 offen lds
    s_add_u32 m0, m0, 1024
    s_add_u32 s50, s50, 8192
    buffer_load_dwordx4 v2, s[72:75], s50 offen lds
    s_add_u32 m0, m0, 1024
    s_add_u32 s50, s50, 8192
    buffer_load_dwordx4 v2, s[72:75], s50 offen lds
    s_add_u32 m0, m0, 1024
    s_add_u32 s50, s50, 8192
    buffer_load_dwordx4 v2, s[72:75], s50 offen lds
    s_add_u32 m0, m0, 1024
    s_add_u32 s50, s50, 8192
    buffer_load_dwordx4 v2, s[72:75], s50 offen lds
    s_add_u32 m0, m0, 1024
    s_add_u32 s50, s50, 8192
    buffer_load_dwordx4 v2, s[72:75], s50 offen lds
    s_add_u32 m0, m0, 1024
    s_add_u32 s50, s50, 8192
    buffer_load_dwordx4 v2, s[72:75], s50 offen lds
    s_add_u32 m0, m0, 1024
    s_add_u32 s50, s50, 8192
    buffer_load_dwordx4 v2, s[72:75], s50 offen lds
    s_add_u32 m0, m0, 1024
    s_add_u32 s50, s50, 8192
    buffer_load_dwordx4 v2, s[72:75], s50 offen lds
    s_add_u32 m0, m0, 1024
    s_add_u32 s50, s50, 8192
    buffer_load_dwordx4 v2, s[72:75], s50 offen lds
    s_add_u32 m0, m0, 1024
    s_add_u32 s50, s50, 8192
    buffer_load_dwordx4 v2, s[72:75], s50 offen lds
    s_add_u32 m0, m0, 1024
    s_add_u32 s50, s50, 8192
    buffer_load_dwordx4 v2, s[72:75], s50 offen lds
    s_add_u32 m0, m0, 1024
    s_add_u32 s50, s50, 8192
    buffer_load_dwordx4 v2, s[72:75], s50 offen lds
    s_add_u32 m0, m0, 1024
    s_add_u32 s50, s50, 8192
    buffer_load_dwordx4 v2, s[72:75], s50 offen lds
    s_add_u32 m0, m0, 1024
    s_add_u32 s50, s50, 8192
    buffer_load_dwordx4 v2, s[72:75], s50 offen lds
    s_waitcnt vmcnt(16)
    ds_read_b64_tr_b16 a[160:161], v6 offset:16384
    ds_read_b64_tr_b16 a[162:163], v6 offset:16640
    ds_read_b64_tr_b16 a[164:165], v6 offset:20480
    ds_read_b64_tr_b16 a[166:167], v6 offset:20736
    ds_read_b64_tr_b16 a[168:169], v6 offset:16416
    ds_read_b64_tr_b16 a[170:171], v6 offset:16672
    ds_read_b64_tr_b16 a[172:173], v6 offset:20512
    ds_read_b64_tr_b16 a[174:175], v6 offset:20768
    ds_read_b64_tr_b16 v[208:209], v6 offset:16448
    ds_read_b64_tr_b16 v[210:211], v6 offset:16704
    ds_read_b64_tr_b16 v[212:213], v6 offset:20544
    ds_read_b64_tr_b16 v[214:215], v6 offset:20800
    ds_read_b64_tr_b16 v[96:97], v6 offset:16480
    ds_read_b64_tr_b16 v[98:99], v6 offset:16736
    ds_read_b64_tr_b16 v[100:101], v6 offset:20576
    ds_read_b64_tr_b16 v[102:103], v6 offset:20832
    ds_read_b64_tr_b16 a[176:177], v6 offset:24576
    ds_read_b64_tr_b16 a[178:179], v6 offset:24832
    ds_read_b64_tr_b16 a[180:181], v6 offset:28672
    ds_read_b64_tr_b16 a[182:183], v6 offset:28928
    ds_read_b64_tr_b16 a[184:185], v6 offset:24608
    ds_read_b64_tr_b16 a[186:187], v6 offset:24864
    ds_read_b64_tr_b16 a[188:189], v6 offset:28704
    ds_read_b64_tr_b16 a[190:191], v6 offset:28960
    ds_read_b64_tr_b16 v[216:217], v6 offset:24640
    ds_read_b64_tr_b16 v[218:219], v6 offset:24896
    ds_read_b64_tr_b16 v[220:221], v6 offset:28736
    ds_read_b64_tr_b16 v[222:223], v6 offset:28992
    ds_read_b64_tr_b16 v[104:105], v6 offset:24672
    ds_read_b64_tr_b16 v[106:107], v6 offset:24928
    ds_read_b64_tr_b16 v[108:109], v6 offset:28768
    ds_read_b64_tr_b16 v[110:111], v6 offset:29024
    s_waitcnt lgkmcnt(0)
    s_add_u32 m0, s84, 16384
    s_mov_b32 s50, 917504
    buffer_load_dwordx4 v2, s[72:75], s50 offen lds
    s_add_u32 m0, m0, 1024
    s_add_u32 s50, s50, 8192
    buffer_load_dwordx4 v2, s[72:75], s50 offen lds
    s_add_u32 m0, m0, 1024
    s_add_u32 s50, s50, 8192
    buffer_load_dwordx4 v2, s[72:75], s50 offen lds
    s_add_u32 m0, m0, 1024
    s_add_u32 s50, s50, 8192
    buffer_load_dwordx4 v2, s[72:75], s50 offen lds
    s_add_u32 m0, m0, 1024
    s_add_u32 s50, s50, 8192
    buffer_load_dwordx4 v2, s[72:75], s50 offen lds
    s_add_u32 m0, m0, 1024
    s_add_u32 s50, s50, 8192
    buffer_load_dwordx4 v2, s[72:75], s50 offen lds
    s_add_u32 m0, m0, 1024
    s_add_u32 s50, s50, 8192
    buffer_load_dwordx4 v2, s[72:75], s50 offen lds
    s_add_u32 m0, m0, 1024
    s_add_u32 s50, s50, 8192
    buffer_load_dwordx4 v2, s[72:75], s50 offen lds
    s_add_u32 m0, m0, 1024
    s_add_u32 s50, s50, 8192
    buffer_load_dwordx4 v2, s[72:75], s50 offen lds
    s_add_u32 m0, m0, 1024
    s_add_u32 s50, s50, 8192
    buffer_load_dwordx4 v2, s[72:75], s50 offen lds
    s_add_u32 m0, m0, 1024
    s_add_u32 s50, s50, 8192
    buffer_load_dwordx4 v2, s[72:75], s50 offen lds
    s_add_u32 m0, m0, 1024
    s_add_u32 s50, s50, 8192
    buffer_load_dwordx4 v2, s[72:75], s50 offen lds
    s_add_u32 m0, m0, 1024
    s_add_u32 s50, s50, 8192
    buffer_load_dwordx4 v2, s[72:75], s50 offen lds
    s_add_u32 m0, m0, 1024
    s_add_u32 s50, s50, 8192
    buffer_load_dwordx4 v2, s[72:75], s50 offen lds
    s_add_u32 m0, m0, 1024
    s_add_u32 s50, s50, 8192
    buffer_load_dwordx4 v2, s[72:75], s50 offen lds
    s_add_u32 m0, m0, 1024
    s_add_u32 s50, s50, 8192
    buffer_load_dwordx4 v2, s[72:75], s50 offen lds
    s_waitcnt vmcnt(16)
    ds_read_b64_tr_b16 a[192:193], v6 offset:0
    ds_read_b64_tr_b16 a[194:195], v6 offset:256
    ds_read_b64_tr_b16 a[196:197], v6 offset:4096
    ds_read_b64_tr_b16 a[198:199], v6 offset:4352
    ds_read_b64_tr_b16 a[200:201], v6 offset:32
    ds_read_b64_tr_b16 a[202:203], v6 offset:288
    ds_read_b64_tr_b16 a[204:205], v6 offset:4128
    ds_read_b64_tr_b16 a[206:207], v6 offset:4384
    ds_read_b64_tr_b16 v[224:225], v6 offset:64
    ds_read_b64_tr_b16 v[226:227], v6 offset:320
    ds_read_b64_tr_b16 v[228:229], v6 offset:4160
    ds_read_b64_tr_b16 v[230:231], v6 offset:4416
    ds_read_b64_tr_b16 v[112:113], v6 offset:96
    ds_read_b64_tr_b16 v[114:115], v6 offset:352
    ds_read_b64_tr_b16 v[116:117], v6 offset:4192
    ds_read_b64_tr_b16 v[118:119], v6 offset:4448
    ds_read_b64_tr_b16 a[208:209], v6 offset:8192
    ds_read_b64_tr_b16 a[210:211], v6 offset:8448
    ds_read_b64_tr_b16 a[212:213], v6 offset:12288
    ds_read_b64_tr_b16 a[214:215], v6 offset:12544
    ds_read_b64_tr_b16 a[216:217], v6 offset:8224
    ds_read_b64_tr_b16 a[218:219], v6 offset:8480
    ds_read_b64_tr_b16 a[220:221], v6 offset:12320
    ds_read_b64_tr_b16 a[222:223], v6 offset:12576
    ds_read_b64_tr_b16 v[232:233], v6 offset:8256
    ds_read_b64_tr_b16 v[234:235], v6 offset:8512
    ds_read_b64_tr_b16 v[236:237], v6 offset:12352
    ds_read_b64_tr_b16 v[238:239], v6 offset:12608
    ds_read_b64_tr_b16 v[120:121], v6 offset:8288
    ds_read_b64_tr_b16 v[122:123], v6 offset:8544
    ds_read_b64_tr_b16 v[124:125], v6 offset:12384
    ds_read_b64_tr_b16 v[126:127], v6 offset:12640
    s_waitcnt lgkmcnt(0)
    s_waitcnt vmcnt(0)
    ds_write_b128 v12, v[16:19] offset:0
    ds_write_b128 v12, v[20:23] offset:1024
    ds_write_b128 v12, v[24:27] offset:2048
    ds_write_b128 v12, v[28:31] offset:3072
    ds_write_b128 v12, v[32:35] offset:4096
    ds_write_b128 v12, v[36:39] offset:5120
    ds_write_b128 v12, v[40:43] offset:6144
    ds_write_b128 v12, v[44:47] offset:7168
    ds_write_b128 v12, v[48:51] offset:8192
    ds_write_b128 v12, v[52:55] offset:9216
    ds_write_b128 v12, v[56:59] offset:10240
    ds_write_b128 v12, v[60:63] offset:11264
    ds_write_b128 v12, v[64:67] offset:12288
    ds_write_b128 v12, v[68:71] offset:13312
    ds_write_b128 v12, v[72:75] offset:14336
    ds_write_b128 v12, v[76:79] offset:15360
    s_waitcnt lgkmcnt(0)
    ds_read_b64_tr_b16 a[224:225], v6 offset:16384
    ds_read_b64_tr_b16 a[226:227], v6 offset:16640
    ds_read_b64_tr_b16 a[228:229], v6 offset:20480
    ds_read_b64_tr_b16 a[230:231], v6 offset:20736
    ds_read_b64_tr_b16 a[232:233], v6 offset:16416
    ds_read_b64_tr_b16 a[234:235], v6 offset:16672
    ds_read_b64_tr_b16 a[236:237], v6 offset:20512
    ds_read_b64_tr_b16 a[238:239], v6 offset:20768
    ds_read_b64_tr_b16 v[240:241], v6 offset:16448
    ds_read_b64_tr_b16 v[242:243], v6 offset:16704
    ds_read_b64_tr_b16 v[244:245], v6 offset:20544
    ds_read_b64_tr_b16 v[246:247], v6 offset:20800
    ds_read_b64_tr_b16 v[16:17], v6 offset:16480
    ds_read_b64_tr_b16 v[18:19], v6 offset:16736
    ds_read_b64_tr_b16 v[20:21], v6 offset:20576
    ds_read_b64_tr_b16 v[22:23], v6 offset:20832
    ds_read_b64_tr_b16 a[240:241], v6 offset:24576
    ds_read_b64_tr_b16 a[242:243], v6 offset:24832
    ds_read_b64_tr_b16 a[244:245], v6 offset:28672
    ds_read_b64_tr_b16 a[246:247], v6 offset:28928
    ds_read_b64_tr_b16 a[248:249], v6 offset:24608
    ds_read_b64_tr_b16 a[250:251], v6 offset:24864
    ds_read_b64_tr_b16 a[252:253], v6 offset:28704
    ds_read_b64_tr_b16 a[254:255], v6 offset:28960
    ds_read_b64_tr_b16 v[248:249], v6 offset:24640
    ds_read_b64_tr_b16 v[250:251], v6 offset:24896
    ds_read_b64_tr_b16 v[252:253], v6 offset:28736
    ds_read_b64_tr_b16 v[254:255], v6 offset:28992
    ds_read_b64_tr_b16 v[24:25], v6 offset:24672
    ds_read_b64_tr_b16 v[26:27], v6 offset:24928
    ds_read_b64_tr_b16 v[28:29], v6 offset:28768
    ds_read_b64_tr_b16 v[30:31], v6 offset:29024
    s_waitcnt lgkmcnt(0)
    ds_write_b128 v12, v[80:83] offset:16384
    ds_write_b128 v12, v[84:87] offset:17408
    ds_write_b128 v12, v[88:91] offset:18432
    ds_write_b128 v12, v[92:95] offset:19456
    ds_write_b128 v12, v[96:99] offset:20480
    ds_write_b128 v12, v[100:103] offset:21504
    ds_write_b128 v12, v[104:107] offset:22528
    ds_write_b128 v12, v[108:111] offset:23552
    ds_write_b128 v12, v[112:115] offset:24576
    ds_write_b128 v12, v[116:119] offset:25600
    ds_write_b128 v12, v[120:123] offset:26624
    ds_write_b128 v12, v[124:127] offset:27648
    ds_write_b128 v12, v[16:19] offset:28672
    ds_write_b128 v12, v[20:23] offset:29696
    ds_write_b128 v12, v[24:27] offset:30720
    ds_write_b128 v12, v[28:31] offset:31744
    s_waitcnt lgkmcnt(0)
    v_add_u32 v2, 0, v1
    v_add_u32 v3, 4096, v1
    v_add_u32 v4, 8192, v1
    v_add_u32 v5, 12288, v1
    v_and_b32 v7, 7, v0
    v_lshlrev_b32 v7, 2, v7
    s_lshl_b32 s14, s3, 12
    s_add_u32 s14, s14, 131072
    v_add_u32 v8, s14, v1
    s_lshl_b32 s14, s3, 10
    s_add_u32 s14, s14, 131072
    v_add_u32 v9, s14, v1
    v_bfe_u32 v16, v0, 4, 1
    v_lshrrev_b32 v17, 5, v0
    v_lshlrev_b32 v16, 13, v16
    v_lshl_add_u32 v16, v17, 12, v16
    v_and_b32 v17, 15, v0
    v_lshl_add_u32 v10, v17, 1, v16
    v_and_b32 v16, 8, v0
    v_cmp_eq_u32 vcc, 0, v16
    v_mov_b32 v16, 0x4444
    v_mov_b32 v17, 0xeeee
    v_cndmask_b32 v6, v17, v16, vcc
    s_mov_b32 s16, 0
    s_lshl_b32 s17, s8, 24
    s_lshl_b32 s14, s10, 16
    s_add_u32 s17, s17, s14
    s_lshl_b32 s14, s3, 14
    s_add_u32 s17, s17, s14
    s_add_u32 s17, s17, 73400320
    s_lshl_b32 s14, s8, 10
    s_lshl_b32 s15, s3, 7
    s_add_u32 s18, s14, s15
    s_add_u32 s18, s18, 933888
    s_lshl_b32 s20, s10, 14
    s_add_u32 s20, s20, s14
    s_lshl_b32 s15, s11, 7
    s_add_u32 s20, s20, s15
    s_lshl_b32 s15, s3, 5
    s_add_u32 s20, s20, s15
    s_lshl_b32 s14, s11, 11
    v_lshl_add_u32 v0, v0, 5, s14
    s_mov_b32 s22, 0x40000000
    v_xor_b32 v9, 0x4000, v9
    ds_read_b128 v[96:99], v12 offset:0
    ds_read_b128 v[100:103], v12 offset:1024
    ds_read_b128 v[104:107], v12 offset:2048
    ds_read_b128 v[108:111], v12 offset:3072
    v_mov_b64 v[16:17], 0
    v_mov_b64 v[18:19], 0
    v_mov_b64 v[20:21], 0
    v_mov_b64 v[22:23], 0
    v_mov_b64 v[24:25], 0
    v_mov_b64 v[26:27], 0
    v_mov_b64 v[28:29], 0
    v_mov_b64 v[30:31], 0
L_orefill:
    s_add_u32 s21, s16, 0
    s_and_b32 s14, s21, 1
    s_lshr_b32 s21, s21, 1
    s_lshl_b32 s14, s14, 9
    s_add_u32 s14, s14, s18
    s_mov_b32 s13, 0
L_ospin0:
    buffer_load_dword v11, v7, s[52:55], s14 offen sc1
    s_waitcnt vmcnt(0)
    v_cmp_lt_i32 vcc, s21, v11
    s_nop 0
    s_cmp_eq_u64 vcc, -1
    s_cbranch_scc1 L_ospin0_ok
    s_add_u32 s13, s13, 1
    s_cmp_lt_u32 s13, 1048576
    s_cbranch_scc1 L_ospin0
    s_branch L_end
L_ospin0_ok:
    s_xor_b32 s14, s14, 512
    buffer_load_dwordx4 v[32:35], v2, s[52:55], s17 offen offset:0 sc1
    buffer_load_dwordx4 v[36:39], v2, s[52:55], s17 offen offset:1024 sc1
    buffer_load_dwordx4 v[40:43], v2, s[52:55], s17 offen offset:2048 sc1
    buffer_load_dwordx4 v[44:47], v2, s[52:55], s17 offen offset:3072 sc1
    buffer_load_dwordx4 v[48:51], v3, s[52:55], s17 offen offset:0 sc1
    buffer_load_dwordx4 v[52:55], v3, s[52:55], s17 offen offset:1024 sc1
    buffer_load_dwordx4 v[56:59], v3, s[52:55], s17 offen offset:2048 sc1
    buffer_load_dwordx4 v[60:63], v3, s[52:55], s17 offen offset:3072 sc1
    buffer_load_dwordx4 v[64:67], v4, s[52:55], s17 offen offset:0 sc1
    buffer_load_dwordx4 v[68:71], v4, s[52:55], s17 offen offset:1024 sc1
    buffer_load_dword v13, v7, s[52:55], s14 offen sc1
    buffer_load_dword v13, v7, s[52:55], s14 offen sc1
    buffer_load_dwordx4 v[72:75], v4, s[52:55], s17 offen offset:2048 sc1
    buffer_load_dwordx4 v[76:79], v4, s[52:55], s17 offen offset:3072 sc1
    buffer_load_dwordx4 v[80:83], v5, s[52:55], s17 offen offset:0 sc1
    buffer_load_dwordx4 v[84:87], v5, s[52:55], s17 offen offset:1024 sc1
    buffer_load_dwordx4 v[88:91], v5, s[52:55], s17 offen offset:2048 sc1
    buffer_load_dword v11, v7, s[52:55], s14 offen sc1
    buffer_load_dwordx4 v[92:95], v5, s[52:55], s17 offen offset:3072 sc1
L_oseg:
    s_add_u32 s21, s16, 1
    s_and_b32 s14, s21, 1
    s_lshr_b32 s21, s21, 1
    s_lshl_b32 s14, s14, 9
    s_add_u32 s14, s14, s18
    s_add_u32 s17, s17, 262144
    s_xor_b32 s14, s14, 512
    s_cmp_ge_u32 s16, 59
    s_cbranch_scc1 L_ostream
    s_waitcnt vmcnt(1)
    v_cmp_lt_i32 vcc, s21, v11
    s_nop 0
    s_cmp_eq_u64 vcc, -1
    s_cbranch_scc0 L_odrain
L_ostream:
    s_waitcnt vmcnt(18)
    s_waitcnt lgkmcnt(2)
    v_smfmac_f32_16x16x64_bf16 v[28:31], v[32:35], v[96:103], v6
    s_waitcnt lgkmcnt(4)
    s_barrier
    ds_read_b128 v[96:99], v12 offset:4096
    v_smfmac_f32_16x16x64_bf16 v[16:19], v[32:35], a[0:7], v6
    ds_read_b128 v[100:103], v12 offset:5120
    v_smfmac_f32_16x16x64_bf16 v[20:23], v[32:35], a[8:15], v6
    ds_read_b128 v[112:115], v9 offset:0
    ds_read_b128 v[116:119], v9 offset:4096
    s_waitcnt lgkmcnt(4)
    v_smfmac_f32_16x16x64_bf16 v[24:27], v[32:35], v[128:135], v6
    buffer_load_dwordx4 v[32:35], v2, s[52:55], s17 offen offset:0 sc1
    s_waitcnt vmcnt(18)
    v_smfmac_f32_16x16x64_bf16 v[28:31], v[36:39], v[104:111], v6
    ds_read_b128 v[104:107], v12 offset:6144
    v_smfmac_f32_16x16x64_bf16 v[16:19], v[36:39], a[16:23], v6
    ds_read_b128 v[108:111], v12 offset:7168
    v_smfmac_f32_16x16x64_bf16 v[20:23], v[36:39], a[24:31], v6
    ds_read_b128 v[120:123], v9 offset:8192
    ds_read_b128 v[124:127], v9 offset:12288
    s_waitcnt lgkmcnt(6)
    v_smfmac_f32_16x16x64_bf16 v[24:27], v[36:39], v[136:143], v6
    buffer_load_dwordx4 v[36:39], v2, s[52:55], s17 offen offset:1024 sc1
    s_waitcnt vmcnt(18)
    v_smfmac_f32_16x16x64_bf16 v[28:31], v[40:43], v[96:103], v6
    ds_read_b128 v[96:99], v12 offset:8192
    v_smfmac_f32_16x16x64_bf16 v[16:19], v[40:43], a[32:39], v6
    ds_read_b128 v[100:103], v12 offset:9216
    v_smfmac_f32_16x16x64_bf16 v[20:23], v[40:43], a[40:47], v6
    s_waitcnt lgkmcnt(4)
    v_smfmac_f32_16x16x64_bf16 v[24:27], v[40:43], v[144:151], v6
    buffer_load_dwordx4 v[40:43], v2, s[52:55], s17 offen offset:2048 sc1
    s_waitcnt vmcnt(18)
    v_smfmac_f32_16x16x64_bf16 v[28:31], v[44:47], v[104:111], v6
    s_waitcnt lgkmcnt(2)
    ds_read_b128 v[104:107], v12 offset:10240
    v_add_f32 v112, v112, v116
    v_smfmac_f32_16x16x64_bf16 v[16:19], v[44:47], a[48:55], v6
    ds_read_b128 v[108:111], v12 offset:11264
    v_add_f32 v113, v113, v117
    v_smfmac_f32_16x16x64_bf16 v[20:23], v[44:47], a[56:63], v6
    s_waitcnt lgkmcnt(2)
    v_add_f32 v114, v114, v118
    v_smfmac_f32_16x16x64_bf16 v[24:27], v[44:47], v[152:159], v6
    buffer_load_dwordx4 v[44:47], v2, s[52:55], s17 offen offset:3072 sc1
    s_waitcnt vmcnt(18)
    v_smfmac_f32_16x16x64_bf16 v[28:31], v[48:51], v[96:103], v6
    ds_read_b128 v[96:99], v12 offset:12288
    v_add_f32 v115, v115, v119
    v_smfmac_f32_16x16x64_bf16 v[16:19], v[48:51], a[64:71], v6
    ds_read_b128 v[100:103], v12 offset:13312
    v_add_f32 v120, v120, v124
    v_smfmac_f32_16x16x64_bf16 v[20:23], v[48:51], a[72:79], v6
    s_waitcnt lgkmcnt(2)
    v_add_f32 v121, v121, v125
    v_smfmac_f32_16x16x64_bf16 v[24:27], v[48:51], v[160:167], v6
    buffer_load_dwordx4 v[48:51], v3, s[52:55], s17 offen offset:0 sc1
    s_waitcnt vmcnt(18)
    v_smfmac_f32_16x16x64_bf16 v[28:31], v[52:55], v[104:111], v6
    ds_read_b128 v[104:107], v12 offset:14336
    v_add_f32 v122, v122, v126
    v_smfmac_f32_16x16x64_bf16 v[16:19], v[52:55], a[80:87], v6
    ds_read_b128 v[108:111], v12 offset:15360
    v_add_f32 v123, v123, v127
    v_smfmac_f32_16x16x64_bf16 v[20:23], v[52:55], a[88:95], v6
    s_waitcnt lgkmcnt(2)
    v_add_f32 v112, v112, v120
    v_smfmac_f32_16x16x64_bf16 v[24:27], v[52:55], v[168:175], v6
    buffer_load_dwordx4 v[52:55], v3, s[52:55], s17 offen offset:1024 sc1
    s_waitcnt vmcnt(18)
    v_smfmac_f32_16x16x64_bf16 v[28:31], v[56:59], v[96:103], v6
    ds_read_b128 v[96:99], v12 offset:16384
    v_add_f32 v113, v113, v121
    v_smfmac_f32_16x16x64_bf16 v[16:19], v[56:59], a[96:103], v6
    ds_read_b128 v[100:103], v12 offset:17408
    v_add_f32 v114, v114, v122
    v_smfmac_f32_16x16x64_bf16 v[20:23], v[56:59], a[104:111], v6
    s_waitcnt lgkmcnt(2)
    v_add_f32 v115, v115, v123
    v_smfmac_f32_16x16x64_bf16 v[24:27], v[56:59], v[176:183], v6
    buffer_load_dwordx4 v[56:59], v3, s[52:55], s17 offen offset:2048 sc1
    s_waitcnt vmcnt(18)
    v_smfmac_f32_16x16x64_bf16 v[28:31], v[60:63], v[104:111], v6
    ds_read_b128 v[104:107], v12 offset:18432
    v_permlane32_swap_b32 v112, v114
    v_smfmac_f32_16x16x64_bf16 v[16:19], v[60:63], a[112:119], v6
    ds_read_b128 v[108:111], v12 offset:19456
    v_permlane32_swap_b32 v113, v115
    v_smfmac_f32_16x16x64_bf16 v[20:23], v[60:63], a[120:127], v6
    s_waitcnt lgkmcnt(2)
    v_add_f32 v112, v112, v114
    v_smfmac_f32_16x16x64_bf16 v[24:27], v[60:63], v[184:191], v6
    buffer_load_dwordx4 v[60:63], v3, s[52:55], s17 offen offset:3072 sc1
    s_waitcnt vmcnt(18)
    v_smfmac_f32_16x16x64_bf16 v[28:31], v[64:67], v[96:103], v6
    ds_read_b128 v[96:99], v12 offset:20480
    v_add_f32 v113, v113, v115
    v_smfmac_f32_16x16x64_bf16 v[16:19], v[64:67], a[128:135], v6
    ds_read_b128 v[100:103], v12 offset:21504
    v_cvt_pk_bf16_f32 v116, v112, v113
    v_smfmac_f32_16x16x64_bf16 v[20:23], v[64:67], a[136:143], v6
    s_waitcnt lgkmcnt(2)
    v_xor_b32 v9, 0x4000, v9
    v_smfmac_f32_16x16x64_bf16 v[24:27], v[64:67], v[192:199], v6
    buffer_load_dwordx4 v[64:67], v4, s[52:55], s17 offen offset:0 sc1
    s_waitcnt vmcnt(18)
    v_smfmac_f32_16x16x64_bf16 v[28:31], v[68:71], v[104:111], v6
    ds_read_b128 v[104:107], v12 offset:22528
    v_smfmac_f32_16x16x64_bf16 v[16:19], v[68:71], a[144:151], v6
    ds_read_b128 v[108:111], v12 offset:23552
    v_smfmac_f32_16x16x64_bf16 v[20:23], v[68:71], a[152:159], v6
    s_waitcnt lgkmcnt(2)
    v_smfmac_f32_16x16x64_bf16 v[24:27], v[68:71], v[200:207], v6
    buffer_load_dwordx4 v[68:71], v4, s[52:55], s17 offen offset:1024 sc1
    buffer_store_short v116, v10, s[80:83], s22 offen
    buffer_store_short_d16_hi v116, v10, s[80:83], s22 offen offset:2048
    s_mov_b32 s22, s20
    s_add_u32 s20, s20, 65536
    s_waitcnt vmcnt(18)
    v_smfmac_f32_16x16x64_bf16 v[28:31], v[72:75], v[96:103], v6
    ds_read_b128 v[96:99], v12 offset:24576
    v_smfmac_f32_16x16x64_bf16 v[16:19], v[72:75], a[160:167], v6
    ds_read_b128 v[100:103], v12 offset:25600
    v_smfmac_f32_16x16x64_bf16 v[20:23], v[72:75], a[168:175], v6
    s_waitcnt lgkmcnt(2)
    v_smfmac_f32_16x16x64_bf16 v[24:27], v[72:75], v[208:215], v6
    buffer_load_dwordx4 v[72:75], v4, s[52:55], s17 offen offset:2048 sc1
    s_waitcnt vmcnt(18)
    v_smfmac_f32_16x16x64_bf16 v[28:31], v[76:79], v[104:111], v6
    ds_read_b128 v[104:107], v12 offset:26624
    v_smfmac_f32_16x16x64_bf16 v[16:19], v[76:79], a[176:183], v6
    ds_read_b128 v[108:111], v12 offset:27648
    v_smfmac_f32_16x16x64_bf16 v[20:23], v[76:79], a[184:191], v6
    s_waitcnt lgkmcnt(2)
    v_smfmac_f32_16x16x64_bf16 v[24:27], v[76:79], v[216:223], v6
    buffer_load_dwordx4 v[76:79], v4, s[52:55], s17 offen offset:3072 sc1
    s_waitcnt vmcnt(18)
    v_smfmac_f32_16x16x64_bf16 v[28:31], v[80:83], v[96:103], v6
    ds_read_b128 v[96:99], v12 offset:28672
    v_smfmac_f32_16x16x64_bf16 v[16:19], v[80:83], a[192:199], v6
    ds_read_b128 v[100:103], v12 offset:29696
    v_smfmac_f32_16x16x64_bf16 v[20:23], v[80:83], a[200:207], v6
    s_waitcnt lgkmcnt(2)
    v_smfmac_f32_16x16x64_bf16 v[24:27], v[80:83], v[224:231], v6
    buffer_load_dwordx4 v[80:83], v5, s[52:55], s17 offen offset:0 sc1
    s_waitcnt vmcnt(18)
    v_smfmac_f32_16x16x64_bf16 v[28:31], v[84:87], v[104:111], v6
    ds_read_b128 v[104:107], v12 offset:30720
    v_smfmac_f32_16x16x64_bf16 v[16:19], v[84:87], a[208:215], v6
    ds_read_b128 v[108:111], v12 offset:31744
    v_smfmac_f32_16x16x64_bf16 v[20:23], v[84:87], a[216:223], v6
    s_waitcnt lgkmcnt(2)
    v_smfmac_f32_16x16x64_bf16 v[24:27], v[84:87], v[232:239], v6
    buffer_load_dwordx4 v[84:87], v5, s[52:55], s17 offen offset:1024 sc1
    s_waitcnt vmcnt(18)
    v_smfmac_f32_16x16x64_bf16 v[28:31], v[88:91], v[96:103], v6
    v_smfmac_f32_16x16x64_bf16 v[16:19], v[88:91], a[224:231], v6
    v_smfmac_f32_16x16x64_bf16 v[20:23], v[88:91], a[232:239], v6
    s_waitcnt lgkmcnt(0)
    v_smfmac_f32_16x16x64_bf16 v[24:27], v[88:91], v[240:247], v6
    buffer_load_dwordx4 v[88:91], v5, s[52:55], s17 offen offset:2048 sc1
    buffer_load_dword v11, v7, s[52:55], s14 offen sc1
    s_waitcnt vmcnt(18)
    v_smfmac_f32_16x16x64_bf16 v[28:31], v[92:95], v[104:111], v6
    v_smfmac_f32_16x16x64_bf16 v[16:19], v[92:95], a[240:247], v6
    v_smfmac_f32_16x16x64_bf16 v[20:23], v[92:95], a[248:255], v6
    v_smfmac_f32_16x16x64_bf16 v[24:27], v[92:95], v[248:255], v6
    buffer_load_dwordx4 v[92:95], v5, s[52:55], s17 offen offset:3072 sc1
    ds_write_b128 v8, v[16:19] offset:0
    s_nop 1
    ds_write_b128 v8, v[20:23] offset:1024
    s_nop 2
    ds_write_b128 v8, v[24:27] offset:2048
    ds_write_b128 v8, v[28:31] offset:3072
    ds_read_b128 v[96:99], v12 offset:0
    ds_read_b128 v[100:103], v12 offset:1024
    ds_read_b128 v[104:107], v12 offset:2048
    ds_read_b128 v[108:111], v12 offset:3072
    v_mov_b64 v[16:17], 0
    v_mov_b64 v[18:19], 0
    v_mov_b64 v[20:21], 0
    v_mov_b64 v[22:23], 0
    v_mov_b64 v[24:25], 0
    v_mov_b64 v[26:27], 0
    v_mov_b64 v[28:29], 0
    v_mov_b64 v[30:31], 0
    v_xor_b32 v8, 0x4000, v8
    s_add_u32 s16, s16, 1
    s_cmp_lt_u32 s16, 60
    s_cbranch_scc1 L_oseg
    s_branch L_onext
L_oval:
    s_mov_b32 s23, 0
    s_waitcnt vmcnt(18)
    v_max3_u32 v14, v32, v33, v34
    v_max_u32 v14, v14, v35
    v_cmp_eq_u32 vcc, -1, v14
    s_cbranch_vccnz L_opoll
    s_mov_b32 s24, s17
    s_add_u32 s17, s17, 262144
    s_cmp_eq_u32 s16, 63
    s_cselect_b32 s17, 0x40000000, s17
    s_waitcnt vmcnt(18)
    s_waitcnt lgkmcnt(2)
    v_smfmac_f32_16x16x64_bf16 v[28:31], v[32:35], v[96:103], v6
    s_waitcnt lgkmcnt(4)
    s_barrier
    ds_read_b128 v[96:99], v12 offset:4096
    v_smfmac_f32_16x16x64_bf16 v[16:19], v[32:35], a[0:7], v6
    ds_read_b128 v[100:103], v12 offset:5120
    v_smfmac_f32_16x16x64_bf16 v[20:23], v[32:35], a[8:15], v6
    ds_read_b128 v[112:115], v9 offset:0
    ds_read_b128 v[116:119], v9 offset:4096
    s_waitcnt lgkmcnt(4)
    v_smfmac_f32_16x16x64_bf16 v[24:27], v[32:35], v[128:135], v6
    buffer_load_dwordx4 v[32:35], v2, s[52:55], s17 offen offset:0 sc1
    s_waitcnt vmcnt(18)
    v_smfmac_f32_16x16x64_bf16 v[28:31], v[36:39], v[104:111], v6
    ds_read_b128 v[104:107], v12 offset:6144
    v_smfmac_f32_16x16x64_bf16 v[16:19], v[36:39], a[16:23], v6
    ds_read_b128 v[108:111], v12 offset:7168
    v_max3_u32 v14, v14, v36, v37
    v_smfmac_f32_16x16x64_bf16 v[20:23], v[36:39], a[24:31], v6
    ds_read_b128 v[120:123], v9 offset:8192
    ds_read_b128 v[124:127], v9 offset:12288
    s_waitcnt lgkmcnt(6)
    v_max3_u32 v14, v14, v38, v39
    v_smfmac_f32_16x16x64_bf16 v[24:27], v[36:39], v[136:143], v6
    buffer_load_dwordx4 v[36:39], v2, s[52:55], s17 offen offset:1024 sc1
    s_waitcnt vmcnt(18)
    v_smfmac_f32_16x16x64_bf16 v[28:31], v[40:43], v[96:103], v6
    ds_read_b128 v[96:99], v12 offset:8192
    v_smfmac_f32_16x16x64_bf16 v[16:19], v[40:43], a[32:39], v6
    ds_read_b128 v[100:103], v12 offset:9216
    v_max3_u32 v14, v14, v40, v41
    v_smfmac_f32_16x16x64_bf16 v[20:23], v[40:43], a[40:47], v6
    s_waitcnt lgkmcnt(4)
    v_max3_u32 v14, v14, v42, v43
    v_smfmac_f32_16x16x64_bf16 v[24:27], v[40:43], v[144:151], v6
    buffer_load_dwordx4 v[40:43], v2, s[52:55], s17 offen offset:2048 sc1
    s_waitcnt vmcnt(18)
    v_smfmac_f32_16x16x64_bf16 v[28:31], v[44:47], v[104:111], v6
    s_waitcnt lgkmcnt(2)
    ds_read_b128 v[104:107], v12 offset:10240
    v_add_f32 v112, v112, v116
    v_smfmac_f32_16x16x64_bf16 v[16:19], v[44:47], a[48:55], v6
    ds_read_b128 v[108:111], v12 offset:11264
    v_add_f32 v113, v113, v117
    v_max3_u32 v14, v14, v44, v45
    v_smfmac_f32_16x16x64_bf16 v[20:23], v[44:47], a[56:63], v6
    s_waitcnt lgkmcnt(2)
    v_add_f32 v114, v114, v118
    v_max3_u32 v14, v14, v46, v47
    v_smfmac_f32_16x16x64_bf16 v[24:27], v[44:47], v[152:159], v6
    buffer_load_dwordx4 v[44:47], v2, s[52:55], s17 offen offset:3072 sc1
    s_waitcnt vmcnt(18)
    v_smfmac_f32_16x16x64_bf16 v[28:31], v[48:51], v[96:103], v6
    ds_read_b128 v[96:99], v12 offset:12288
    v_add_f32 v115, v115, v119
    v_smfmac_f32_16x16x64_bf16 v[16:19], v[48:51], a[64:71], v6
    ds_read_b128 v[100:103], v12 offset:13312
    v_add_f32 v120, v120, v124
    v_max3_u32 v14, v14, v48, v49
    v_smfmac_f32_16x16x64_bf16 v[20:23], v[48:51], a[72:79], v6
    s_waitcnt lgkmcnt(2)
    v_add_f32 v121, v121, v125
    v_max3_u32 v14, v14, v50, v51
    v_smfmac_f32_16x16x64_bf16 v[24:27], v[48:51], v[160:167], v6
    buffer_load_dwordx4 v[48:51], v3, s[52:55], s17 offen offset:0 sc1
    s_waitcnt vmcnt(18)
    v_smfmac_f32_16x16x64_bf16 v[28:31], v[52:55], v[104:111], v6
    ds_read_b128 v[104:107], v12 offset:14336
    v_add_f32 v122, v122, v126
    v_smfmac_f32_16x16x64_bf16 v[16:19], v[52:55], a[80:87], v6
    ds_read_b128 v[108:111], v12 offset:15360
    v_add_f32 v123, v123, v127
    v_max3_u32 v14, v14, v52, v53
    v_smfmac_f32_16x16x64_bf16 v[20:23], v[52:55], a[88:95], v6
    s_waitcnt lgkmcnt(2)
    v_add_f32 v112, v112, v120
    v_max3_u32 v14, v14, v54, v55
    v_smfmac_f32_16x16x64_bf16 v[24:27], v[52:55], v[168:175], v6
    buffer_load_dwordx4 v[52:55], v3, s[52:55], s17 offen offset:1024 sc1
    s_waitcnt vmcnt(18)
    v_smfmac_f32_16x16x64_bf16 v[28:31], v[56:59], v[96:103], v6
    ds_read_b128 v[96:99], v12 offset:16384
    v_add_f32 v113, v113, v121
    v_smfmac_f32_16x16x64_bf16 v[16:19], v[56:59], a[96:103], v6
    ds_read_b128 v[100:103], v12 offset:17408
    v_add_f32 v114, v114, v122
    v_max3_u32 v14, v14, v56, v57
    v_smfmac_f32_16x16x64_bf16 v[20:23], v[56:59], a[104:111], v6
    s_waitcnt lgkmcnt(2)
    v_add_f32 v115, v115, v123
    v_max3_u32 v14, v14, v58, v59
    v_smfmac_f32_16x16x64_bf16 v[24:27], v[56:59], v[176:183], v6
    buffer_load_dwordx4 v[56:59], v3, s[52:55], s17 offen offset:2048 sc1
    s_waitcnt vmcnt(18)
    v_smfmac_f32_16x16x64_bf16 v[28:31], v[60:63], v[104:111], v6
    ds_read_b128 v[104:107], v12 offset:18432
    v_permlane32_swap_b32 v112, v114
    v_smfmac_f32_16x16x64_bf16 v[16:19], v[60:63], a[112:119], v6
    ds_read_b128 v[108:111], v12 offset:19456
    v_permlane32_swap_b32 v113, v115
    v_max3_u32 v14, v14, v60, v61
    v_smfmac_f32_16x16x64_bf16 v[20:23], v[60:63], a[120:127], v6
    s_waitcnt lgkmcnt(2)
    v_add_f32 v112, v112, v114
    v_max3_u32 v14, v14, v62, v63
    v_smfmac_f32_16x16x64_bf16 v[24:27], v[60:63], v[184:191], v6
    buffer_load_dwordx4 v[60:63], v3, s[52:55], s17 offen offset:3072 sc1
    s_waitcnt vmcnt(18)
    v_smfmac_f32_16x16x64_bf16 v[28:31], v[64:67], v[96:103], v6
    ds_read_b128 v[96:99], v12 offset:20480
    v_add_f32 v113, v113, v115
    v_smfmac_f32_16x16x64_bf16 v[16:19], v[64:67], a[128:135], v6
    ds_read_b128 v[100:103], v12 offset:21504
    v_cvt_pk_bf16_f32 v116, v112, v113
    v_max3_u32 v14, v14, v64, v65
    v_smfmac_f32_16x16x64_bf16 v[20:23], v[64:67], a[136:143], v6
    s_waitcnt lgkmcnt(2)
    v_xor_b32 v9, 0x4000, v9
    v_max3_u32 v14, v14, v66, v67
    v_smfmac_f32_16x16x64_bf16 v[24:27], v[64:67], v[192:199], v6
    buffer_load_dwordx4 v[64:67], v4, s[52:55], s17 offen offset:0 sc1
    s_waitcnt vmcnt(18)
    v_smfmac_f32_16x16x64_bf16 v[28:31], v[68:71], v[104:111], v6
    ds_read_b128 v[104:107], v12 offset:22528
    v_smfmac_f32_16x16x64_bf16 v[16:19], v[68:71], a[144:151], v6
    ds_read_b128 v[108:111], v12 offset:23552
    v_max3_u32 v14, v14, v68, v69
    v_smfmac_f32_16x16x64_bf16 v[20:23], v[68:71], a[152:159], v6
    s_waitcnt lgkmcnt(2)
    v_max3_u32 v14, v14, v70, v71
    v_smfmac_f32_16x16x64_bf16 v[24:27], v[68:71], v[200:207], v6
    buffer_load_dwordx4 v[68:71], v4, s[52:55], s17 offen offset:1024 sc1
    buffer_store_short v116, v10, s[80:83], s22 offen
    buffer_store_short_d16_hi v116, v10, s[80:83], s22 offen offset:2048
    s_mov_b32 s22, s20
    s_add_u32 s20, s20, 65536
    s_waitcnt vmcnt(18)
    v_smfmac_f32_16x16x64_bf16 v[28:31], v[72:75], v[96:103], v6
    ds_read_b128 v[96:99], v12 offset:24576
    v_smfmac_f32_16x16x64_bf16 v[16:19], v[72:75], a[160:167], v6
    ds_read_b128 v[100:103], v12 offset:25600
    v_max3_u32 v14, v14, v72, v73
    v_smfmac_f32_16x16x64_bf16 v[20:23], v[72:75], a[168:175], v6
    s_waitcnt lgkmcnt(2)
    v_max3_u32 v14, v14, v74, v75
    v_smfmac_f32_16x16x64_bf16 v[24:27], v[72:75], v[208:215], v6
    buffer_load_dwordx4 v[72:75], v4, s[52:55], s17 offen offset:2048 sc1
    s_waitcnt vmcnt(18)
    v_smfmac_f32_16x16x64_bf16 v[28:31], v[76:79], v[104:111], v6
    ds_read_b128 v[104:107], v12 offset:26624
    v_smfmac_f32_16x16x64_bf16 v[16:19], v[76:79], a[176:183], v6
    ds_read_b128 v[108:111], v12 offset:27648
    v_max3_u32 v14, v14, v76, v77
    v_smfmac_f32_16x16x64_bf16 v[20:23], v[76:79], a[184:191], v6
    s_waitcnt lgkmcnt(2)
    v_max3_u32 v14, v14, v78, v79
    v_smfmac_f32_16x16x64_bf16 v[24:27], v[76:79], v[216:223], v6
    buffer_load_dwordx4 v[76:79], v4, s[52:55], s17 offen offset:3072 sc1
    s_waitcnt vmcnt(18)
    v_smfmac_f32_16x16x64_bf16 v[28:31], v[80:83], v[96:103], v6
    ds_read_b128 v[96:99], v12 offset:28672
    v_smfmac_f32_16x16x64_bf16 v[16:19], v[80:83], a[192:199], v6
    ds_read_b128 v[100:103], v12 offset:29696
    v_max3_u32 v14, v14, v80, v81
    v_smfmac_f32_16x16x64_bf16 v[20:23], v[80:83], a[200:207], v6
    s_waitcnt lgkmcnt(2)
    v_max3_u32 v14, v14, v82, v83
    v_smfmac_f32_16x16x64_bf16 v[24:27], v[80:83], v[224:231], v6
    buffer_load_dwordx4 v[80:83], v5, s[52:55], s17 offen offset:0 sc1
    s_waitcnt vmcnt(18)
    v_smfmac_f32_16x16x64_bf16 v[28:31], v[84:87], v[104:111], v6
    ds_read_b128 v[104:107], v12 offset:30720
    v_smfmac_f32_16x16x64_bf16 v[16:19], v[84:87], a[208:215], v6
    ds_read_b128 v[108:111], v12 offset:31744
    v_max3_u32 v14, v14, v84, v85
    v_smfmac_f32_16x16x64_bf16 v[20:23], v[84:87], a[216:223], v6
    s_waitcnt lgkmcnt(2)
    v_max3_u32 v14, v14, v86, v87
    v_smfmac_f32_16x16x64_bf16 v[24:27], v[84:87], v[232:239], v6
    buffer_load_dwordx4 v[84:87], v5, s[52:55], s17 offen offset:1024 sc1
    s_waitcnt vmcnt(18)
    v_smfmac_f32_16x16x64_bf16 v[28:31], v[88:91], v[96:103], v6
    v_smfmac_f32_16x16x64_bf16 v[16:19], v[88:91], a[224:231], v6
    v_max3_u32 v14, v14, v88, v89
    v_smfmac_f32_16x16x64_bf16 v[20:23], v[88:91], a[232:239], v6
    s_waitcnt lgkmcnt(0)
    v_max3_u32 v14, v14, v90, v91
    v_smfmac_f32_16x16x64_bf16 v[24:27], v[88:91], v[240:247], v6
    buffer_load_dwordx4 v[88:91], v5, s[52:55], s17 offen offset:2048 sc1
    buffer_load_dword v11, v7, s[52:55], s14 offen sc1
    s_waitcnt vmcnt(18)
    v_smfmac_f32_16x16x64_bf16 v[28:31], v[92:95], v[104:111], v6
    v_smfmac_f32_16x16x64_bf16 v[16:19], v[92:95], a[240:247], v6
    v_max3_u32 v14, v14, v92, v93
    v_smfmac_f32_16x16x64_bf16 v[20:23], v[92:95], a[248:255], v6
    v_max3_u32 v14, v14, v94, v95
    v_smfmac_f32_16x16x64_bf16 v[24:27], v[92:95], v[248:255], v6
    buffer_load_dwordx4 v[92:95], v5, s[52:55], s17 offen offset:3072 sc1
    v_cmp_eq_u32 vcc, -1, v14
    s_cbranch_vccnz L_oredo
    ds_write_b128 v8, v[16:19] offset:0
    ds_write_b128 v8, v[20:23] offset:1024
    ds_write_b128 v8, v[24:27] offset:2048
    ds_write_b128 v8, v[28:31] offset:3072
    ds_read_b128 v[96:99], v12 offset:0
    ds_read_b128 v[100:103], v12 offset:1024
    ds_read_b128 v[104:107], v12 offset:2048
    ds_read_b128 v[108:111], v12 offset:3072
    v_mov_b64 v[16:17], 0
    v_mov_b64 v[18:19], 0
    v_mov_b64 v[20:21], 0
    v_mov_b64 v[22:23], 0
    v_mov_b64 v[24:25], 0
    v_mov_b64 v[26:27], 0
    v_mov_b64 v[28:29], 0
    v_mov_b64 v[30:31], 0
    v_xor_b32 v8, 0x4000, v8
    s_add_u32 s16, s16, 1
L_onext:
    s_cmp_lt_u32 s16, 64
    s_cbranch_scc1 L_oval
    s_branch L_odone
L_oredo:
    s_mov_b32 s23, 1
    s_mov_b32 s17, s24
    s_nop 7
    ds_read_b128 v[96:99], v12 offset:0
    ds_read_b128 v[100:103], v12 offset:1024
    ds_read_b128 v[104:107], v12 offset:2048
    ds_read_b128 v[108:111], v12 offset:3072
    v_mov_b64 v[16:17], 0
    v_mov_b64 v[18:19], 0
    v_mov_b64 v[20:21], 0
    v_mov_b64 v[22:23], 0
    v_mov_b64 v[24:25], 0
    v_mov_b64 v[26:27], 0
    v_mov_b64 v[28:29], 0
    v_mov_b64 v[30:31], 0
L_opoll:
    s_add_u32 s21, s16, 0
    s_and_b32 s14, s21, 1
    s_lshr_b32 s21, s21, 1
    s_lshl_b32 s14, s14, 9
    s_add_u32 s14, s14, s18
    s_mov_b32 s13, 0
    s_mov_b32 s15, 0
L_ocheck:
    buffer_load_dword v11, v7, s[52:55], s14 offen sc1
    buffer_load_dwordx4 v[32:35], v2, s[52:55], s17 offen offset:0 sc1
    buffer_load_dwordx4 v[36:39], v2, s[52:55], s17 offen offset:1024 sc1
    buffer_load_dwordx4 v[40:43], v2, s[52:55], s17 offen offset:2048 sc1
    buffer_load_dwordx4 v[44:47], v2, s[52:55], s17 offen offset:3072 sc1
    buffer_load_dwordx4 v[48:51], v3, s[52:55], s17 offen offset:0 sc1
    buffer_load_dwordx4 v[52:55], v3, s[52:55], s17 offen offset:1024 sc1
    buffer_load_dwordx4 v[56:59], v3, s[52:55], s17 offen offset:2048 sc1
    buffer_load_dwordx4 v[60:63], v3, s[52:55], s17 offen offset:3072 sc1
    buffer_load_dwordx4 v[64:67], v4, s[52:55], s17 offen offset:0 sc1
    buffer_load_dwordx4 v[68:71], v4, s[52:55], s17 offen offset:1024 sc1
    buffer_load_dwordx4 v[72:75], v4, s[52:55], s17 offen offset:2048 sc1
    buffer_load_dwordx4 v[76:79], v4, s[52:55], s17 offen offset:3072 sc1
    buffer_load_dwordx4 v[80:83], v5, s[52:55], s17 offen offset:0 sc1
    buffer_load_dwordx4 v[84:87], v5, s[52:55], s17 offen offset:1024 sc1
    buffer_load_dwordx4 v[88:91], v5, s[52:55], s17 offen offset:2048 sc1
    buffer_load_dwordx4 v[92:95], v5, s[52:55], s17 offen offset:3072 sc1
    s_waitcnt vmcnt(15)
    v_max_u32 v14, v32, v33
    v_max3_u32 v14, v14, v34, v35
    s_waitcnt vmcnt(14)
    v_max3_u32 v14, v14, v36, v37
    v_max3_u32 v14, v14, v38, v39
    s_waitcnt vmcnt(13)
    v_max3_u32 v14, v14, v40, v41
    v_max3_u32 v14, v14, v42, v43
    s_waitcnt vmcnt(12)
    v_max3_u32 v14, v14, v44, v45
    v_max3_u32 v14, v14, v46, v47
    s_waitcnt vmcnt(11)
    v_max3_u32 v14, v14, v48, v49
    v_max3_u32 v14, v14, v50, v51
    s_waitcnt vmcnt(10)
    v_max3_u32 v14, v14, v52, v53
    v_max3_u32 v14, v14, v54, v55
    s_waitcnt vmcnt(9)
    v_max3_u32 v14, v14, v56, v57
    v_max3_u32 v14, v14, v58, v59
    s_waitcnt vmcnt(8)
    v_max3_u32 v14, v14, v60, v61
    v_max3_u32 v14, v14, v62, v63
    s_waitcnt vmcnt(7)
    v_max3_u32 v14, v14, v64, v65
    v_max3_u32 v14, v14, v66, v67
    s_waitcnt vmcnt(6)
    v_max3_u32 v14, v14, v68, v69
    v_max3_u32 v14, v14, v70, v71
    s_waitcnt vmcnt(5)
    v_max3_u32 v14, v14, v72, v73
    v_max3_u32 v14, v14, v74, v75
    s_waitcnt vmcnt(4)
    v_max3_u32 v14, v14, v76, v77
    v_max3_u32 v14, v14, v78, v79
    s_waitcnt vmcnt(3)
    v_max3_u32 v14, v14, v80, v81
    v_max3_u32 v14, v14, v82, v83
    s_waitcnt vmcnt(2)
    v_max3_u32 v14, v14, v84, v85
    v_max3_u32 v14, v14, v86, v87
    s_waitcnt vmcnt(1)
    v_max3_u32 v14, v14, v88, v89
    v_max3_u32 v14, v14, v90, v91
    s_waitcnt vmcnt(0)
    v_max3_u32 v14, v14, v92, v93
    v_max3_u32 v14, v14, v94, v95
    v_cmp_eq_u32 vcc, -1, v14
    s_cbranch_vccz L_ovalid
    s_cmp_eq_u32 s15, 1
    s_cbranch_scc1 L_ovalid
    v_cmp_lt_i32 vcc, s21, v11
    s_nop 0
    s_cmp_eq_u64 vcc, -1
    s_cselect_b32 s15, 1, 0
    s_add_u32 s13, s13, 1
    s_cmp_lt_u32 s13, 1048576
    s_cbranch_scc1 L_ocheck
    s_branch L_end
L_ovalid:
    s_mov_b32 s24, s17
    s_add_u32 s17, s17, 262144
    s_cmp_eq_u32 s16, 63
    s_cselect_b32 s17, 0x40000000, s17
    s_cmp_eq_u32 s23, 0
    s_cbranch_scc1 L_ostream
    s_waitcnt vmcnt(18)
    s_waitcnt lgkmcnt(2)
    v_smfmac_f32_16x16x64_bf16 v[28:31], v[32:35], v[96:103], v6
    ds_read_b128 v[96:99], v12 offset:4096
    v_smfmac_f32_16x16x64_bf16 v[16:19], v[32:35], a[0:7], v6
    ds_read_b128 v[100:103], v12 offset:5120
    v_smfmac_f32_16x16x64_bf16 v[20:23], v[32:35], a[8:15], v6
    s_waitcnt lgkmcnt(2)
    v_smfmac_f32_16x16x64_bf16 v[24:27], v[32:35], v[128:135], v6
    buffer_load_dwordx4 v[32:35], v2, s[52:55], s17 offen offset:0 sc1
    s_waitcnt vmcnt(18)
    v_smfmac_f32_16x16x64_bf16 v[28:31], v[36:39], v[104:111], v6
    ds_read_b128 v[104:107], v12 offset:6144
    v_smfmac_f32_16x16x64_bf16 v[16:19], v[36:39], a[16:23], v6
    ds_read_b128 v[108:111], v12 offset:7168
    v_smfmac_f32_16x16x64_bf16 v[20:23], v[36:39], a[24:31], v6
    s_waitcnt lgkmcnt(2)
    v_smfmac_f32_16x16x64_bf16 v[24:27], v[36:39], v[136:143], v6
    buffer_load_dwordx4 v[36:39], v2, s[52:55], s17 offen offset:1024 sc1
    s_waitcnt vmcnt(18)
    v_smfmac_f32_16x16x64_bf16 v[28:31], v[40:43], v[96:103], v6
    ds_read_b128 v[96:99], v12 offset:8192
    v_smfmac_f32_16x16x64_bf16 v[16:19], v[40:43], a[32:39], v6
    ds_read_b128 v[100:103], v12 offset:9216
    v_smfmac_f32_16x16x64_bf16 v[20:23], v[40:43], a[40:47], v6
    s_waitcnt lgkmcnt(2)
    v_smfmac_f32_16x16x64_bf16 v[24:27], v[40:43], v[144:151], v6
    buffer_load_dwordx4 v[40:43], v2, s[52:55], s17 offen offset:2048 sc1
    s_waitcnt vmcnt(18)
    v_smfmac_f32_16x16x64_bf16 v[28:31], v[44:47], v[104:111], v6
    ds_read_b128 v[104:107], v12 offset:10240
    v_smfmac_f32_16x16x64_bf16 v[16:19], v[44:47], a[48:55], v6
    ds_read_b128 v[108:111], v12 offset:11264
    v_smfmac_f32_16x16x64_bf16 v[20:23], v[44:47], a[56:63], v6
    s_waitcnt lgkmcnt(2)
    v_smfmac_f32_16x16x64_bf16 v[24:27], v[44:47], v[152:159], v6
    buffer_load_dwordx4 v[44:47], v2, s[52:55], s17 offen offset:3072 sc1
    s_waitcnt vmcnt(18)
    v_smfmac_f32_16x16x64_bf16 v[28:31], v[48:51], v[96:103], v6
    ds_read_b128 v[96:99], v12 offset:12288
    v_smfmac_f32_16x16x64_bf16 v[16:19], v[48:51], a[64:71], v6
    ds_read_b128 v[100:103], v12 offset:13312
    v_smfmac_f32_16x16x64_bf16 v[20:23], v[48:51], a[72:79], v6
    s_waitcnt lgkmcnt(2)
    v_smfmac_f32_16x16x64_bf16 v[24:27], v[48:51], v[160:167], v6
    buffer_load_dwordx4 v[48:51], v3, s[52:55], s17 offen offset:0 sc1
    s_waitcnt vmcnt(18)
    v_smfmac_f32_16x16x64_bf16 v[28:31], v[52:55], v[104:111], v6
    ds_read_b128 v[104:107], v12 offset:14336
    v_smfmac_f32_16x16x64_bf16 v[16:19], v[52:55], a[80:87], v6
    ds_read_b128 v[108:111], v12 offset:15360
    v_smfmac_f32_16x16x64_bf16 v[20:23], v[52:55], a[88:95], v6
    s_waitcnt lgkmcnt(2)
    v_smfmac_f32_16x16x64_bf16 v[24:27], v[52:55], v[168:175], v6
    buffer_load_dwordx4 v[52:55], v3, s[52:55], s17 offen offset:1024 sc1
    s_waitcnt vmcnt(18)
    v_smfmac_f32_16x16x64_bf16 v[28:31], v[56:59], v[96:103], v6
    ds_read_b128 v[96:99], v12 offset:16384
    v_smfmac_f32_16x16x64_bf16 v[16:19], v[56:59], a[96:103], v6
    ds_read_b128 v[100:103], v12 offset:17408
    v_smfmac_f32_16x16x64_bf16 v[20:23], v[56:59], a[104:111], v6
    s_waitcnt lgkmcnt(2)
    v_smfmac_f32_16x16x64_bf16 v[24:27], v[56:59], v[176:183], v6
    buffer_load_dwordx4 v[56:59], v3, s[52:55], s17 offen offset:2048 sc1
    s_waitcnt vmcnt(18)
    v_smfmac_f32_16x16x64_bf16 v[28:31], v[60:63], v[104:111], v6
    ds_read_b128 v[104:107], v12 offset:18432
    v_smfmac_f32_16x16x64_bf16 v[16:19], v[60:63], a[112:119], v6
    ds_read_b128 v[108:111], v12 offset:19456
    v_smfmac_f32_16x16x64_bf16 v[20:23], v[60:63], a[120:127], v6
    s_waitcnt lgkmcnt(2)
    v_smfmac_f32_16x16x64_bf16 v[24:27], v[60:63], v[184:191], v6
    buffer_load_dwordx4 v[60:63], v3, s[52:55], s17 offen offset:3072 sc1
    s_waitcnt vmcnt(18)
    v_smfmac_f32_16x16x64_bf16 v[28:31], v[64:67], v[96:103], v6
    ds_read_b128 v[96:99], v12 offset:20480
    v_smfmac_f32_16x16x64_bf16 v[16:19], v[64:67], a[128:135], v6
    ds_read_b128 v[100:103], v12 offset:21504
    v_smfmac_f32_16x16x64_bf16 v[20:23], v[64:67], a[136:143], v6
    s_waitcnt lgkmcnt(2)
    v_smfmac_f32_16x16x64_bf16 v[24:27], v[64:67], v[192:199], v6
    buffer_load_dwordx4 v[64:67], v4, s[52:55], s17 offen offset:0 sc1
    s_waitcnt vmcnt(18)
    v_smfmac_f32_16x16x64_bf16 v[28:31], v[68:71], v[104:111], v6
    ds_read_b128 v[104:107], v12 offset:22528
    v_smfmac_f32_16x16x64_bf16 v[16:19], v[68:71], a[144:151], v6
    ds_read_b128 v[108:111], v12 offset:23552
    v_smfmac_f32_16x16x64_bf16 v[20:23], v[68:71], a[152:159], v6
    s_waitcnt lgkmcnt(2)
    v_smfmac_f32_16x16x64_bf16 v[24:27], v[68:71], v[200:207], v6
    buffer_load_dwordx4 v[68:71], v4, s[52:55], s17 offen offset:1024 sc1
    buffer_load_dword v13, v7, s[52:55], s14 offen sc1
    buffer_load_dword v13, v7, s[52:55], s14 offen sc1
    s_waitcnt vmcnt(18)
    v_smfmac_f32_16x16x64_bf16 v[28:31], v[72:75], v[96:103], v6
    ds_read_b128 v[96:99], v12 offset:24576
    v_smfmac_f32_16x16x64_bf16 v[16:19], v[72:75], a[160:167], v6
    ds_read_b128 v[100:103], v12 offset:25600
    v_smfmac_f32_16x16x64_bf16 v[20:23], v[72:75], a[168:175], v6
    s_waitcnt lgkmcnt(2)
    v_smfmac_f32_16x16x64_bf16 v[24:27], v[72:75], v[208:215], v6
    buffer_load_dwordx4 v[72:75], v4, s[52:55], s17 offen offset:2048 sc1
    s_waitcnt vmcnt(18)
    v_smfmac_f32_16x16x64_bf16 v[28:31], v[76:79], v[104:111], v6
    ds_read_b128 v[104:107], v12 offset:26624
    v_smfmac_f32_16x16x64_bf16 v[16:19], v[76:79], a[176:183], v6
    ds_read_b128 v[108:111], v12 offset:27648
    v_smfmac_f32_16x16x64_bf16 v[20:23], v[76:79], a[184:191], v6
    s_waitcnt lgkmcnt(2)
    v_smfmac_f32_16x16x64_bf16 v[24:27], v[76:79], v[216:223], v6
    buffer_load_dwordx4 v[76:79], v4, s[52:55], s17 offen offset:3072 sc1
    s_waitcnt vmcnt(18)
    v_smfmac_f32_16x16x64_bf16 v[28:31], v[80:83], v[96:103], v6
    ds_read_b128 v[96:99], v12 offset:28672
    v_smfmac_f32_16x16x64_bf16 v[16:19], v[80:83], a[192:199], v6
    ds_read_b128 v[100:103], v12 offset:29696
    v_smfmac_f32_16x16x64_bf16 v[20:23], v[80:83], a[200:207], v6
    s_waitcnt lgkmcnt(2)
    v_smfmac_f32_16x16x64_bf16 v[24:27], v[80:83], v[224:231], v6
    buffer_load_dwordx4 v[80:83], v5, s[52:55], s17 offen offset:0 sc1
    s_waitcnt vmcnt(18)
    v_smfmac_f32_16x16x64_bf16 v[28:31], v[84:87], v[104:111], v6
    ds_read_b128 v[104:107], v12 offset:30720
    v_smfmac_f32_16x16x64_bf16 v[16:19], v[84:87], a[208:215], v6
    ds_read_b128 v[108:111], v12 offset:31744
    v_smfmac_f32_16x16x64_bf16 v[20:23], v[84:87], a[216:223], v6
    s_waitcnt lgkmcnt(2)
    v_smfmac_f32_16x16x64_bf16 v[24:27], v[84:87], v[232:239], v6
    buffer_load_dwordx4 v[84:87], v5, s[52:55], s17 offen offset:1024 sc1
    s_waitcnt vmcnt(18)
    v_smfmac_f32_16x16x64_bf16 v[28:31], v[88:91], v[96:103], v6
    v_smfmac_f32_16x16x64_bf16 v[16:19], v[88:91], a[224:231], v6
    v_smfmac_f32_16x16x64_bf16 v[20:23], v[88:91], a[232:239], v6
    s_waitcnt lgkmcnt(0)
    v_smfmac_f32_16x16x64_bf16 v[24:27], v[88:91], v[240:247], v6
    buffer_load_dwordx4 v[88:91], v5, s[52:55], s17 offen offset:2048 sc1
    buffer_load_dword v11, v7, s[52:55], s14 offen sc1
    s_waitcnt vmcnt(18)
    v_smfmac_f32_16x16x64_bf16 v[28:31], v[92:95], v[104:111], v6
    v_smfmac_f32_16x16x64_bf16 v[16:19], v[92:95], a[240:247], v6
    v_smfmac_f32_16x16x64_bf16 v[20:23], v[92:95], a[248:255], v6
    v_smfmac_f32_16x16x64_bf16 v[24:27], v[92:95], v[248:255], v6
    buffer_load_dwordx4 v[92:95], v5, s[52:55], s17 offen offset:3072 sc1
    ds_write_b128 v8, v[16:19] offset:0
    s_nop 1
    ds_write_b128 v8, v[20:23] offset:1024
    s_nop 2
    ds_write_b128 v8, v[24:27] offset:2048
    ds_write_b128 v8, v[28:31] offset:3072
    ds_read_b128 v[96:99], v12 offset:0
    ds_read_b128 v[100:103], v12 offset:1024
    ds_read_b128 v[104:107], v12 offset:2048
    ds_read_b128 v[108:111], v12 offset:3072
    v_mov_b64 v[16:17], 0
    v_mov_b64 v[18:19], 0
    v_mov_b64 v[20:21], 0
    v_mov_b64 v[22:23], 0
    v_mov_b64 v[24:25], 0
    v_mov_b64 v[26:27], 0
    v_mov_b64 v[28:29], 0
    v_mov_b64 v[30:31], 0
    v_xor_b32 v8, 0x4000, v8
    s_add_u32 s16, s16, 1
    s_branch L_onext
L_odrain:
    s_waitcnt vmcnt(18)
    s_waitcnt lgkmcnt(2)
    v_smfmac_f32_16x16x64_bf16 v[28:31], v[32:35], v[96:103], v6
    s_waitcnt lgkmcnt(4)
    s_barrier
    ds_read_b128 v[96:99], v12 offset:4096
    v_smfmac_f32_16x16x64_bf16 v[16:19], v[32:35], a[0:7], v6
    ds_read_b128 v[100:103], v12 offset:5120
    v_smfmac_f32_16x16x64_bf16 v[20:23], v[32:35], a[8:15], v6
    ds_read_b128 v[112:115], v9 offset:0
    ds_read_b128 v[116:119], v9 offset:4096
    s_waitcnt lgkmcnt(4)
    v_smfmac_f32_16x16x64_bf16 v[24:27], v[32:35], v[128:135], v6
    s_waitcnt vmcnt(17)
    v_smfmac_f32_16x16x64_bf16 v[28:31], v[36:39], v[104:111], v6
    ds_read_b128 v[104:107], v12 offset:6144
    v_smfmac_f32_16x16x64_bf16 v[16:19], v[36:39], a[16:23], v6
    ds_read_b128 v[108:111], v12 offset:7168
    v_smfmac_f32_16x16x64_bf16 v[20:23], v[36:39], a[24:31], v6
    ds_read_b128 v[120:123], v9 offset:8192
    ds_read_b128 v[124:127], v9 offset:12288
    s_waitcnt lgkmcnt(6)
    v_smfmac_f32_16x16x64_bf16 v[24:27], v[36:39], v[136:143], v6
    s_waitcnt vmcnt(16)
    v_smfmac_f32_16x16x64_bf16 v[28:31], v[40:43], v[96:103], v6
    ds_read_b128 v[96:99], v12 offset:8192
    v_smfmac_f32_16x16x64_bf16 v[16:19], v[40:43], a[32:39], v6
    ds_read_b128 v[100:103], v12 offset:9216
    v_smfmac_f32_16x16x64_bf16 v[20:23], v[40:43], a[40:47], v6
    s_waitcnt lgkmcnt(4)
    v_smfmac_f32_16x16x64_bf16 v[24:27], v[40:43], v[144:151], v6
    s_waitcnt vmcnt(15)
    v_smfmac_f32_16x16x64_bf16 v[28:31], v[44:47], v[104:111], v6
    s_waitcnt lgkmcnt(2)
    ds_read_b128 v[104:107], v12 offset:10240
    v_add_f32 v112, v112, v116
    v_smfmac_f32_16x16x64_bf16 v[16:19], v[44:47], a[48:55], v6
    ds_read_b128 v[108:111], v12 offset:11264
    v_add_f32 v113, v113, v117
    v_smfmac_f32_16x16x64_bf16 v[20:23], v[44:47], a[56:63], v6
    s_waitcnt lgkmcnt(2)
    v_add_f32 v114, v114, v118
    v_smfmac_f32_16x16x64_bf16 v[24:27], v[44:47], v[152:159], v6
    s_waitcnt vmcnt(14)
    v_smfmac_f32_16x16x64_bf16 v[28:31], v[48:51], v[96:103], v6
    ds_read_b128 v[96:99], v12 offset:12288
    v_add_f32 v115, v115, v119
    v_smfmac_f32_16x16x64_bf16 v[16:19], v[48:51], a[64:71], v6
    ds_read_b128 v[100:103], v12 offset:13312
    v_add_f32 v120, v120, v124
    v_smfmac_f32_16x16x64_bf16 v[20:23], v[48:51], a[72:79], v6
    s_waitcnt lgkmcnt(2)
    v_add_f32 v121, v121, v125
    v_smfmac_f32_16x16x64_bf16 v[24:27], v[48:51], v[160:167], v6
    s_waitcnt vmcnt(13)
    v_smfmac_f32_16x16x64_bf16 v[28:31], v[52:55], v[104:111], v6
    ds_read_b128 v[104:107], v12 offset:14336
    v_add_f32 v122, v122, v126
    v_smfmac_f32_16x16x64_bf16 v[16:19], v[52:55], a[80:87], v6
    ds_read_b128 v[108:111], v12 offset:15360
    v_add_f32 v123, v123, v127
    v_smfmac_f32_16x16x64_bf16 v[20:23], v[52:55], a[88:95], v6
    s_waitcnt lgkmcnt(2)
    v_add_f32 v112, v112, v120
    v_smfmac_f32_16x16x64_bf16 v[24:27], v[52:55], v[168:175], v6
    s_waitcnt vmcnt(12)
    v_smfmac_f32_16x16x64_bf16 v[28:31], v[56:59], v[96:103], v6
    ds_read_b128 v[96:99], v12 offset:16384
    v_add_f32 v113, v113, v121
    v_smfmac_f32_16x16x64_bf16 v[16:19], v[56:59], a[96:103], v6
    ds_read_b128 v[100:103], v12 offset:17408
    v_add_f32 v114, v114, v122
    v_smfmac_f32_16x16x64_bf16 v[20:23], v[56:59], a[104:111], v6
    s_waitcnt lgkmcnt(2)
    v_add_f32 v115, v115, v123
    v_smfmac_f32_16x16x64_bf16 v[24:27], v[56:59], v[176:183], v6
    s_waitcnt vmcnt(11)
    v_smfmac_f32_16x16x64_bf16 v[28:31], v[60:63], v[104:111], v6
    ds_read_b128 v[104:107], v12 offset:18432
    v_permlane32_swap_b32 v112, v114
    v_smfmac_f32_16x16x64_bf16 v[16:19], v[60:63], a[112:119], v6
    ds_read_b128 v[108:111], v12 offset:19456
    v_permlane32_swap_b32 v113, v115
    v_smfmac_f32_16x16x64_bf16 v[20:23], v[60:63], a[120:127], v6
    s_waitcnt lgkmcnt(2)
    v_add_f32 v112, v112, v114
    v_smfmac_f32_16x16x64_bf16 v[24:27], v[60:63], v[184:191], v6
    s_waitcnt vmcnt(10)
    v_smfmac_f32_16x16x64_bf16 v[28:31], v[64:67], v[96:103], v6
    ds_read_b128 v[96:99], v12 offset:20480
    v_add_f32 v113, v113, v115
    v_smfmac_f32_16x16x64_bf16 v[16:19], v[64:67], a[128:135], v6
    ds_read_b128 v[100:103], v12 offset:21504
    v_cvt_pk_bf16_f32 v116, v112, v113
    v_smfmac_f32_16x16x64_bf16 v[20:23], v[64:67], a[136:143], v6
    s_waitcnt lgkmcnt(2)
    v_xor_b32 v9, 0x4000, v9
    v_smfmac_f32_16x16x64_bf16 v[24:27], v[64:67], v[192:199], v6
    s_waitcnt vmcnt(9)
    v_smfmac_f32_16x16x64_bf16 v[28:31], v[68:71], v[104:111], v6
    ds_read_b128 v[104:107], v12 offset:22528
    v_smfmac_f32_16x16x64_bf16 v[16:19], v[68:71], a[144:151], v6
    ds_read_b128 v[108:111], v12 offset:23552
    v_smfmac_f32_16x16x64_bf16 v[20:23], v[68:71], a[152:159], v6
    s_waitcnt lgkmcnt(2)
    v_smfmac_f32_16x16x64_bf16 v[24:27], v[68:71], v[200:207], v6
    buffer_store_short v116, v10, s[80:83], s22 offen
    buffer_store_short_d16_hi v116, v10, s[80:83], s22 offen offset:2048
    s_mov_b32 s22, s20
    s_add_u32 s20, s20, 65536
    s_waitcnt vmcnt(8)
    v_smfmac_f32_16x16x64_bf16 v[28:31], v[72:75], v[96:103], v6
    ds_read_b128 v[96:99], v12 offset:24576
    v_smfmac_f32_16x16x64_bf16 v[16:19], v[72:75], a[160:167], v6
    ds_read_b128 v[100:103], v12 offset:25600
    v_smfmac_f32_16x16x64_bf16 v[20:23], v[72:75], a[168:175], v6
    s_waitcnt lgkmcnt(2)
    v_smfmac_f32_16x16x64_bf16 v[24:27], v[72:75], v[208:215], v6
    s_waitcnt vmcnt(7)
    v_smfmac_f32_16x16x64_bf16 v[28:31], v[76:79], v[104:111], v6
    ds_read_b128 v[104:107], v12 offset:26624
    v_smfmac_f32_16x16x64_bf16 v[16:19], v[76:79], a[176:183], v6
    ds_read_b128 v[108:111], v12 offset:27648
    v_smfmac_f32_16x16x64_bf16 v[20:23], v[76:79], a[184:191], v6
    s_waitcnt lgkmcnt(2)
    v_smfmac_f32_16x16x64_bf16 v[24:27], v[76:79], v[216:223], v6
    s_waitcnt vmcnt(6)
    v_smfmac_f32_16x16x64_bf16 v[28:31], v[80:83], v[96:103], v6
    ds_read_b128 v[96:99], v12 offset:28672
    v_smfmac_f32_16x16x64_bf16 v[16:19], v[80:83], a[192:199], v6
    ds_read_b128 v[100:103], v12 offset:29696
    v_smfmac_f32_16x16x64_bf16 v[20:23], v[80:83], a[200:207], v6
    s_waitcnt lgkmcnt(2)
    v_smfmac_f32_16x16x64_bf16 v[24:27], v[80:83], v[224:231], v6
    s_waitcnt vmcnt(5)
    v_smfmac_f32_16x16x64_bf16 v[28:31], v[84:87], v[104:111], v6
    ds_read_b128 v[104:107], v12 offset:30720
    v_smfmac_f32_16x16x64_bf16 v[16:19], v[84:87], a[208:215], v6
    ds_read_b128 v[108:111], v12 offset:31744
    v_smfmac_f32_16x16x64_bf16 v[20:23], v[84:87], a[216:223], v6
    s_waitcnt lgkmcnt(2)
    v_smfmac_f32_16x16x64_bf16 v[24:27], v[84:87], v[232:239], v6
    s_waitcnt vmcnt(4)
    v_smfmac_f32_16x16x64_bf16 v[28:31], v[88:91], v[96:103], v6
    v_smfmac_f32_16x16x64_bf16 v[16:19], v[88:91], a[224:231], v6
    v_smfmac_f32_16x16x64_bf16 v[20:23], v[88:91], a[232:239], v6
    s_waitcnt lgkmcnt(0)
    v_smfmac_f32_16x16x64_bf16 v[24:27], v[88:91], v[240:247], v6
    s_waitcnt vmcnt(2)
    v_smfmac_f32_16x16x64_bf16 v[28:31], v[92:95], v[104:111], v6
    v_smfmac_f32_16x16x64_bf16 v[16:19], v[92:95], a[240:247], v6
    v_smfmac_f32_16x16x64_bf16 v[20:23], v[92:95], a[248:255], v6
    v_smfmac_f32_16x16x64_bf16 v[24:27], v[92:95], v[248:255], v6
    ds_write_b128 v8, v[16:19] offset:0
    s_nop 2
    ds_write_b128 v8, v[20:23] offset:1024
    s_nop 2
    ds_write_b128 v8, v[24:27] offset:2048
    ds_write_b128 v8, v[28:31] offset:3072
    ds_read_b128 v[96:99], v12 offset:0
    ds_read_b128 v[100:103], v12 offset:1024
    ds_read_b128 v[104:107], v12 offset:2048
    ds_read_b128 v[108:111], v12 offset:3072
    v_mov_b64 v[16:17], 0
    v_mov_b64 v[18:19], 0
    v_mov_b64 v[20:21], 0
    v_mov_b64 v[22:23], 0
    v_mov_b64 v[24:25], 0
    v_mov_b64 v[26:27], 0
    v_mov_b64 v[28:29], 0
    v_mov_b64 v[30:31], 0
    v_xor_b32 v8, 0x4000, v8
    s_add_u32 s16, s16, 1
    s_branch L_orefill
L_odone:
    s_waitcnt lgkmcnt(0)
    s_barrier
    ds_read_b128 v[112:115], v9 offset:0
    ds_read_b128 v[116:119], v9 offset:4096
    ds_read_b128 v[120:123], v9 offset:8192
    ds_read_b128 v[124:127], v9 offset:12288
    s_waitcnt lgkmcnt(0)
    v_add_f32 v112, v112, v116
    v_add_f32 v113, v113, v117
    v_add_f32 v114, v114, v118
    v_add_f32 v115, v115, v119
    v_add_f32 v120, v120, v124
    v_add_f32 v121, v121, v125
    v_add_f32 v122, v122, v126
    v_add_f32 v123, v123, v127
    v_add_f32 v112, v112, v120
    v_add_f32 v113, v113, v121
    v_add_f32 v114, v114, v122
    v_add_f32 v115, v115, v123
    s_nop 0
    v_permlane32_swap_b32 v112, v114
    v_permlane32_swap_b32 v113, v115
    v_add_f32 v112, v112, v114
    v_add_f32 v113, v113, v115
    v_cvt_pk_bf16_f32 v116, v112, v113
    v_xor_b32 v9, 0x4000, v9
    buffer_store_short v116, v10, s[80:83], s22 offen
    buffer_store_short_d16_hi v116, v10, s[80:83], s22 offen offset:2048
    s_mov_b32 s22, s20
    s_add_u32 s20, s20, 65536
    s_endpgm
L_end:
    s_endpgm
.section .rodata,"a"
.p2align 6
.amdhsa_kernel concat_heads__memory_aug_recurrent_mem_tr__memory_aug_recurrent_mem_tr__prompt_kernel
  .amdhsa_next_free_vgpr 512
  .amdhsa_next_free_sgpr 102
  .amdhsa_accum_offset 256
  .amdhsa_group_segment_fixed_size 0
  .amdhsa_kernarg_size 136
  .amdhsa_user_sgpr_count 2
  .amdhsa_user_sgpr_kernarg_segment_ptr 1
  .amdhsa_system_sgpr_workgroup_id_x 1
  .amdhsa_float_denorm_mode_32 3
.end_amdhsa_kernel
```
